```python
import torch

def _softmax(x, axis=-1):
    return torch.softmax(x, dim=axis)
def _gelu(x):
    return torch.nn.functional.gelu(x, approximate="tanh")
def _silu(x):
    return torch.nn.functional.silu(x)
def _sigmoid(x):
    return torch.sigmoid(x)
def _layernorm(x, axis=-1, eps=1e-5):
    m = x.mean(dim=axis, keepdim=True)
    v = x.var(dim=axis, keepdim=True, unbiased=False)
    return (x - m) / torch.sqrt(v + eps)
def _scatter_add(tgt, idx, src, axis=0):
    return tgt.clone().index_add_(axis, idx, src)
def _segment_sum(src, seg, n):
    out = torch.zeros((n,) + src.shape[1:], dtype=src.dtype)
    return out.index_add_(0, seg, src)
def _pad(x, pw):
    flat = tuple(v for pair in reversed(pw) for v in pair)
    return torch.nn.functional.pad(x, flat)

kernel_name = 'concat_heads__mha_block_cached__gqa_block_cached__near_ridge'

def setup_inputs():

    _w = (lambda a: (lambda t: t.to(torch.bfloat16) if t.is_floating_point() else t)(torch.as_tensor(a)))
    def _A_setup():
        B, Sq, D = 8, 112, 512
        H, Sk, Dh = 32, 512, 128
        return {
            "x": _w((lambda *s: torch.randn(*s, dtype=torch.bfloat16) * 0.8)(B, Sq, D)),
            "k_cache": _w((lambda *s: torch.randn(*s, dtype=torch.bfloat16) * 0.8)(B, H, Sk, Dh)),
            "v_cache": _w((lambda *s: torch.randn(*s, dtype=torch.bfloat16) * 0.05)(B, H, Sk, Dh)),
            "wq": _w((lambda *s: torch.randn(*s, dtype=torch.bfloat16) * 0.8)(D, H * Dh) * (D ** -0.5)),
            "wo": _w((lambda *s: torch.randn(*s, dtype=torch.bfloat16) * 0.05)(H * Dh, D) * ((H * Dh) ** -0.5)),
        }
    _A_in = _A_setup()

    def _B_setup():
        B, Sq, D = 8, 112, 512
        Hq, Hkv, Sk, Dh = 32, 32, 512, 128
        assert Hq % Hkv == 0, (Hq, Hkv)
        return {
            "x": _w((lambda *s: torch.randn(*s, dtype=torch.bfloat16) * 0.8)(B, Sq, D)),
            "k_cache": _w((lambda *s: torch.randn(*s, dtype=torch.bfloat16) * 0.8)(B, Hkv, Sk, Dh)),
            "v_cache": _w((lambda *s: torch.randn(*s, dtype=torch.bfloat16) * 0.05)(B, Hkv, Sk, Dh)),
            "wq": _w((lambda *s: torch.randn(*s, dtype=torch.bfloat16) * 0.8)(D, Hq * Dh) * (D ** -0.5)),
            "wo": _w((lambda *s: torch.randn(*s, dtype=torch.bfloat16) * 0.05)(Hq * Dh, D) * ((Hq * Dh) ** -0.5)),
        }
    _B_in = _B_setup()

    return {
        "A_x": _A_in["x"],
        "A_k_cache": _A_in["k_cache"],
        "A_v_cache": _A_in["v_cache"],
        "A_wq": _A_in["wq"],
        "A_wo": _A_in["wo"],
        "B_x": _B_in["x"],
        "B_k_cache": _B_in["k_cache"],
        "B_v_cache": _B_in["v_cache"],
        "B_wq": _B_in["wq"],
        "B_wo": _B_in["wo"],
    }

def reference(A_x, A_k_cache, A_v_cache, A_wq, A_wo, B_x, B_k_cache, B_v_cache, B_wq, B_wo):
    def _A_ref(x, k_cache, v_cache, wq, wo):
        B, Sq, D = x.shape
        H, Dh = 32, 128
        q = (lambda x, *d: x.permute(*d))((x @ wq).reshape(B, Sq, H, Dh), 0, 2, 1, 3)
        scores = torch.einsum("bhqd,bhkd->bhqk", q, k_cache) * (Dh ** -0.5)
        p = _softmax(scores, axis=-1)
        o = torch.einsum("bhqk,bhkd->bhqd", p, v_cache)
        return (lambda x, *d: x.permute(*d))(o, 0, 2, 1, 3).reshape(B, Sq, H * Dh) @ wo

    def _B_ref(x, k_cache, v_cache, wq, wo):
        B, Sq, D = x.shape
        Hq, Dh = 32, 128
        Hkv = k_cache.shape[1]
        rep = Hq // Hkv
        q = (lambda x, *d: x.permute(*d))((x @ wq).reshape(B, Sq, Hq, Dh), 0, 2, 1, 3)
        k = (lambda x, n, axis: torch.repeat_interleave(x, n, dim=axis))(k_cache, rep, axis=1)
        v = (lambda x, n, axis: torch.repeat_interleave(x, n, dim=axis))(v_cache, rep, axis=1)
        scores = torch.einsum("bhqd,bhkd->bhqk", q, k) * (Dh ** -0.5)
        p = _softmax(scores, axis=-1)
        o = torch.einsum("bhqk,bhkd->bhqd", p, v)
        return (lambda x, *d: x.permute(*d))(o, 0, 2, 1, 3).reshape(B, Sq, Hq * Dh) @ wo

    a = _A_ref(A_x, A_k_cache, A_v_cache, A_wq, A_wo)
    b = _B_ref(B_x, B_k_cache, B_v_cache, B_wq, B_wo)
    return torch.concatenate([a, b], axis=-1)
```

```asm
; @launch kernel=attn_kernel grid=(256,1,1) block=(512,1,1) lds=163840
.amdgcn_target "amdgcn-amd-amdhsa--gfx950"
.text
.globl attn_kernel
.p2align 8
.type attn_kernel,@function
attn_kernel:
  s_cmp_ge_u32 s2, 256
  s_cbranch_scc1 L_k1_done
  s_and_b32 s3, s2, 7
  s_lshr_b32 s44, s2, 3
  s_lshr_b32 s45, s3, 2
  s_mul_i32 s46, s45, 40
  s_load_dwordx8 s[4:11], s[0:1], s46
  s_load_dwordx2 s[12:13], s[0:1], 96
  s_add_u32 s46, s46, 32
  s_load_dwordx2 s[14:15], s[0:1], s46
  s_load_dwordx2 s[72:73], s[0:1], 88
  s_load_dwordx2 s[96:97], s[0:1], 80
  s_and_b32 s47, s3, 3
  s_lshl_b32 s47, s47, 3
  s_lshr_b32 s48, s44, 2
  s_add_u32 s47, s47, s48
  s_and_b32 s48, s44, 3
  s_lshr_b32 s62, s44, 2
  s_add_u32 s62, s62, s48
  s_and_b32 s62, s62, 3
  v_lshrrev_b32 v1, 6, v0
  v_and_b32 v2, 63, v0
  v_readfirstlane_b32 s36, v1
  v_lshrrev_b32 v3, 4, v2
  v_and_b32 v4, 15, v2
  v_bfe_u32 v5, v2, 2, 2
  v_and_b32 v6, 3, v2
  v_and_b32 v7, 1, v3
  v_lshrrev_b32 v8, 1, v3
  v_lshl_or_b32 v7, v8, 2, v7
  v_lshlrev_b32 v248, 4, v2
  v_lshlrev_b32 v249, 3, v2
  s_cmp_eq_u32 s36, 7
  s_cbranch_scc1 L_k1_loader
  s_lshl_b32 s50, s36, 4
  v_lshlrev_b32 v9, 1, v3
  v_xor_b32 v9, v9, v4
  v_add_u32 v8, s50, v3
  v_lshlrev_b32 v8, 10, v8
  v_lshl_add_u32 v8, v9, 4, v8
  v_xor_b32 v244, 0, v8
  v_xor_b32 v245, 128, v8
  v_xor_b32 v246, 144, v8
  v_xor_b32 v247, 16, v8
  s_lshl_b32 s51, s36, 13
  s_mul_i32 s50, s48, 114688
  s_waitcnt lgkmcnt(0)
  s_add_u32 s16, s4, s50
  s_addc_u32 s17, s5, 0
  s_mov_b32 s18, 573440
  s_mov_b32 s19, 0x20000
  s_add_u32 s63, s62, 0
  s_and_b32 s63, s63, 3
  s_lshl_b32 s63, s63, 8
  s_add_u32 m0, s51, 0
  s_add_u32 s38, s63, 0
  buffer_load_dwordx4 v244, s[16:19], s38 offen lds
  s_add_u32 m0, s51, 1024
  s_add_u32 s38, s63, 4096
  buffer_load_dwordx4 v245, s[16:19], s38 offen lds
  s_add_u32 m0, s51, 2048
  s_add_u32 s38, s63, 8192
  buffer_load_dwordx4 v246, s[16:19], s38 offen lds
  s_add_u32 m0, s51, 3072
  s_add_u32 s38, s63, 12288
  buffer_load_dwordx4 v247, s[16:19], s38 offen lds
  s_add_u32 m0, s51, 4096
  s_add_u32 s38, s63, 458752
  buffer_load_dwordx4 v244, s[16:19], s38 offen lds
  s_add_u32 m0, s51, 5120
  s_add_u32 s38, s63, 462848
  buffer_load_dwordx4 v245, s[16:19], s38 offen lds
  s_add_u32 m0, s51, 6144
  s_add_u32 s38, s63, 466944
  buffer_load_dwordx4 v246, s[16:19], s38 offen lds
  s_add_u32 m0, s51, 7168
  s_add_u32 s38, s63, 471040
  buffer_load_dwordx4 v247, s[16:19], s38 offen lds
  s_lshl_b32 s50, s45, 3
  s_add_u32 s50, s50, s48
  s_mul_i32 s50, s50, 224
  s_add_u32 s50, s50, s47
  s_lshl_b32 s50, s50, 12
  s_add_u32 s32, s12, s50
  s_addc_u32 s33, s13, 0
  s_mov_b32 s34, 4460544
  s_mov_b32 s35, 0x20000
  s_mov_b32 s41, 3670016
  s_mov_b32 s40, 0x3e0293ee
  s_and_b32 s66, s3, 3
  s_lshl_b32 s98, s3, 13
  s_add_u32 s98, s98, 0x3000000
  s_add_u32 s68, s12, s98
  s_addc_u32 s69, s13, 0
  s_mov_b32 s70, 8192
  s_mov_b32 s71, 0x20000
  s_mov_b32 s74, 256
  s_mov_b32 s75, 0x20000
  s_lshl_b32 s53, s48, 9
  s_lshl_b32 s98, s36, 6
  s_add_u32 s53, s53, s98
  s_lshr_b32 s98, s44, 2
  s_lshl_b32 s98, s98, 3
  s_add_u32 s52, s53, s98
  s_mov_b32 s55, 0
  s_mov_b32 s56, 0
  s_mov_b32 s37, 0
  s_mov_b32 s39, 0
  s_mov_b32 s57, 0
  s_mov_b32 s46, -1
  s_mov_b32 s59, 0xff
  s_mov_b32 s67, 0
  s_getreg_b32 s49, hwreg(HW_REG_XCC_ID, 0, 16)
  s_add_u32 s49, s49, 1
  s_lshr_b32 s98, s44, 2
  s_and_b32 s99, s44, 3
  s_lshl_b32 s100, s66, 20
  s_lshl_b32 s101, s98, 7
  s_add_u32 s100, s100, s101
  s_add_u32 s76, s14, s100
  s_addc_u32 s77, s15, 0
  s_sub_u32 s78, 0x100000, s101
  s_mov_b32 s79, 0x20000
  s_lshl_b32 s100, s45, 3
  s_add_u32 s99, s99, s100
  s_mul_i32 s100, s99, 7
  s_add_u32 s100, s100, s36
  s_lshl_b32 s100, s100, 17
  s_lshl_b32 s101, s66, 15
  s_add_u32 s100, s100, s101
  s_add_u32 s80, s12, s100
  s_addc_u32 s81, s13, 0
  s_mov_b32 s82, 3702784
  s_mov_b32 s83, 0x20000
  s_lshl_b32 s99, s99, 4
  s_lshl_b32 s100, s98, 1
  s_add_u32 s99, s99, s100
  s_lshl_b32 s99, s99, 2
  s_add_u32 s99, s99, s66
  s_mul_i32 s99, s99, 14336
  s_lshl_b32 s100, s36, 11
  s_add_u32 s99, s99, s100
  s_add_u32 s99, s99, 0x2000000
  s_add_u32 s84, s12, s99
  s_addc_u32 s85, s13, 0
  s_mov_b32 s86, 3729408
  s_mov_b32 s87, 0x20000
  s_add_u32 s100, s98, 0
  s_and_b32 s100, s100, 7
  s_lshl_b32 s88, s100, 12
  s_add_u32 s100, s98, 1
  s_and_b32 s100, s100, 7
  s_lshl_b32 s89, s100, 12
  s_add_u32 s100, s98, 2
  s_and_b32 s100, s100, 7
  s_lshl_b32 s90, s100, 12
  s_add_u32 s100, s98, 3
  s_and_b32 s100, s100, 7
  s_lshl_b32 s91, s100, 12
  s_add_u32 s100, s98, 4
  s_and_b32 s100, s100, 7
  s_lshl_b32 s92, s100, 12
  s_add_u32 s100, s98, 5
  s_and_b32 s100, s100, 7
  s_lshl_b32 s93, s100, 12
  s_add_u32 s100, s98, 6
  s_and_b32 s100, s100, 7
  s_lshl_b32 s94, s100, 12
  s_add_u32 s100, s98, 7
  s_and_b32 s100, s100, 7
  s_lshl_b32 s95, s100, 12
  s_lshr_b32 s98, s44, 2
  s_and_b32 s99, s44, 3
  s_lshl_b32 s100, s45, 2
  s_add_u32 s100, s100, s99
  s_lshl_b32 s100, s100, 3
  s_add_u32 s100, s100, s98
  s_lshl_b32 s100, s100, 3
  s_add_u32 s100, s100, s36
  s_lshl_b32 s100, s100, 8
  s_add_u32 s100, s100, 0x3400000
  s_add_u32 s20, s12, s100
  s_addc_u32 s21, s13, 0
  s_mov_b32 s22, 256
  s_add_u32 s101, s98, s99
  s_add_u32 s101, s101, s36
  s_sub_u32 s101, s101, s66
  s_and_b32 s101, s101, 3
  s_mov_b32 s23, 0x20000
  s_mul_i32 s99, s99, 7
  s_add_u32 s99, s99, s36
  s_lshl_b32 s99, s99, 15
  s_lshl_b32 s100, s45, 10
  s_add_u32 s99, s99, s100
  s_lshl_b32 s100, s98, 7
  s_add_u32 s99, s99, s100
  s_add_u32 s24, s96, s99
  s_addc_u32 s25, s97, 0
  s_sub_u32 s26, 1835008, s99
  s_mov_b32 s27, 0x20000
  s_mul_i32 s100, s66, 14336
  s_sub_u32 s28, s84, s100
  s_subb_u32 s29, s85, 0
  s_mov_b32 s30, 3772416
  s_mov_b32 s31, 0x20000
  s_add_u32 s100, s66, 1
  s_and_b32 s100, s100, 3
  s_mul_i32 s6, s100, 14336
  s_add_u32 s100, s66, 2
  s_and_b32 s100, s100, 3
  s_mul_i32 s7, s100, 14336
  s_add_u32 s100, s66, 3
  s_and_b32 s100, s100, 3
  s_mul_i32 s8, s100, 14336
  s_lshl_b32 s10, 1, s66
  s_cmp_eq_u32 s101, 0
  s_cselect_b32 s9, 1, 2
  s_cmp_eq_u32 s101, 2
  s_cselect_b32 s11, 1, 2
  v_and_b32 v8, 1, v5
  v_lshrrev_b32 v9, 1, v5
  v_lshl_or_b32 v8, v9, 2, v8
  v_and_b32 v9, 1, v3
  v_lshl_or_b32 v8, v9, 3, v8
  v_xor_b32 v8, v8, v6
  v_lshlrev_b32 v8, 4, v8
  v_and_b32 v10, 1, v6
  v_lshl_or_b32 v8, v10, 3, v8
  v_cmp_eq_u32_e64 s[42:43], 1, v9
  v_lshl_add_u32 v10, v3, 3, v5
  v_lshl_add_u32 v10, v10, 8, v8
  v_add_u32 v10, 114688, v10
  v_xor_b32 v236, 0, v10
  v_xor_b32 v237, 8, v10
  v_xor_b32 v238, 64, v10
  v_xor_b32 v239, 72, v10
  v_xor_b32 v240, 128, v10
  v_xor_b32 v241, 136, v10
  v_xor_b32 v242, 192, v10
  v_xor_b32 v243, 200, v10
  v_lshl_add_u32 v10, v3, 2, v5
  v_lshl_add_u32 v254, v10, 8, v8
  v_lshrrev_b32 v9, 3, v4
  v_and_b32 v10, 7, v4
  v_lshlrev_b32 v11, 2, v9
  v_xor_b32 v10, v10, v11
  v_lshl_or_b32 v10, v10, 1, v9
  v_xor_b32 v10, v10, v3
  v_lshlrev_b32 v10, 4, v10
  v_lshl_add_u32 v10, v4, 8, v10
  v_xor_b32 v232, 0, v10
  v_add_u32 v224, s51, v232
  v_xor_b32 v233, 64, v10
  v_add_u32 v225, s51, v233
  v_xor_b32 v234, 128, v10
  v_add_u32 v226, s51, v234
  v_xor_b32 v235, 192, v10
  v_add_u32 v227, s51, v235
  s_lshl_b32 s50, s36, 17
  v_add_u32 v255, s50, v248
  v_mov_b32 v228, 0x3f803f80
  v_mov_b32 v229, 0x3f803f80
  v_mov_b32 v230, 0x3f803f80
  v_mov_b32 v231, 0x3f803f80
  s_waitcnt vmcnt(0)
  ds_read_b128 v[0:3], v224 offset:0
  ds_read_b128 v[4:7], v224 offset:4096
  ds_read_b128 v[8:11], v225 offset:0
  ds_read_b128 v[12:15], v225 offset:4096
  ds_read_b128 v[16:19], v226 offset:0
  ds_read_b128 v[20:23], v226 offset:4096
  ds_read_b128 v[24:27], v227 offset:0
  ds_read_b128 v[28:31], v227 offset:4096
  s_waitcnt lgkmcnt(0)
  s_add_u32 s63, s62, 1
  s_and_b32 s63, s63, 3
  s_lshl_b32 s63, s63, 8
  s_add_u32 m0, s51, 0
  s_add_u32 s38, s63, 0
  buffer_load_dwordx4 v244, s[16:19], s38 offen lds
  s_add_u32 m0, s51, 1024
  s_add_u32 s38, s63, 4096
  buffer_load_dwordx4 v245, s[16:19], s38 offen lds
  s_add_u32 m0, s51, 2048
  s_add_u32 s38, s63, 8192
  buffer_load_dwordx4 v246, s[16:19], s38 offen lds
  s_add_u32 m0, s51, 3072
  s_add_u32 s38, s63, 12288
  buffer_load_dwordx4 v247, s[16:19], s38 offen lds
  s_add_u32 m0, s51, 4096
  s_add_u32 s38, s63, 458752
  buffer_load_dwordx4 v244, s[16:19], s38 offen lds
  s_add_u32 m0, s51, 5120
  s_add_u32 s38, s63, 462848
  buffer_load_dwordx4 v245, s[16:19], s38 offen lds
  s_add_u32 m0, s51, 6144
  s_add_u32 s38, s63, 466944
  buffer_load_dwordx4 v246, s[16:19], s38 offen lds
  s_add_u32 m0, s51, 7168
  s_add_u32 s38, s63, 471040
  buffer_load_dwordx4 v247, s[16:19], s38 offen lds
  s_barrier
  ds_read_b64_tr_b16 v[192:193], v236 offset:0
  ds_read_b64_tr_b16 v[194:195], v236 offset:1024
  ds_read_b64_tr_b16 v[196:197], v237 offset:0
  ds_read_b64_tr_b16 v[198:199], v237 offset:1024
  ds_read_b64_tr_b16 v[200:201], v238 offset:0
  ds_read_b64_tr_b16 v[202:203], v238 offset:1024
  ds_read_b64_tr_b16 v[204:205], v239 offset:0
  ds_read_b64_tr_b16 v[206:207], v239 offset:1024
  ds_read_b64_tr_b16 v[208:209], v240 offset:0
  ds_read_b64_tr_b16 v[210:211], v240 offset:1024
  ds_read_b64_tr_b16 v[212:213], v241 offset:0
  ds_read_b64_tr_b16 v[214:215], v241 offset:1024
  s_waitcnt lgkmcnt(10)
  v_mfma_f32_16x16x32_bf16 v[128:131], v[192:195], v[0:3], 0
  v_mfma_f32_16x16x32_bf16 v[160:163], v[192:195], v[4:7], 0
  ds_read_b64_tr_b16 v[216:217], v242 offset:0
  ds_read_b64_tr_b16 v[218:219], v242 offset:1024
  s_waitcnt lgkmcnt(10)
  v_mfma_f32_16x16x32_bf16 v[132:135], v[196:199], v[0:3], 0
  v_mfma_f32_16x16x32_bf16 v[164:167], v[196:199], v[4:7], 0
  ds_read_b64_tr_b16 v[220:221], v243 offset:0
  ds_read_b64_tr_b16 v[222:223], v243 offset:1024
  s_waitcnt lgkmcnt(10)
  v_mfma_f32_16x16x32_bf16 v[136:139], v[200:203], v[0:3], 0
  v_mfma_f32_16x16x32_bf16 v[168:171], v[200:203], v[4:7], 0
  ds_read_b64_tr_b16 v[192:193], v236 offset:8192
  ds_read_b64_tr_b16 v[194:195], v236 offset:9216
  s_waitcnt lgkmcnt(10)
  v_mfma_f32_16x16x32_bf16 v[140:143], v[204:207], v[0:3], 0
  v_mfma_f32_16x16x32_bf16 v[172:175], v[204:207], v[4:7], 0
  ds_read_b64_tr_b16 v[196:197], v237 offset:8192
  ds_read_b64_tr_b16 v[198:199], v237 offset:9216
  s_waitcnt lgkmcnt(10)
  v_mfma_f32_16x16x32_bf16 v[144:147], v[208:211], v[0:3], 0
  v_mfma_f32_16x16x32_bf16 v[176:179], v[208:211], v[4:7], 0
  ds_read_b64_tr_b16 v[200:201], v238 offset:8192
  ds_read_b64_tr_b16 v[202:203], v238 offset:9216
  s_waitcnt lgkmcnt(10)
  v_mfma_f32_16x16x32_bf16 v[148:151], v[212:215], v[0:3], 0
  v_mfma_f32_16x16x32_bf16 v[180:183], v[212:215], v[4:7], 0
  ds_read_b64_tr_b16 v[204:205], v239 offset:8192
  ds_read_b64_tr_b16 v[206:207], v239 offset:9216
  s_waitcnt lgkmcnt(10)
  v_mfma_f32_16x16x32_bf16 v[152:155], v[216:219], v[0:3], 0
  v_mfma_f32_16x16x32_bf16 v[184:187], v[216:219], v[4:7], 0
  ds_read_b64_tr_b16 v[208:209], v240 offset:8192
  ds_read_b64_tr_b16 v[210:211], v240 offset:9216
  s_waitcnt lgkmcnt(10)
  v_mfma_f32_16x16x32_bf16 v[156:159], v[220:223], v[0:3], 0
  v_mfma_f32_16x16x32_bf16 v[188:191], v[220:223], v[4:7], 0
  ds_read_b64_tr_b16 v[212:213], v241 offset:8192
  ds_read_b64_tr_b16 v[214:215], v241 offset:9216
  s_waitcnt lgkmcnt(10)
  v_mfma_f32_16x16x32_bf16 v[128:131], v[192:195], v[8:11], v[128:131]
  v_mfma_f32_16x16x32_bf16 v[160:163], v[192:195], v[12:15], v[160:163]
  ds_read_b64_tr_b16 v[216:217], v242 offset:8192
  ds_read_b64_tr_b16 v[218:219], v242 offset:9216
  s_waitcnt lgkmcnt(10)
  v_mfma_f32_16x16x32_bf16 v[132:135], v[196:199], v[8:11], v[132:135]
  v_mfma_f32_16x16x32_bf16 v[164:167], v[196:199], v[12:15], v[164:167]
  ds_read_b64_tr_b16 v[220:221], v243 offset:8192
  ds_read_b64_tr_b16 v[222:223], v243 offset:9216
  s_waitcnt lgkmcnt(10)
  v_mfma_f32_16x16x32_bf16 v[136:139], v[200:203], v[8:11], v[136:139]
  v_mfma_f32_16x16x32_bf16 v[168:171], v[200:203], v[12:15], v[168:171]
  s_waitcnt lgkmcnt(8)
  v_mfma_f32_16x16x32_bf16 v[140:143], v[204:207], v[8:11], v[140:143]
  v_mfma_f32_16x16x32_bf16 v[172:175], v[204:207], v[12:15], v[172:175]
  s_waitcnt lgkmcnt(6)
  v_mfma_f32_16x16x32_bf16 v[144:147], v[208:211], v[8:11], v[144:147]
  v_mfma_f32_16x16x32_bf16 v[176:179], v[208:211], v[12:15], v[176:179]
  s_waitcnt lgkmcnt(4)
  v_mfma_f32_16x16x32_bf16 v[148:151], v[212:215], v[8:11], v[148:151]
  v_mfma_f32_16x16x32_bf16 v[180:183], v[212:215], v[12:15], v[180:183]
  s_waitcnt lgkmcnt(2)
  v_mfma_f32_16x16x32_bf16 v[152:155], v[216:219], v[8:11], v[152:155]
  v_mfma_f32_16x16x32_bf16 v[184:187], v[216:219], v[12:15], v[184:187]
  s_waitcnt lgkmcnt(0)
  v_mfma_f32_16x16x32_bf16 v[156:159], v[220:223], v[8:11], v[156:159]
  v_mfma_f32_16x16x32_bf16 v[188:191], v[220:223], v[12:15], v[188:191]
  s_barrier
  s_waitcnt vmcnt(0)
  ds_read_b128 v[32:35], v224 offset:0
  ds_read_b128 v[36:39], v224 offset:4096
  ds_read_b128 v[40:43], v225 offset:0
  ds_read_b128 v[44:47], v225 offset:4096
  ds_read_b128 v[48:51], v226 offset:0
  ds_read_b128 v[52:55], v226 offset:4096
  ds_read_b128 v[56:59], v227 offset:0
  ds_read_b128 v[60:63], v227 offset:4096
  s_waitcnt lgkmcnt(0)
  s_add_u32 s63, s62, 2
  s_and_b32 s63, s63, 3
  s_lshl_b32 s63, s63, 8
  s_add_u32 m0, s51, 0
  s_add_u32 s38, s63, 0
  buffer_load_dwordx4 v244, s[16:19], s38 offen lds
  s_add_u32 m0, s51, 1024
  s_add_u32 s38, s63, 4096
  buffer_load_dwordx4 v245, s[16:19], s38 offen lds
  s_add_u32 m0, s51, 2048
  s_add_u32 s38, s63, 8192
  buffer_load_dwordx4 v246, s[16:19], s38 offen lds
  s_add_u32 m0, s51, 3072
  s_add_u32 s38, s63, 12288
  buffer_load_dwordx4 v247, s[16:19], s38 offen lds
  s_add_u32 m0, s51, 4096
  s_add_u32 s38, s63, 458752
  buffer_load_dwordx4 v244, s[16:19], s38 offen lds
  s_add_u32 m0, s51, 5120
  s_add_u32 s38, s63, 462848
  buffer_load_dwordx4 v245, s[16:19], s38 offen lds
  s_add_u32 m0, s51, 6144
  s_add_u32 s38, s63, 466944
  buffer_load_dwordx4 v246, s[16:19], s38 offen lds
  s_add_u32 m0, s51, 7168
  s_add_u32 s38, s63, 471040
  buffer_load_dwordx4 v247, s[16:19], s38 offen lds
  ds_read_b64_tr_b16 v[192:193], v236 offset:16384
  ds_read_b64_tr_b16 v[194:195], v236 offset:17408
  ds_read_b64_tr_b16 v[196:197], v237 offset:16384
  ds_read_b64_tr_b16 v[198:199], v237 offset:17408
  ds_read_b64_tr_b16 v[200:201], v238 offset:16384
  ds_read_b64_tr_b16 v[202:203], v238 offset:17408
  ds_read_b64_tr_b16 v[204:205], v239 offset:16384
  ds_read_b64_tr_b16 v[206:207], v239 offset:17408
  ds_read_b64_tr_b16 v[208:209], v240 offset:16384
  ds_read_b64_tr_b16 v[210:211], v240 offset:17408
  ds_read_b64_tr_b16 v[212:213], v241 offset:16384
  ds_read_b64_tr_b16 v[214:215], v241 offset:17408
  s_waitcnt lgkmcnt(10)
  v_mfma_f32_16x16x32_bf16 v[128:131], v[192:195], v[16:19], v[128:131]
  v_mfma_f32_16x16x32_bf16 v[160:163], v[192:195], v[20:23], v[160:163]
  ds_read_b64_tr_b16 v[216:217], v242 offset:16384
  ds_read_b64_tr_b16 v[218:219], v242 offset:17408
  s_waitcnt lgkmcnt(10)
  v_mfma_f32_16x16x32_bf16 v[132:135], v[196:199], v[16:19], v[132:135]
  v_mfma_f32_16x16x32_bf16 v[164:167], v[196:199], v[20:23], v[164:167]
  ds_read_b64_tr_b16 v[220:221], v243 offset:16384
  ds_read_b64_tr_b16 v[222:223], v243 offset:17408
  s_waitcnt lgkmcnt(10)
  v_mfma_f32_16x16x32_bf16 v[136:139], v[200:203], v[16:19], v[136:139]
  v_mfma_f32_16x16x32_bf16 v[168:171], v[200:203], v[20:23], v[168:171]
  ds_read_b64_tr_b16 v[192:193], v236 offset:24576
  ds_read_b64_tr_b16 v[194:195], v236 offset:25600
  s_waitcnt lgkmcnt(10)
  v_mfma_f32_16x16x32_bf16 v[140:143], v[204:207], v[16:19], v[140:143]
  v_mfma_f32_16x16x32_bf16 v[172:175], v[204:207], v[20:23], v[172:175]
  ds_read_b64_tr_b16 v[196:197], v237 offset:24576
  ds_read_b64_tr_b16 v[198:199], v237 offset:25600
  s_waitcnt lgkmcnt(10)
  v_mfma_f32_16x16x32_bf16 v[144:147], v[208:211], v[16:19], v[144:147]
  v_mfma_f32_16x16x32_bf16 v[176:179], v[208:211], v[20:23], v[176:179]
  ds_read_b64_tr_b16 v[200:201], v238 offset:24576
  ds_read_b64_tr_b16 v[202:203], v238 offset:25600
  s_waitcnt lgkmcnt(10)
  v_mfma_f32_16x16x32_bf16 v[148:151], v[212:215], v[16:19], v[148:151]
  v_mfma_f32_16x16x32_bf16 v[180:183], v[212:215], v[20:23], v[180:183]
  ds_read_b64_tr_b16 v[204:205], v239 offset:24576
  ds_read_b64_tr_b16 v[206:207], v239 offset:25600
  s_waitcnt lgkmcnt(10)
  v_mfma_f32_16x16x32_bf16 v[152:155], v[216:219], v[16:19], v[152:155]
  v_mfma_f32_16x16x32_bf16 v[184:187], v[216:219], v[20:23], v[184:187]
  ds_read_b64_tr_b16 v[208:209], v240 offset:24576
  ds_read_b64_tr_b16 v[210:211], v240 offset:25600
  s_waitcnt lgkmcnt(10)
  v_mfma_f32_16x16x32_bf16 v[156:159], v[220:223], v[16:19], v[156:159]
  v_mfma_f32_16x16x32_bf16 v[188:191], v[220:223], v[20:23], v[188:191]
  ds_read_b64_tr_b16 v[212:213], v241 offset:24576
  ds_read_b64_tr_b16 v[214:215], v241 offset:25600
  s_waitcnt lgkmcnt(10)
  v_mfma_f32_16x16x32_bf16 v[128:131], v[192:195], v[24:27], v[128:131]
  v_mfma_f32_16x16x32_bf16 v[160:163], v[192:195], v[28:31], v[160:163]
  ds_read_b64_tr_b16 v[216:217], v242 offset:24576
  ds_read_b64_tr_b16 v[218:219], v242 offset:25600
  s_waitcnt lgkmcnt(10)
  v_mfma_f32_16x16x32_bf16 v[132:135], v[196:199], v[24:27], v[132:135]
  v_mfma_f32_16x16x32_bf16 v[164:167], v[196:199], v[28:31], v[164:167]
  ds_read_b64_tr_b16 v[220:221], v243 offset:24576
  ds_read_b64_tr_b16 v[222:223], v243 offset:25600
  s_waitcnt lgkmcnt(10)
  v_mfma_f32_16x16x32_bf16 v[136:139], v[200:203], v[24:27], v[136:139]
  v_mfma_f32_16x16x32_bf16 v[168:171], v[200:203], v[28:31], v[168:171]
  s_waitcnt lgkmcnt(8)
  v_mfma_f32_16x16x32_bf16 v[140:143], v[204:207], v[24:27], v[140:143]
  v_mfma_f32_16x16x32_bf16 v[172:175], v[204:207], v[28:31], v[172:175]
  s_waitcnt lgkmcnt(6)
  v_mfma_f32_16x16x32_bf16 v[144:147], v[208:211], v[24:27], v[144:147]
  v_mfma_f32_16x16x32_bf16 v[176:179], v[208:211], v[28:31], v[176:179]
  s_waitcnt lgkmcnt(4)
  v_mfma_f32_16x16x32_bf16 v[148:151], v[212:215], v[24:27], v[148:151]
  v_mfma_f32_16x16x32_bf16 v[180:183], v[212:215], v[28:31], v[180:183]
  s_waitcnt lgkmcnt(2)
  v_mfma_f32_16x16x32_bf16 v[152:155], v[216:219], v[24:27], v[152:155]
  v_mfma_f32_16x16x32_bf16 v[184:187], v[216:219], v[28:31], v[184:187]
  s_waitcnt lgkmcnt(0)
  v_mfma_f32_16x16x32_bf16 v[156:159], v[220:223], v[24:27], v[156:159]
  v_mfma_f32_16x16x32_bf16 v[188:191], v[220:223], v[28:31], v[188:191]
  s_barrier
  s_waitcnt vmcnt(0)
  ds_read_b128 v[64:67], v224 offset:0
  ds_read_b128 v[68:71], v224 offset:4096
  ds_read_b128 v[72:75], v225 offset:0
  ds_read_b128 v[76:79], v225 offset:4096
  ds_read_b128 v[80:83], v226 offset:0
  ds_read_b128 v[84:87], v226 offset:4096
  ds_read_b128 v[88:91], v227 offset:0
  ds_read_b128 v[92:95], v227 offset:4096
  s_waitcnt lgkmcnt(0)
  s_add_u32 s63, s62, 3
  s_and_b32 s63, s63, 3
  s_lshl_b32 s63, s63, 8
  s_add_u32 m0, s51, 0
  s_add_u32 s38, s63, 0
  buffer_load_dwordx4 v244, s[16:19], s38 offen lds
  s_add_u32 m0, s51, 1024
  s_add_u32 s38, s63, 4096
  buffer_load_dwordx4 v245, s[16:19], s38 offen lds
  s_add_u32 m0, s51, 2048
  s_add_u32 s38, s63, 8192
  buffer_load_dwordx4 v246, s[16:19], s38 offen lds
  s_add_u32 m0, s51, 3072
  s_add_u32 s38, s63, 12288
  buffer_load_dwordx4 v247, s[16:19], s38 offen lds
  s_add_u32 m0, s51, 4096
  s_add_u32 s38, s63, 458752
  buffer_load_dwordx4 v244, s[16:19], s38 offen lds
  s_add_u32 m0, s51, 5120
  s_add_u32 s38, s63, 462848
  buffer_load_dwordx4 v245, s[16:19], s38 offen lds
  s_add_u32 m0, s51, 6144
  s_add_u32 s38, s63, 466944
  buffer_load_dwordx4 v246, s[16:19], s38 offen lds
  s_add_u32 m0, s51, 7168
  s_add_u32 s38, s63, 471040
  buffer_load_dwordx4 v247, s[16:19], s38 offen lds
  ds_read_b64_tr_b16 v[192:193], v236 offset:32768
  ds_read_b64_tr_b16 v[194:195], v236 offset:33792
  ds_read_b64_tr_b16 v[196:197], v237 offset:32768
  ds_read_b64_tr_b16 v[198:199], v237 offset:33792
  ds_read_b64_tr_b16 v[200:201], v238 offset:32768
  ds_read_b64_tr_b16 v[202:203], v238 offset:33792
  ds_read_b64_tr_b16 v[204:205], v239 offset:32768
  ds_read_b64_tr_b16 v[206:207], v239 offset:33792
  ds_read_b64_tr_b16 v[208:209], v240 offset:32768
  ds_read_b64_tr_b16 v[210:211], v240 offset:33792
  ds_read_b64_tr_b16 v[212:213], v241 offset:32768
  ds_read_b64_tr_b16 v[214:215], v241 offset:33792
  s_waitcnt lgkmcnt(10)
  v_mfma_f32_16x16x32_bf16 v[128:131], v[192:195], v[32:35], v[128:131]
  v_mfma_f32_16x16x32_bf16 v[160:163], v[192:195], v[36:39], v[160:163]
  ds_read_b64_tr_b16 v[216:217], v242 offset:32768
  ds_read_b64_tr_b16 v[218:219], v242 offset:33792
  s_waitcnt lgkmcnt(10)
  v_mfma_f32_16x16x32_bf16 v[132:135], v[196:199], v[32:35], v[132:135]
  v_mfma_f32_16x16x32_bf16 v[164:167], v[196:199], v[36:39], v[164:167]
  ds_read_b64_tr_b16 v[220:221], v243 offset:32768
  ds_read_b64_tr_b16 v[222:223], v243 offset:33792
  s_waitcnt lgkmcnt(10)
  v_mfma_f32_16x16x32_bf16 v[136:139], v[200:203], v[32:35], v[136:139]
  v_mfma_f32_16x16x32_bf16 v[168:171], v[200:203], v[36:39], v[168:171]
  ds_read_b64_tr_b16 v[192:193], v236 offset:40960
  ds_read_b64_tr_b16 v[194:195], v236 offset:41984
  s_waitcnt lgkmcnt(10)
  v_mfma_f32_16x16x32_bf16 v[140:143], v[204:207], v[32:35], v[140:143]
  v_mfma_f32_16x16x32_bf16 v[172:175], v[204:207], v[36:39], v[172:175]
  ds_read_b64_tr_b16 v[196:197], v237 offset:40960
  ds_read_b64_tr_b16 v[198:199], v237 offset:41984
  s_waitcnt lgkmcnt(10)
  v_mfma_f32_16x16x32_bf16 v[144:147], v[208:211], v[32:35], v[144:147]
  v_mfma_f32_16x16x32_bf16 v[176:179], v[208:211], v[36:39], v[176:179]
  ds_read_b64_tr_b16 v[200:201], v238 offset:40960
  ds_read_b64_tr_b16 v[202:203], v238 offset:41984
  s_waitcnt lgkmcnt(10)
  v_mfma_f32_16x16x32_bf16 v[148:151], v[212:215], v[32:35], v[148:151]
  v_mfma_f32_16x16x32_bf16 v[180:183], v[212:215], v[36:39], v[180:183]
  ds_read_b64_tr_b16 v[204:205], v239 offset:40960
  ds_read_b64_tr_b16 v[206:207], v239 offset:41984
  s_waitcnt lgkmcnt(10)
  v_mfma_f32_16x16x32_bf16 v[152:155], v[216:219], v[32:35], v[152:155]
  v_mfma_f32_16x16x32_bf16 v[184:187], v[216:219], v[36:39], v[184:187]
  ds_read_b64_tr_b16 v[208:209], v240 offset:40960
  ds_read_b64_tr_b16 v[210:211], v240 offset:41984
  s_waitcnt lgkmcnt(10)
  v_mfma_f32_16x16x32_bf16 v[156:159], v[220:223], v[32:35], v[156:159]
  v_mfma_f32_16x16x32_bf16 v[188:191], v[220:223], v[36:39], v[188:191]
  ds_read_b64_tr_b16 v[212:213], v241 offset:40960
  ds_read_b64_tr_b16 v[214:215], v241 offset:41984
  s_waitcnt lgkmcnt(10)
  v_mfma_f32_16x16x32_bf16 v[128:131], v[192:195], v[40:43], v[128:131]
  v_mfma_f32_16x16x32_bf16 v[160:163], v[192:195], v[44:47], v[160:163]
  ds_read_b64_tr_b16 v[216:217], v242 offset:40960
  ds_read_b64_tr_b16 v[218:219], v242 offset:41984
  s_waitcnt lgkmcnt(10)
  v_mfma_f32_16x16x32_bf16 v[132:135], v[196:199], v[40:43], v[132:135]
  v_mfma_f32_16x16x32_bf16 v[164:167], v[196:199], v[44:47], v[164:167]
  ds_read_b64_tr_b16 v[220:221], v243 offset:40960
  ds_read_b64_tr_b16 v[222:223], v243 offset:41984
  s_waitcnt lgkmcnt(10)
  v_mfma_f32_16x16x32_bf16 v[136:139], v[200:203], v[40:43], v[136:139]
  v_mfma_f32_16x16x32_bf16 v[168:171], v[200:203], v[44:47], v[168:171]
  s_waitcnt lgkmcnt(8)
  v_mfma_f32_16x16x32_bf16 v[140:143], v[204:207], v[40:43], v[140:143]
  v_mfma_f32_16x16x32_bf16 v[172:175], v[204:207], v[44:47], v[172:175]
  s_waitcnt lgkmcnt(6)
  v_mfma_f32_16x16x32_bf16 v[144:147], v[208:211], v[40:43], v[144:147]
  v_mfma_f32_16x16x32_bf16 v[176:179], v[208:211], v[44:47], v[176:179]
  s_waitcnt lgkmcnt(4)
  v_mfma_f32_16x16x32_bf16 v[148:151], v[212:215], v[40:43], v[148:151]
  v_mfma_f32_16x16x32_bf16 v[180:183], v[212:215], v[44:47], v[180:183]
  s_waitcnt lgkmcnt(2)
  v_mfma_f32_16x16x32_bf16 v[152:155], v[216:219], v[40:43], v[152:155]
  v_mfma_f32_16x16x32_bf16 v[184:187], v[216:219], v[44:47], v[184:187]
  s_waitcnt lgkmcnt(0)
  v_mfma_f32_16x16x32_bf16 v[156:159], v[220:223], v[40:43], v[156:159]
  v_mfma_f32_16x16x32_bf16 v[188:191], v[220:223], v[44:47], v[188:191]
  s_barrier
  s_waitcnt vmcnt(0)
  ds_read_b128 v[96:99], v224 offset:0
  ds_read_b128 v[100:103], v224 offset:4096
  ds_read_b128 v[104:107], v225 offset:0
  ds_read_b128 v[108:111], v225 offset:4096
  ds_read_b128 v[112:115], v226 offset:0
  ds_read_b128 v[116:119], v226 offset:4096
  ds_read_b128 v[120:123], v227 offset:0
  ds_read_b128 v[124:127], v227 offset:4096
  s_waitcnt lgkmcnt(0)
  s_cmp_lg_u32 s36, 3
  s_cbranch_scc1 L_x1
  s_memrealtime s[64:65]
  s_waitcnt lgkmcnt(0)
  s_lshl_b64 s[64:65], s[64:65], 4
  v_mov_b32 v244, s64
  v_mov_b32 v245, s65
  v_mov_b32 v246, 0
  v_mov_b32 v247, 0
  s_mov_b64 exec, 1
  buffer_atomic_cmpswap_x2 v[244:247], off, s[72:75], 0 sc0 sc1
  s_mov_b64 exec, -1
L_x1:
  ds_read_b64_tr_b16 v[192:193], v236 offset:0
  ds_read_b64_tr_b16 v[194:195], v236 offset:1024
  ds_read_b64_tr_b16 v[196:197], v237 offset:0
  ds_read_b64_tr_b16 v[198:199], v237 offset:1024
  ds_read_b64_tr_b16 v[200:201], v238 offset:0
  ds_read_b64_tr_b16 v[202:203], v238 offset:1024
  ds_read_b64_tr_b16 v[204:205], v239 offset:0
  ds_read_b64_tr_b16 v[206:207], v239 offset:1024
  ds_read_b64_tr_b16 v[208:209], v240 offset:0
  ds_read_b64_tr_b16 v[210:211], v240 offset:1024
  ds_read_b64_tr_b16 v[212:213], v241 offset:0
  ds_read_b64_tr_b16 v[214:215], v241 offset:1024
  s_waitcnt lgkmcnt(10)
  v_mfma_f32_16x16x32_bf16 v[128:131], v[192:195], v[48:51], v[128:131]
  v_mfma_f32_16x16x32_bf16 v[160:163], v[192:195], v[52:55], v[160:163]
  ds_read_b64_tr_b16 v[216:217], v242 offset:0
  ds_read_b64_tr_b16 v[218:219], v242 offset:1024
  s_waitcnt lgkmcnt(10)
  v_mfma_f32_16x16x32_bf16 v[132:135], v[196:199], v[48:51], v[132:135]
  v_mfma_f32_16x16x32_bf16 v[164:167], v[196:199], v[52:55], v[164:167]
  ds_read_b64_tr_b16 v[220:221], v243 offset:0
  ds_read_b64_tr_b16 v[222:223], v243 offset:1024
  s_waitcnt lgkmcnt(10)
  v_mfma_f32_16x16x32_bf16 v[136:139], v[200:203], v[48:51], v[136:139]
  v_mfma_f32_16x16x32_bf16 v[168:171], v[200:203], v[52:55], v[168:171]
  ds_read_b64_tr_b16 v[192:193], v236 offset:8192
  ds_read_b64_tr_b16 v[194:195], v236 offset:9216
  s_waitcnt lgkmcnt(10)
  v_mfma_f32_16x16x32_bf16 v[140:143], v[204:207], v[48:51], v[140:143]
  v_mfma_f32_16x16x32_bf16 v[172:175], v[204:207], v[52:55], v[172:175]
  ds_read_b64_tr_b16 v[196:197], v237 offset:8192
  ds_read_b64_tr_b16 v[198:199], v237 offset:9216
  s_waitcnt lgkmcnt(10)
  v_mfma_f32_16x16x32_bf16 v[144:147], v[208:211], v[48:51], v[144:147]
  v_mfma_f32_16x16x32_bf16 v[176:179], v[208:211], v[52:55], v[176:179]
  ds_read_b64_tr_b16 v[200:201], v238 offset:8192
  ds_read_b64_tr_b16 v[202:203], v238 offset:9216
  s_waitcnt lgkmcnt(10)
  v_mfma_f32_16x16x32_bf16 v[148:151], v[212:215], v[48:51], v[148:151]
  v_mfma_f32_16x16x32_bf16 v[180:183], v[212:215], v[52:55], v[180:183]
  ds_read_b64_tr_b16 v[204:205], v239 offset:8192
  ds_read_b64_tr_b16 v[206:207], v239 offset:9216
  s_waitcnt lgkmcnt(10)
  v_mfma_f32_16x16x32_bf16 v[152:155], v[216:219], v[48:51], v[152:155]
  v_mfma_f32_16x16x32_bf16 v[184:187], v[216:219], v[52:55], v[184:187]
  ds_read_b64_tr_b16 v[208:209], v240 offset:8192
  ds_read_b64_tr_b16 v[210:211], v240 offset:9216
  s_waitcnt lgkmcnt(10)
  v_mfma_f32_16x16x32_bf16 v[156:159], v[220:223], v[48:51], v[156:159]
  v_mfma_f32_16x16x32_bf16 v[188:191], v[220:223], v[52:55], v[188:191]
  ds_read_b64_tr_b16 v[212:213], v241 offset:8192
  ds_read_b64_tr_b16 v[214:215], v241 offset:9216
  s_waitcnt lgkmcnt(10)
  v_mfma_f32_16x16x32_bf16 v[128:131], v[192:195], v[56:59], v[128:131]
  v_mfma_f32_16x16x32_bf16 v[160:163], v[192:195], v[60:63], v[160:163]
  ds_read_b64_tr_b16 v[216:217], v242 offset:8192
  ds_read_b64_tr_b16 v[218:219], v242 offset:9216
  s_waitcnt lgkmcnt(10)
  v_mfma_f32_16x16x32_bf16 v[132:135], v[196:199], v[56:59], v[132:135]
  v_mfma_f32_16x16x32_bf16 v[164:167], v[196:199], v[60:63], v[164:167]
  ds_read_b64_tr_b16 v[220:221], v243 offset:8192
  ds_read_b64_tr_b16 v[222:223], v243 offset:9216
  s_waitcnt lgkmcnt(10)
  v_mfma_f32_16x16x32_bf16 v[136:139], v[200:203], v[56:59], v[136:139]
  v_mfma_f32_16x16x32_bf16 v[168:171], v[200:203], v[60:63], v[168:171]
  s_waitcnt lgkmcnt(8)
  v_mfma_f32_16x16x32_bf16 v[140:143], v[204:207], v[56:59], v[140:143]
  v_mfma_f32_16x16x32_bf16 v[172:175], v[204:207], v[60:63], v[172:175]
  s_waitcnt lgkmcnt(6)
  v_mfma_f32_16x16x32_bf16 v[144:147], v[208:211], v[56:59], v[144:147]
  v_mfma_f32_16x16x32_bf16 v[176:179], v[208:211], v[60:63], v[176:179]
  s_waitcnt lgkmcnt(4)
  v_mfma_f32_16x16x32_bf16 v[148:151], v[212:215], v[56:59], v[148:151]
  v_mfma_f32_16x16x32_bf16 v[180:183], v[212:215], v[60:63], v[180:183]
  s_waitcnt lgkmcnt(2)
  v_mfma_f32_16x16x32_bf16 v[152:155], v[216:219], v[56:59], v[152:155]
  v_mfma_f32_16x16x32_bf16 v[184:187], v[216:219], v[60:63], v[184:187]
  s_waitcnt lgkmcnt(0)
  v_mfma_f32_16x16x32_bf16 v[156:159], v[220:223], v[56:59], v[156:159]
  v_mfma_f32_16x16x32_bf16 v[188:191], v[220:223], v[60:63], v[188:191]
  s_barrier
  ds_read_b64_tr_b16 v[192:193], v236 offset:16384
  ds_read_b64_tr_b16 v[194:195], v236 offset:17408
  ds_read_b64_tr_b16 v[196:197], v237 offset:16384
  ds_read_b64_tr_b16 v[198:199], v237 offset:17408
  ds_read_b64_tr_b16 v[200:201], v238 offset:16384
  ds_read_b64_tr_b16 v[202:203], v238 offset:17408
  ds_read_b64_tr_b16 v[204:205], v239 offset:16384
  ds_read_b64_tr_b16 v[206:207], v239 offset:17408
  ds_read_b64_tr_b16 v[208:209], v240 offset:16384
  ds_read_b64_tr_b16 v[210:211], v240 offset:17408
  ds_read_b64_tr_b16 v[212:213], v241 offset:16384
  ds_read_b64_tr_b16 v[214:215], v241 offset:17408
  s_waitcnt lgkmcnt(10)
  v_mfma_f32_16x16x32_bf16 v[128:131], v[192:195], v[64:67], v[128:131]
  v_mfma_f32_16x16x32_bf16 v[160:163], v[192:195], v[68:71], v[160:163]
  ds_read_b64_tr_b16 v[216:217], v242 offset:16384
  ds_read_b64_tr_b16 v[218:219], v242 offset:17408
  s_waitcnt lgkmcnt(10)
  v_mfma_f32_16x16x32_bf16 v[132:135], v[196:199], v[64:67], v[132:135]
  v_mfma_f32_16x16x32_bf16 v[164:167], v[196:199], v[68:71], v[164:167]
  ds_read_b64_tr_b16 v[220:221], v243 offset:16384
  ds_read_b64_tr_b16 v[222:223], v243 offset:17408
  s_waitcnt lgkmcnt(10)
  v_mfma_f32_16x16x32_bf16 v[136:139], v[200:203], v[64:67], v[136:139]
  v_mfma_f32_16x16x32_bf16 v[168:171], v[200:203], v[68:71], v[168:171]
  ds_read_b64_tr_b16 v[192:193], v236 offset:24576
  ds_read_b64_tr_b16 v[194:195], v236 offset:25600
  s_waitcnt lgkmcnt(10)
  v_mfma_f32_16x16x32_bf16 v[140:143], v[204:207], v[64:67], v[140:143]
  v_mfma_f32_16x16x32_bf16 v[172:175], v[204:207], v[68:71], v[172:175]
  ds_read_b64_tr_b16 v[196:197], v237 offset:24576
  ds_read_b64_tr_b16 v[198:199], v237 offset:25600
  s_waitcnt lgkmcnt(10)
  v_mfma_f32_16x16x32_bf16 v[144:147], v[208:211], v[64:67], v[144:147]
  v_mfma_f32_16x16x32_bf16 v[176:179], v[208:211], v[68:71], v[176:179]
  ds_read_b64_tr_b16 v[200:201], v238 offset:24576
  ds_read_b64_tr_b16 v[202:203], v238 offset:25600
  s_waitcnt lgkmcnt(10)
  v_mfma_f32_16x16x32_bf16 v[148:151], v[212:215], v[64:67], v[148:151]
  v_mfma_f32_16x16x32_bf16 v[180:183], v[212:215], v[68:71], v[180:183]
  ds_read_b64_tr_b16 v[204:205], v239 offset:24576
  ds_read_b64_tr_b16 v[206:207], v239 offset:25600
  s_waitcnt lgkmcnt(10)
  v_mfma_f32_16x16x32_bf16 v[152:155], v[216:219], v[64:67], v[152:155]
  v_mfma_f32_16x16x32_bf16 v[184:187], v[216:219], v[68:71], v[184:187]
  ds_read_b64_tr_b16 v[208:209], v240 offset:24576
  ds_read_b64_tr_b16 v[210:211], v240 offset:25600
  s_waitcnt lgkmcnt(10)
  v_mfma_f32_16x16x32_bf16 v[156:159], v[220:223], v[64:67], v[156:159]
  v_mfma_f32_16x16x32_bf16 v[188:191], v[220:223], v[68:71], v[188:191]
  ds_read_b64_tr_b16 v[212:213], v241 offset:24576
  ds_read_b64_tr_b16 v[214:215], v241 offset:25600
  s_waitcnt lgkmcnt(10)
  v_mfma_f32_16x16x32_bf16 v[128:131], v[192:195], v[72:75], v[128:131]
  v_mfma_f32_16x16x32_bf16 v[160:163], v[192:195], v[76:79], v[160:163]
  ds_read_b64_tr_b16 v[216:217], v242 offset:24576
  ds_read_b64_tr_b16 v[218:219], v242 offset:25600
  s_waitcnt lgkmcnt(10)
  v_mfma_f32_16x16x32_bf16 v[132:135], v[196:199], v[72:75], v[132:135]
  v_mfma_f32_16x16x32_bf16 v[164:167], v[196:199], v[76:79], v[164:167]
  ds_read_b64_tr_b16 v[220:221], v243 offset:24576
  ds_read_b64_tr_b16 v[222:223], v243 offset:25600
  s_waitcnt lgkmcnt(10)
  v_mfma_f32_16x16x32_bf16 v[136:139], v[200:203], v[72:75], v[136:139]
  v_mfma_f32_16x16x32_bf16 v[168:171], v[200:203], v[76:79], v[168:171]
  s_waitcnt lgkmcnt(8)
  v_mfma_f32_16x16x32_bf16 v[140:143], v[204:207], v[72:75], v[140:143]
  v_mfma_f32_16x16x32_bf16 v[172:175], v[204:207], v[76:79], v[172:175]
  s_waitcnt lgkmcnt(6)
  v_mfma_f32_16x16x32_bf16 v[144:147], v[208:211], v[72:75], v[144:147]
  v_mfma_f32_16x16x32_bf16 v[176:179], v[208:211], v[76:79], v[176:179]
  s_waitcnt lgkmcnt(4)
  v_mfma_f32_16x16x32_bf16 v[148:151], v[212:215], v[72:75], v[148:151]
  v_mfma_f32_16x16x32_bf16 v[180:183], v[212:215], v[76:79], v[180:183]
  s_waitcnt lgkmcnt(2)
  v_mfma_f32_16x16x32_bf16 v[152:155], v[216:219], v[72:75], v[152:155]
  v_mfma_f32_16x16x32_bf16 v[184:187], v[216:219], v[76:79], v[184:187]
  s_waitcnt lgkmcnt(0)
  v_mfma_f32_16x16x32_bf16 v[156:159], v[220:223], v[72:75], v[156:159]
  v_mfma_f32_16x16x32_bf16 v[188:191], v[220:223], v[76:79], v[188:191]
  s_barrier
  ds_read_b64_tr_b16 v[192:193], v236 offset:32768
  ds_read_b64_tr_b16 v[194:195], v236 offset:33792
  ds_read_b64_tr_b16 v[196:197], v237 offset:32768
  ds_read_b64_tr_b16 v[198:199], v237 offset:33792
  ds_read_b64_tr_b16 v[200:201], v238 offset:32768
  ds_read_b64_tr_b16 v[202:203], v238 offset:33792
  ds_read_b64_tr_b16 v[204:205], v239 offset:32768
  ds_read_b64_tr_b16 v[206:207], v239 offset:33792
  ds_read_b64_tr_b16 v[208:209], v240 offset:32768
  ds_read_b64_tr_b16 v[210:211], v240 offset:33792
  ds_read_b64_tr_b16 v[212:213], v241 offset:32768
  ds_read_b64_tr_b16 v[214:215], v241 offset:33792
  s_waitcnt lgkmcnt(10)
  v_mfma_f32_16x16x32_bf16 v[128:131], v[192:195], v[80:83], v[128:131]
  v_mfma_f32_16x16x32_bf16 v[160:163], v[192:195], v[84:87], v[160:163]
  ds_read_b64_tr_b16 v[216:217], v242 offset:32768
  ds_read_b64_tr_b16 v[218:219], v242 offset:33792
  s_waitcnt lgkmcnt(10)
  v_mfma_f32_16x16x32_bf16 v[132:135], v[196:199], v[80:83], v[132:135]
  v_mfma_f32_16x16x32_bf16 v[164:167], v[196:199], v[84:87], v[164:167]
  ds_read_b64_tr_b16 v[220:221], v243 offset:32768
  ds_read_b64_tr_b16 v[222:223], v243 offset:33792
  s_waitcnt lgkmcnt(10)
  v_mfma_f32_16x16x32_bf16 v[136:139], v[200:203], v[80:83], v[136:139]
  v_mfma_f32_16x16x32_bf16 v[168:171], v[200:203], v[84:87], v[168:171]
  ds_read_b64_tr_b16 v[192:193], v236 offset:40960
  ds_read_b64_tr_b16 v[194:195], v236 offset:41984
  s_waitcnt lgkmcnt(10)
  v_mfma_f32_16x16x32_bf16 v[140:143], v[204:207], v[80:83], v[140:143]
  v_mfma_f32_16x16x32_bf16 v[172:175], v[204:207], v[84:87], v[172:175]
  ds_read_b64_tr_b16 v[196:197], v237 offset:40960
  ds_read_b64_tr_b16 v[198:199], v237 offset:41984
  s_waitcnt lgkmcnt(10)
  v_mfma_f32_16x16x32_bf16 v[144:147], v[208:211], v[80:83], v[144:147]
  v_mfma_f32_16x16x32_bf16 v[176:179], v[208:211], v[84:87], v[176:179]
  ds_read_b64_tr_b16 v[200:201], v238 offset:40960
  ds_read_b64_tr_b16 v[202:203], v238 offset:41984
  s_waitcnt lgkmcnt(10)
  v_mfma_f32_16x16x32_bf16 v[148:151], v[212:215], v[80:83], v[148:151]
  v_mfma_f32_16x16x32_bf16 v[180:183], v[212:215], v[84:87], v[180:183]
  ds_read_b64_tr_b16 v[204:205], v239 offset:40960
  ds_read_b64_tr_b16 v[206:207], v239 offset:41984
  s_waitcnt lgkmcnt(10)
  v_mfma_f32_16x16x32_bf16 v[152:155], v[216:219], v[80:83], v[152:155]
  v_mfma_f32_16x16x32_bf16 v[184:187], v[216:219], v[84:87], v[184:187]
  ds_read_b64_tr_b16 v[208:209], v240 offset:40960
  ds_read_b64_tr_b16 v[210:211], v240 offset:41984
  s_waitcnt lgkmcnt(10)
  v_mfma_f32_16x16x32_bf16 v[156:159], v[220:223], v[80:83], v[156:159]
  v_mfma_f32_16x16x32_bf16 v[188:191], v[220:223], v[84:87], v[188:191]
  ds_read_b64_tr_b16 v[212:213], v241 offset:40960
  ds_read_b64_tr_b16 v[214:215], v241 offset:41984
  s_waitcnt lgkmcnt(10)
  v_mfma_f32_16x16x32_bf16 v[128:131], v[192:195], v[88:91], v[128:131]
  v_mfma_f32_16x16x32_bf16 v[160:163], v[192:195], v[92:95], v[160:163]
  ds_read_b64_tr_b16 v[216:217], v242 offset:40960
  ds_read_b64_tr_b16 v[218:219], v242 offset:41984
  s_waitcnt lgkmcnt(10)
  v_mfma_f32_16x16x32_bf16 v[132:135], v[196:199], v[88:91], v[132:135]
  v_mfma_f32_16x16x32_bf16 v[164:167], v[196:199], v[92:95], v[164:167]
  ds_read_b64_tr_b16 v[220:221], v243 offset:40960
  ds_read_b64_tr_b16 v[222:223], v243 offset:41984
  s_waitcnt lgkmcnt(10)
  v_mfma_f32_16x16x32_bf16 v[136:139], v[200:203], v[88:91], v[136:139]
  v_mfma_f32_16x16x32_bf16 v[168:171], v[200:203], v[92:95], v[168:171]
  s_waitcnt lgkmcnt(8)
  v_mfma_f32_16x16x32_bf16 v[140:143], v[204:207], v[88:91], v[140:143]
  v_mfma_f32_16x16x32_bf16 v[172:175], v[204:207], v[92:95], v[172:175]
  s_waitcnt lgkmcnt(6)
  v_mfma_f32_16x16x32_bf16 v[144:147], v[208:211], v[88:91], v[144:147]
  v_mfma_f32_16x16x32_bf16 v[176:179], v[208:211], v[92:95], v[176:179]
  s_waitcnt lgkmcnt(4)
  v_mfma_f32_16x16x32_bf16 v[148:151], v[212:215], v[88:91], v[148:151]
  v_mfma_f32_16x16x32_bf16 v[180:183], v[212:215], v[92:95], v[180:183]
  s_waitcnt lgkmcnt(2)
  v_mfma_f32_16x16x32_bf16 v[152:155], v[216:219], v[88:91], v[152:155]
  v_mfma_f32_16x16x32_bf16 v[184:187], v[216:219], v[92:95], v[184:187]
  s_waitcnt lgkmcnt(0)
  v_mfma_f32_16x16x32_bf16 v[156:159], v[220:223], v[88:91], v[156:159]
  v_mfma_f32_16x16x32_bf16 v[188:191], v[220:223], v[92:95], v[188:191]
  s_barrier
  s_cmp_lg_u32 s36, 3
  s_cbranch_scc1 L_x2
  s_waitcnt vmcnt(0)
  v_cmp_eq_u64 vcc, 0, v[244:245]
  v_mov_b32 v246, s64
  v_mov_b32 v247, s65
  s_nop 1
  v_cndmask_b32 v244, v244, v246, vcc
  v_cndmask_b32 v245, v245, v247, vcc
  v_add_u32 v244, s49, v244
  s_lshl_b32 s98, s44, 3
  s_add_u32 s98, s98, 4608
  s_mov_b64 exec, 1
  buffer_store_dwordx2 v[244:245], off, s[68:71], s98 sc1
  s_mov_b64 exec, -1
L_x2:
  ds_read_b64_tr_b16 v[192:193], v236 offset:0
  ds_read_b64_tr_b16 v[194:195], v236 offset:1024
  ds_read_b64_tr_b16 v[196:197], v237 offset:0
  ds_read_b64_tr_b16 v[198:199], v237 offset:1024
  ds_read_b64_tr_b16 v[200:201], v238 offset:0
  ds_read_b64_tr_b16 v[202:203], v238 offset:1024
  ds_read_b64_tr_b16 v[204:205], v239 offset:0
  ds_read_b64_tr_b16 v[206:207], v239 offset:1024
  ds_read_b64_tr_b16 v[208:209], v240 offset:0
  ds_read_b64_tr_b16 v[210:211], v240 offset:1024
  ds_read_b64_tr_b16 v[212:213], v241 offset:0
  ds_read_b64_tr_b16 v[214:215], v241 offset:1024
  s_waitcnt lgkmcnt(10)
  v_mfma_f32_16x16x32_bf16 v[128:131], v[192:195], v[96:99], v[128:131]
  v_mfma_f32_16x16x32_bf16 v[160:163], v[192:195], v[100:103], v[160:163]
  ds_read_b64_tr_b16 v[216:217], v242 offset:0
  ds_read_b64_tr_b16 v[218:219], v242 offset:1024
  s_waitcnt lgkmcnt(10)
  v_mfma_f32_16x16x32_bf16 v[132:135], v[196:199], v[96:99], v[132:135]
  v_mfma_f32_16x16x32_bf16 v[164:167], v[196:199], v[100:103], v[164:167]
  ds_read_b64_tr_b16 v[220:221], v243 offset:0
  ds_read_b64_tr_b16 v[222:223], v243 offset:1024
  s_waitcnt lgkmcnt(10)
  v_mfma_f32_16x16x32_bf16 v[136:139], v[200:203], v[96:99], v[136:139]
  v_mfma_f32_16x16x32_bf16 v[168:171], v[200:203], v[100:103], v[168:171]
  ds_read_b64_tr_b16 v[192:193], v236 offset:8192
  ds_read_b64_tr_b16 v[194:195], v236 offset:9216
  s_waitcnt lgkmcnt(10)
  v_mfma_f32_16x16x32_bf16 v[140:143], v[204:207], v[96:99], v[140:143]
  v_mfma_f32_16x16x32_bf16 v[172:175], v[204:207], v[100:103], v[172:175]
  ds_read_b64_tr_b16 v[196:197], v237 offset:8192
  ds_read_b64_tr_b16 v[198:199], v237 offset:9216
  s_waitcnt lgkmcnt(10)
  v_mfma_f32_16x16x32_bf16 v[144:147], v[208:211], v[96:99], v[144:147]
  v_mfma_f32_16x16x32_bf16 v[176:179], v[208:211], v[100:103], v[176:179]
  ds_read_b64_tr_b16 v[200:201], v238 offset:8192
  ds_read_b64_tr_b16 v[202:203], v238 offset:9216
  s_waitcnt lgkmcnt(10)
  v_mfma_f32_16x16x32_bf16 v[148:151], v[212:215], v[96:99], v[148:151]
  v_mfma_f32_16x16x32_bf16 v[180:183], v[212:215], v[100:103], v[180:183]
  ds_read_b64_tr_b16 v[204:205], v239 offset:8192
  ds_read_b64_tr_b16 v[206:207], v239 offset:9216
  s_waitcnt lgkmcnt(10)
  v_mfma_f32_16x16x32_bf16 v[152:155], v[216:219], v[96:99], v[152:155]
  v_mfma_f32_16x16x32_bf16 v[184:187], v[216:219], v[100:103], v[184:187]
  ds_read_b64_tr_b16 v[208:209], v240 offset:8192
  ds_read_b64_tr_b16 v[210:211], v240 offset:9216
  s_waitcnt lgkmcnt(10)
  v_mfma_f32_16x16x32_bf16 v[156:159], v[220:223], v[96:99], v[156:159]
  v_mfma_f32_16x16x32_bf16 v[188:191], v[220:223], v[100:103], v[188:191]
  ds_read_b64_tr_b16 v[212:213], v241 offset:8192
  ds_read_b64_tr_b16 v[214:215], v241 offset:9216
  s_waitcnt lgkmcnt(10)
  v_mfma_f32_16x16x32_bf16 v[128:131], v[192:195], v[104:107], v[128:131]
  v_mfma_f32_16x16x32_bf16 v[160:163], v[192:195], v[108:111], v[160:163]
  ds_read_b64_tr_b16 v[216:217], v242 offset:8192
  ds_read_b64_tr_b16 v[218:219], v242 offset:9216
  s_waitcnt lgkmcnt(10)
  v_mfma_f32_16x16x32_bf16 v[132:135], v[196:199], v[104:107], v[132:135]
  v_mfma_f32_16x16x32_bf16 v[164:167], v[196:199], v[108:111], v[164:167]
  ds_read_b64_tr_b16 v[220:221], v243 offset:8192
  ds_read_b64_tr_b16 v[222:223], v243 offset:9216
  s_waitcnt lgkmcnt(10)
  v_mfma_f32_16x16x32_bf16 v[136:139], v[200:203], v[104:107], v[136:139]
  v_mfma_f32_16x16x32_bf16 v[168:171], v[200:203], v[108:111], v[168:171]
  s_waitcnt lgkmcnt(8)
  v_mfma_f32_16x16x32_bf16 v[140:143], v[204:207], v[104:107], v[140:143]
  v_mfma_f32_16x16x32_bf16 v[172:175], v[204:207], v[108:111], v[172:175]
  s_waitcnt lgkmcnt(6)
  v_mfma_f32_16x16x32_bf16 v[144:147], v[208:211], v[104:107], v[144:147]
  v_mfma_f32_16x16x32_bf16 v[176:179], v[208:211], v[108:111], v[176:179]
  s_waitcnt lgkmcnt(4)
  v_mfma_f32_16x16x32_bf16 v[148:151], v[212:215], v[104:107], v[148:151]
  v_mfma_f32_16x16x32_bf16 v[180:183], v[212:215], v[108:111], v[180:183]
  s_waitcnt lgkmcnt(2)
  v_mfma_f32_16x16x32_bf16 v[152:155], v[216:219], v[104:107], v[152:155]
  v_mfma_f32_16x16x32_bf16 v[184:187], v[216:219], v[108:111], v[184:187]
  s_waitcnt lgkmcnt(0)
  v_mfma_f32_16x16x32_bf16 v[156:159], v[220:223], v[104:107], v[156:159]
  v_mfma_f32_16x16x32_bf16 v[188:191], v[220:223], v[108:111], v[188:191]
  s_barrier
  ds_read_b64_tr_b16 v[192:193], v236 offset:16384
  ds_read_b64_tr_b16 v[194:195], v236 offset:17408
  ds_read_b64_tr_b16 v[196:197], v237 offset:16384
  ds_read_b64_tr_b16 v[198:199], v237 offset:17408
  ds_read_b64_tr_b16 v[200:201], v238 offset:16384
  ds_read_b64_tr_b16 v[202:203], v238 offset:17408
  ds_read_b64_tr_b16 v[204:205], v239 offset:16384
  ds_read_b64_tr_b16 v[206:207], v239 offset:17408
  ds_read_b64_tr_b16 v[208:209], v240 offset:16384
  ds_read_b64_tr_b16 v[210:211], v240 offset:17408
  ds_read_b64_tr_b16 v[212:213], v241 offset:16384
  ds_read_b64_tr_b16 v[214:215], v241 offset:17408
  s_waitcnt lgkmcnt(10)
  v_mfma_f32_16x16x32_bf16 v[128:131], v[192:195], v[112:115], v[128:131]
  v_mfma_f32_16x16x32_bf16 v[160:163], v[192:195], v[116:119], v[160:163]
  ds_read_b64_tr_b16 v[216:217], v242 offset:16384
  ds_read_b64_tr_b16 v[218:219], v242 offset:17408
  s_waitcnt lgkmcnt(10)
  v_mfma_f32_16x16x32_bf16 v[132:135], v[196:199], v[112:115], v[132:135]
  v_mfma_f32_16x16x32_bf16 v[164:167], v[196:199], v[116:119], v[164:167]
  ds_read_b64_tr_b16 v[220:221], v243 offset:16384
  ds_read_b64_tr_b16 v[222:223], v243 offset:17408
  s_waitcnt lgkmcnt(10)
  v_mfma_f32_16x16x32_bf16 v[136:139], v[200:203], v[112:115], v[136:139]
  v_mfma_f32_16x16x32_bf16 v[168:171], v[200:203], v[116:119], v[168:171]
  ds_read_b64_tr_b16 v[192:193], v236 offset:24576
  ds_read_b64_tr_b16 v[194:195], v236 offset:25600
  s_waitcnt lgkmcnt(10)
  v_mfma_f32_16x16x32_bf16 v[140:143], v[204:207], v[112:115], v[140:143]
  v_mfma_f32_16x16x32_bf16 v[172:175], v[204:207], v[116:119], v[172:175]
  ds_read_b64_tr_b16 v[196:197], v237 offset:24576
  ds_read_b64_tr_b16 v[198:199], v237 offset:25600
  s_waitcnt lgkmcnt(10)
  v_mfma_f32_16x16x32_bf16 v[144:147], v[208:211], v[112:115], v[144:147]
  v_mfma_f32_16x16x32_bf16 v[176:179], v[208:211], v[116:119], v[176:179]
  ds_read_b64_tr_b16 v[200:201], v238 offset:24576
  ds_read_b64_tr_b16 v[202:203], v238 offset:25600
  s_waitcnt lgkmcnt(10)
  v_mfma_f32_16x16x32_bf16 v[148:151], v[212:215], v[112:115], v[148:151]
  v_mfma_f32_16x16x32_bf16 v[180:183], v[212:215], v[116:119], v[180:183]
  ds_read_b64_tr_b16 v[204:205], v239 offset:24576
  ds_read_b64_tr_b16 v[206:207], v239 offset:25600
  s_waitcnt lgkmcnt(10)
  v_mfma_f32_16x16x32_bf16 v[152:155], v[216:219], v[112:115], v[152:155]
  v_mfma_f32_16x16x32_bf16 v[184:187], v[216:219], v[116:119], v[184:187]
  ds_read_b64_tr_b16 v[208:209], v240 offset:24576
  ds_read_b64_tr_b16 v[210:211], v240 offset:25600
  s_waitcnt lgkmcnt(10)
  v_mfma_f32_16x16x32_bf16 v[156:159], v[220:223], v[112:115], v[156:159]
  v_mfma_f32_16x16x32_bf16 v[188:191], v[220:223], v[116:119], v[188:191]
  ds_read_b64_tr_b16 v[212:213], v241 offset:24576
  ds_read_b64_tr_b16 v[214:215], v241 offset:25600
  s_waitcnt lgkmcnt(10)
  v_mfma_f32_16x16x32_bf16 v[128:131], v[192:195], v[120:123], v[128:131]
  v_mfma_f32_16x16x32_bf16 v[160:163], v[192:195], v[124:127], v[160:163]
  ds_read_b64_tr_b16 v[216:217], v242 offset:24576
  ds_read_b64_tr_b16 v[218:219], v242 offset:25600
  s_waitcnt lgkmcnt(10)
  v_mfma_f32_16x16x32_bf16 v[132:135], v[196:199], v[120:123], v[132:135]
  v_mfma_f32_16x16x32_bf16 v[164:167], v[196:199], v[124:127], v[164:167]
  ds_read_b64_tr_b16 v[220:221], v243 offset:24576
  ds_read_b64_tr_b16 v[222:223], v243 offset:25600
  s_waitcnt lgkmcnt(10)
  v_mfma_f32_16x16x32_bf16 v[136:139], v[200:203], v[120:123], v[136:139]
  v_mfma_f32_16x16x32_bf16 v[168:171], v[200:203], v[124:127], v[168:171]
  s_waitcnt lgkmcnt(8)
  v_mfma_f32_16x16x32_bf16 v[140:143], v[204:207], v[120:123], v[140:143]
  v_mfma_f32_16x16x32_bf16 v[172:175], v[204:207], v[124:127], v[172:175]
  s_waitcnt lgkmcnt(6)
  v_mfma_f32_16x16x32_bf16 v[144:147], v[208:211], v[120:123], v[144:147]
  v_mfma_f32_16x16x32_bf16 v[176:179], v[208:211], v[124:127], v[176:179]
  s_waitcnt lgkmcnt(4)
  v_mfma_f32_16x16x32_bf16 v[148:151], v[212:215], v[120:123], v[148:151]
  v_mfma_f32_16x16x32_bf16 v[180:183], v[212:215], v[124:127], v[180:183]
  s_waitcnt lgkmcnt(2)
  v_mfma_f32_16x16x32_bf16 v[152:155], v[216:219], v[120:123], v[152:155]
  v_mfma_f32_16x16x32_bf16 v[184:187], v[216:219], v[124:127], v[184:187]
  s_waitcnt lgkmcnt(0)
  v_mfma_f32_16x16x32_bf16 v[156:159], v[220:223], v[120:123], v[156:159]
  v_mfma_f32_16x16x32_bf16 v[188:191], v[220:223], v[124:127], v[188:191]
  s_barrier
  v_cvt_pk_bf16_f32 v132, v132, v133
  v_cvt_pk_bf16_f32 v133, v134, v135
  v_cvt_pk_bf16_f32 v134, v128, v129
  v_cvt_pk_bf16_f32 v135, v130, v131
  v_cndmask_b32_e64 v128, v134, v132, s[42:43]
  v_cndmask_b32_e64 v129, v135, v133, s[42:43]
  v_cndmask_b32_e64 v130, v132, v134, s[42:43]
  v_cndmask_b32_e64 v131, v133, v135, s[42:43]
  v_cvt_pk_bf16_f32 v140, v140, v141
  v_cvt_pk_bf16_f32 v141, v142, v143
  v_cvt_pk_bf16_f32 v142, v136, v137
  v_cvt_pk_bf16_f32 v143, v138, v139
  v_cndmask_b32_e64 v136, v142, v140, s[42:43]
  v_cndmask_b32_e64 v137, v143, v141, s[42:43]
  v_cndmask_b32_e64 v138, v140, v142, s[42:43]
  v_cndmask_b32_e64 v139, v141, v143, s[42:43]
  v_cvt_pk_bf16_f32 v148, v148, v149
  v_cvt_pk_bf16_f32 v149, v150, v151
  v_cvt_pk_bf16_f32 v150, v144, v145
  v_cvt_pk_bf16_f32 v151, v146, v147
  v_cndmask_b32_e64 v144, v150, v148, s[42:43]
  v_cndmask_b32_e64 v145, v151, v149, s[42:43]
  v_cndmask_b32_e64 v146, v148, v150, s[42:43]
  v_cndmask_b32_e64 v147, v149, v151, s[42:43]
  v_cvt_pk_bf16_f32 v156, v156, v157
  v_cvt_pk_bf16_f32 v157, v158, v159
  v_cvt_pk_bf16_f32 v158, v152, v153
  v_cvt_pk_bf16_f32 v159, v154, v155
  v_cndmask_b32_e64 v152, v158, v156, s[42:43]
  v_cndmask_b32_e64 v153, v159, v157, s[42:43]
  v_cndmask_b32_e64 v154, v156, v158, s[42:43]
  v_cndmask_b32_e64 v155, v157, v159, s[42:43]
  v_cvt_pk_bf16_f32 v164, v164, v165
  v_cvt_pk_bf16_f32 v165, v166, v167
  v_cvt_pk_bf16_f32 v166, v160, v161
  v_cvt_pk_bf16_f32 v167, v162, v163
  v_cndmask_b32_e64 v160, v166, v164, s[42:43]
  v_cndmask_b32_e64 v161, v167, v165, s[42:43]
  v_cndmask_b32_e64 v162, v164, v166, s[42:43]
  v_cndmask_b32_e64 v163, v165, v167, s[42:43]
  v_cvt_pk_bf16_f32 v172, v172, v173
  v_cvt_pk_bf16_f32 v173, v174, v175
  v_cvt_pk_bf16_f32 v174, v168, v169
  v_cvt_pk_bf16_f32 v175, v170, v171
  v_cndmask_b32_e64 v168, v174, v172, s[42:43]
  v_cndmask_b32_e64 v169, v175, v173, s[42:43]
  v_cndmask_b32_e64 v170, v172, v174, s[42:43]
  v_cndmask_b32_e64 v171, v173, v175, s[42:43]
  v_cvt_pk_bf16_f32 v180, v180, v181
  v_cvt_pk_bf16_f32 v181, v182, v183
  v_cvt_pk_bf16_f32 v182, v176, v177
  v_cvt_pk_bf16_f32 v183, v178, v179
  v_cndmask_b32_e64 v176, v182, v180, s[42:43]
  v_cndmask_b32_e64 v177, v183, v181, s[42:43]
  v_cndmask_b32_e64 v178, v180, v182, s[42:43]
  v_cndmask_b32_e64 v179, v181, v183, s[42:43]
  v_cvt_pk_bf16_f32 v188, v188, v189
  v_cvt_pk_bf16_f32 v189, v190, v191
  v_cvt_pk_bf16_f32 v190, v184, v185
  v_cvt_pk_bf16_f32 v191, v186, v187
  v_cndmask_b32_e64 v184, v190, v188, s[42:43]
  v_cndmask_b32_e64 v185, v191, v189, s[42:43]
  v_cndmask_b32_e64 v186, v188, v190, s[42:43]
  v_cndmask_b32_e64 v187, v189, v191, s[42:43]
  v_xor_b32 v236, 0, v254
  v_xor_b32 v237, 8, v254
  v_xor_b32 v238, 64, v254
  v_xor_b32 v239, 72, v254
  v_xor_b32 v240, 128, v254
  v_xor_b32 v241, 136, v254
  v_xor_b32 v242, 192, v254
  v_xor_b32 v243, 200, v254
  v_mov_b32 v253, v255
  v_add_u32 v232, 65536, v232
  v_add_u32 v233, 65536, v233
  v_add_u32 v234, 65536, v234
  v_add_u32 v235, 65536, v235
  ds_read_b128 v[192:195], v232 offset:0
  ds_read_b128 v[196:199], v233 offset:0
  ds_read_b128 v[200:203], v234 offset:0
  ds_read_b128 v[204:207], v235 offset:0
  ds_read_b128 v[208:211], v232 offset:4096
  ds_read_b128 v[212:215], v233 offset:4096
  s_waitcnt lgkmcnt(5)
  v_mfma_f32_16x16x32_bf16 v[0:3], v[192:195], v[128:131], 0
  ds_read_b128 v[216:219], v234 offset:4096
  s_waitcnt lgkmcnt(5)
  v_mfma_f32_16x16x32_bf16 v[0:3], v[196:199], v[136:139], v[0:3]
  ds_read_b128 v[220:223], v235 offset:4096
  s_waitcnt lgkmcnt(5)
  v_mfma_f32_16x16x32_bf16 v[0:3], v[200:203], v[144:147], v[0:3]
  ds_read_b128 v[192:195], v232 offset:8192
  s_waitcnt lgkmcnt(5)
  v_mfma_f32_16x16x32_bf16 v[0:3], v[204:207], v[152:155], v[0:3]
  ds_read_b128 v[196:199], v233 offset:8192
  s_waitcnt lgkmcnt(5)
  v_mfma_f32_16x16x32_bf16 v[4:7], v[208:211], v[128:131], 0
  ds_read_b128 v[200:203], v234 offset:8192
  s_waitcnt lgkmcnt(5)
  v_mfma_f32_16x16x32_bf16 v[4:7], v[212:215], v[136:139], v[4:7]
  ds_read_b128 v[204:207], v235 offset:8192
  s_waitcnt lgkmcnt(5)
  v_mfma_f32_16x16x32_bf16 v[4:7], v[216:219], v[144:147], v[4:7]
  ds_read_b128 v[208:211], v232 offset:12288
  s_waitcnt lgkmcnt(5)
  v_mfma_f32_16x16x32_bf16 v[4:7], v[220:223], v[152:155], v[4:7]
  ds_read_b128 v[212:215], v233 offset:12288
  s_waitcnt lgkmcnt(5)
  v_mfma_f32_16x16x32_bf16 v[8:11], v[192:195], v[128:131], 0
  ds_read_b128 v[216:219], v234 offset:12288
  s_waitcnt lgkmcnt(5)
  v_mfma_f32_16x16x32_bf16 v[8:11], v[196:199], v[136:139], v[8:11]
  ds_read_b128 v[220:223], v235 offset:12288
  s_waitcnt lgkmcnt(5)
  v_mfma_f32_16x16x32_bf16 v[8:11], v[200:203], v[144:147], v[8:11]
  s_waitcnt lgkmcnt(4)
  v_mfma_f32_16x16x32_bf16 v[8:11], v[204:207], v[152:155], v[8:11]
  s_waitcnt lgkmcnt(3)
  v_mfma_f32_16x16x32_bf16 v[12:15], v[208:211], v[128:131], 0
  s_waitcnt lgkmcnt(2)
  v_mfma_f32_16x16x32_bf16 v[12:15], v[212:215], v[136:139], v[12:15]
  s_waitcnt lgkmcnt(1)
  v_mfma_f32_16x16x32_bf16 v[12:15], v[216:219], v[144:147], v[12:15]
  s_waitcnt lgkmcnt(0)
  v_mfma_f32_16x16x32_bf16 v[12:15], v[220:223], v[152:155], v[12:15]
  s_barrier
  ds_read_b128 v[192:195], v232 offset:16384
  ds_read_b128 v[196:199], v233 offset:16384
  ds_read_b128 v[200:203], v234 offset:16384
  ds_read_b128 v[204:207], v235 offset:16384
  ds_read_b128 v[208:211], v232 offset:20480
  ds_read_b128 v[212:215], v233 offset:20480
  s_waitcnt lgkmcnt(5)
  v_mfma_f32_16x16x32_bf16 v[16:19], v[192:195], v[128:131], 0
  ds_read_b128 v[216:219], v234 offset:20480
  v_max3_f32 v250, v0, v1, v2
  s_waitcnt lgkmcnt(5)
  v_mfma_f32_16x16x32_bf16 v[16:19], v[196:199], v[136:139], v[16:19]
  ds_read_b128 v[220:223], v235 offset:20480
  s_waitcnt lgkmcnt(5)
  v_mfma_f32_16x16x32_bf16 v[16:19], v[200:203], v[144:147], v[16:19]
  v_max_f32 v250, v250, v3
  ds_read_b128 v[192:195], v232 offset:24576
  s_waitcnt lgkmcnt(5)
  v_mfma_f32_16x16x32_bf16 v[16:19], v[204:207], v[152:155], v[16:19]
  ds_read_b128 v[196:199], v233 offset:24576
  v_max3_f32 v250, v250, v4, v5
  s_waitcnt lgkmcnt(5)
  v_mfma_f32_16x16x32_bf16 v[20:23], v[208:211], v[128:131], 0
  ds_read_b128 v[200:203], v234 offset:24576
  s_waitcnt lgkmcnt(5)
  v_mfma_f32_16x16x32_bf16 v[20:23], v[212:215], v[136:139], v[20:23]
  v_max3_f32 v250, v250, v6, v7
  ds_read_b128 v[204:207], v235 offset:24576
  s_waitcnt lgkmcnt(5)
  v_mfma_f32_16x16x32_bf16 v[20:23], v[216:219], v[144:147], v[20:23]
  ds_read_b128 v[208:211], v232 offset:28672
  s_waitcnt lgkmcnt(5)
  v_mfma_f32_16x16x32_bf16 v[20:23], v[220:223], v[152:155], v[20:23]
  v_max3_f32 v250, v250, v8, v9
  ds_read_b128 v[212:215], v233 offset:28672
  s_waitcnt lgkmcnt(5)
  v_mfma_f32_16x16x32_bf16 v[24:27], v[192:195], v[128:131], 0
  ds_read_b128 v[216:219], v234 offset:28672
  v_max3_f32 v250, v250, v10, v11
  s_waitcnt lgkmcnt(5)
  v_mfma_f32_16x16x32_bf16 v[24:27], v[196:199], v[136:139], v[24:27]
  ds_read_b128 v[220:223], v235 offset:28672
  s_waitcnt lgkmcnt(5)
  v_mfma_f32_16x16x32_bf16 v[24:27], v[200:203], v[144:147], v[24:27]
  v_max3_f32 v250, v250, v12, v13
  s_waitcnt lgkmcnt(4)
  v_mfma_f32_16x16x32_bf16 v[24:27], v[204:207], v[152:155], v[24:27]
  s_waitcnt lgkmcnt(3)
  v_mfma_f32_16x16x32_bf16 v[28:31], v[208:211], v[128:131], 0
  s_waitcnt lgkmcnt(2)
  v_mfma_f32_16x16x32_bf16 v[28:31], v[212:215], v[136:139], v[28:31]
  v_max3_f32 v250, v250, v14, v15
  s_waitcnt lgkmcnt(1)
  v_mfma_f32_16x16x32_bf16 v[28:31], v[216:219], v[144:147], v[28:31]
  s_waitcnt lgkmcnt(0)
  v_mfma_f32_16x16x32_bf16 v[28:31], v[220:223], v[152:155], v[28:31]
  s_barrier
  ds_read_b128 v[192:195], v232 offset:32768
  ds_read_b128 v[196:199], v233 offset:32768
  ds_read_b128 v[200:203], v234 offset:32768
  ds_read_b128 v[204:207], v235 offset:32768
  ds_read_b128 v[208:211], v232 offset:36864
  ds_read_b128 v[212:215], v233 offset:36864
  s_waitcnt lgkmcnt(5)
  v_mfma_f32_16x16x32_bf16 v[32:35], v[192:195], v[128:131], 0
  ds_read_b128 v[216:219], v234 offset:36864
  v_max3_f32 v250, v250, v16, v17
  s_waitcnt lgkmcnt(5)
  v_mfma_f32_16x16x32_bf16 v[32:35], v[196:199], v[136:139], v[32:35]
  ds_read_b128 v[220:223], v235 offset:36864
  s_waitcnt lgkmcnt(5)
  v_mfma_f32_16x16x32_bf16 v[32:35], v[200:203], v[144:147], v[32:35]
  v_max3_f32 v250, v250, v18, v19
  ds_read_b128 v[192:195], v232 offset:40960
  s_waitcnt lgkmcnt(5)
  v_mfma_f32_16x16x32_bf16 v[32:35], v[204:207], v[152:155], v[32:35]
  ds_read_b128 v[196:199], v233 offset:40960
  v_max3_f32 v250, v250, v20, v21
  s_waitcnt lgkmcnt(5)
  v_mfma_f32_16x16x32_bf16 v[36:39], v[208:211], v[128:131], 0
  ds_read_b128 v[200:203], v234 offset:40960
  s_waitcnt lgkmcnt(5)
  v_mfma_f32_16x16x32_bf16 v[36:39], v[212:215], v[136:139], v[36:39]
  v_max3_f32 v250, v250, v22, v23
  ds_read_b128 v[204:207], v235 offset:40960
  s_waitcnt lgkmcnt(5)
  v_mfma_f32_16x16x32_bf16 v[36:39], v[216:219], v[144:147], v[36:39]
  ds_read_b128 v[208:211], v232 offset:45056
  s_waitcnt lgkmcnt(5)
  v_mfma_f32_16x16x32_bf16 v[36:39], v[220:223], v[152:155], v[36:39]
  v_max3_f32 v250, v250, v24, v25
  ds_read_b128 v[212:215], v233 offset:45056
  s_waitcnt lgkmcnt(5)
  v_mfma_f32_16x16x32_bf16 v[40:43], v[192:195], v[128:131], 0
  ds_read_b128 v[216:219], v234 offset:45056
  v_max3_f32 v250, v250, v26, v27
  s_waitcnt lgkmcnt(5)
  v_mfma_f32_16x16x32_bf16 v[40:43], v[196:199], v[136:139], v[40:43]
  ds_read_b128 v[220:223], v235 offset:45056
  s_waitcnt lgkmcnt(5)
  v_mfma_f32_16x16x32_bf16 v[40:43], v[200:203], v[144:147], v[40:43]
  v_max3_f32 v250, v250, v28, v29
  s_waitcnt lgkmcnt(4)
  v_mfma_f32_16x16x32_bf16 v[40:43], v[204:207], v[152:155], v[40:43]
  s_waitcnt lgkmcnt(3)
  v_mfma_f32_16x16x32_bf16 v[44:47], v[208:211], v[128:131], 0
  s_waitcnt lgkmcnt(2)
  v_mfma_f32_16x16x32_bf16 v[44:47], v[212:215], v[136:139], v[44:47]
  v_max3_f32 v250, v250, v30, v31
  s_waitcnt lgkmcnt(1)
  v_mfma_f32_16x16x32_bf16 v[44:47], v[216:219], v[144:147], v[44:47]
  s_waitcnt lgkmcnt(0)
  v_mfma_f32_16x16x32_bf16 v[44:47], v[220:223], v[152:155], v[44:47]
  s_barrier
  buffer_load_dwordx2 v[254:255], off, s[72:75], 0 sc1
  v_mov_b32 v244, 0
  v_mov_b32 v245, 0
  v_mov_b32 v246, 0
  v_mov_b32 v247, 0
  v_subrev_u32 v232, 65536, v232
  v_subrev_u32 v233, 65536, v233
  v_subrev_u32 v234, 65536, v234
  v_subrev_u32 v235, 65536, v235
  ds_read_b128 v[192:195], v232 offset:0
  ds_read_b128 v[196:199], v233 offset:0
  ds_read_b128 v[200:203], v234 offset:0
  ds_read_b128 v[204:207], v235 offset:0
  ds_read_b128 v[208:211], v232 offset:4096
  ds_read_b128 v[212:215], v233 offset:4096
  s_waitcnt lgkmcnt(5)
  v_mfma_f32_16x16x32_bf16 v[48:51], v[192:195], v[128:131], 0
  ds_read_b128 v[216:219], v234 offset:4096
  v_max3_f32 v250, v250, v32, v33
  s_waitcnt lgkmcnt(5)
  v_mfma_f32_16x16x32_bf16 v[48:51], v[196:199], v[136:139], v[48:51]
  ds_read_b128 v[220:223], v235 offset:4096
  s_waitcnt lgkmcnt(5)
  v_mfma_f32_16x16x32_bf16 v[48:51], v[200:203], v[144:147], v[48:51]
  v_max3_f32 v250, v250, v34, v35
  ds_read_b128 v[192:195], v232 offset:8192
  s_waitcnt lgkmcnt(5)
  v_mfma_f32_16x16x32_bf16 v[48:51], v[204:207], v[152:155], v[48:51]
  ds_read_b128 v[196:199], v233 offset:8192
  v_max3_f32 v250, v250, v36, v37
  s_waitcnt lgkmcnt(5)
  v_mfma_f32_16x16x32_bf16 v[52:55], v[208:211], v[128:131], 0
  ds_read_b128 v[200:203], v234 offset:8192
  s_waitcnt lgkmcnt(5)
  v_mfma_f32_16x16x32_bf16 v[52:55], v[212:215], v[136:139], v[52:55]
  v_max3_f32 v250, v250, v38, v39
  ds_read_b128 v[204:207], v235 offset:8192
  s_waitcnt lgkmcnt(5)
  v_mfma_f32_16x16x32_bf16 v[52:55], v[216:219], v[144:147], v[52:55]
  ds_read_b128 v[208:211], v232 offset:12288
  s_waitcnt lgkmcnt(5)
  v_mfma_f32_16x16x32_bf16 v[52:55], v[220:223], v[152:155], v[52:55]
  v_max3_f32 v250, v250, v40, v41
  ds_read_b128 v[212:215], v233 offset:12288
  s_waitcnt lgkmcnt(5)
  v_mfma_f32_16x16x32_bf16 v[56:59], v[192:195], v[128:131], 0
  ds_read_b128 v[216:219], v234 offset:12288
  v_max3_f32 v250, v250, v42, v43
  s_waitcnt lgkmcnt(5)
  v_mfma_f32_16x16x32_bf16 v[56:59], v[196:199], v[136:139], v[56:59]
  ds_read_b128 v[220:223], v235 offset:12288
  s_waitcnt lgkmcnt(5)
  v_mfma_f32_16x16x32_bf16 v[56:59], v[200:203], v[144:147], v[56:59]
  v_max3_f32 v250, v250, v44, v45
  s_waitcnt lgkmcnt(4)
  v_mfma_f32_16x16x32_bf16 v[56:59], v[204:207], v[152:155], v[56:59]
  s_waitcnt lgkmcnt(3)
  v_mfma_f32_16x16x32_bf16 v[60:63], v[208:211], v[128:131], 0
  s_waitcnt lgkmcnt(2)
  v_mfma_f32_16x16x32_bf16 v[60:63], v[212:215], v[136:139], v[60:63]
  v_max3_f32 v250, v250, v46, v47
  s_waitcnt lgkmcnt(1)
  v_mfma_f32_16x16x32_bf16 v[60:63], v[216:219], v[144:147], v[60:63]
  s_waitcnt lgkmcnt(0)
  v_mfma_f32_16x16x32_bf16 v[60:63], v[220:223], v[152:155], v[60:63]
  s_barrier
  ds_read_b128 v[192:195], v232 offset:16384
  ds_read_b128 v[196:199], v233 offset:16384
  ds_read_b128 v[200:203], v234 offset:16384
  ds_read_b128 v[204:207], v235 offset:16384
  ds_read_b128 v[208:211], v232 offset:20480
  ds_read_b128 v[212:215], v233 offset:20480
  s_waitcnt lgkmcnt(5)
  v_mfma_f32_16x16x32_bf16 v[64:67], v[192:195], v[128:131], 0
  ds_read_b128 v[216:219], v234 offset:20480
  v_max3_f32 v250, v250, v48, v49
  s_waitcnt lgkmcnt(5)
  v_mfma_f32_16x16x32_bf16 v[64:67], v[196:199], v[136:139], v[64:67]
  ds_read_b128 v[220:223], v235 offset:20480
  s_waitcnt lgkmcnt(5)
  v_mfma_f32_16x16x32_bf16 v[64:67], v[200:203], v[144:147], v[64:67]
  v_max3_f32 v250, v250, v50, v51
  ds_read_b128 v[192:195], v232 offset:24576
  s_waitcnt lgkmcnt(5)
  v_mfma_f32_16x16x32_bf16 v[64:67], v[204:207], v[152:155], v[64:67]
  ds_read_b128 v[196:199], v233 offset:24576
  v_max3_f32 v250, v250, v52, v53
  s_waitcnt lgkmcnt(5)
  v_mfma_f32_16x16x32_bf16 v[68:71], v[208:211], v[128:131], 0
  ds_read_b128 v[200:203], v234 offset:24576
  s_waitcnt lgkmcnt(5)
  v_mfma_f32_16x16x32_bf16 v[68:71], v[212:215], v[136:139], v[68:71]
  v_max3_f32 v250, v250, v54, v55
  ds_read_b128 v[204:207], v235 offset:24576
  s_waitcnt lgkmcnt(5)
  v_mfma_f32_16x16x32_bf16 v[68:71], v[216:219], v[144:147], v[68:71]
  ds_read_b128 v[208:211], v232 offset:28672
  s_waitcnt lgkmcnt(5)
  v_mfma_f32_16x16x32_bf16 v[68:71], v[220:223], v[152:155], v[68:71]
  v_max3_f32 v250, v250, v56, v57
  ds_read_b128 v[212:215], v233 offset:28672
  s_waitcnt lgkmcnt(5)
  v_mfma_f32_16x16x32_bf16 v[72:75], v[192:195], v[128:131], 0
  ds_read_b128 v[216:219], v234 offset:28672
  v_max3_f32 v250, v250, v58, v59
  s_waitcnt lgkmcnt(5)
  v_mfma_f32_16x16x32_bf16 v[72:75], v[196:199], v[136:139], v[72:75]
  ds_read_b128 v[220:223], v235 offset:28672
  s_waitcnt lgkmcnt(5)
  v_mfma_f32_16x16x32_bf16 v[72:75], v[200:203], v[144:147], v[72:75]
  v_max3_f32 v250, v250, v60, v61
  s_waitcnt lgkmcnt(4)
  v_mfma_f32_16x16x32_bf16 v[72:75], v[204:207], v[152:155], v[72:75]
  s_waitcnt lgkmcnt(3)
  v_mfma_f32_16x16x32_bf16 v[76:79], v[208:211], v[128:131], 0
  s_waitcnt lgkmcnt(2)
  v_mfma_f32_16x16x32_bf16 v[76:79], v[212:215], v[136:139], v[76:79]
  v_max3_f32 v250, v250, v62, v63
  s_waitcnt lgkmcnt(1)
  v_mfma_f32_16x16x32_bf16 v[76:79], v[216:219], v[144:147], v[76:79]
  s_waitcnt lgkmcnt(0)
  v_mfma_f32_16x16x32_bf16 v[76:79], v[220:223], v[152:155], v[76:79]
  s_barrier
  ds_read_b128 v[192:195], v232 offset:32768
  ds_read_b128 v[196:199], v233 offset:32768
  ds_read_b128 v[200:203], v234 offset:32768
  ds_read_b128 v[204:207], v235 offset:32768
  ds_read_b128 v[208:211], v232 offset:36864
  ds_read_b128 v[212:215], v233 offset:36864
  s_waitcnt lgkmcnt(5)
  v_mfma_f32_16x16x32_bf16 v[80:83], v[192:195], v[128:131], 0
  ds_read_b128 v[216:219], v234 offset:36864
  v_max3_f32 v250, v250, v64, v65
  s_waitcnt lgkmcnt(5)
  v_mfma_f32_16x16x32_bf16 v[80:83], v[196:199], v[136:139], v[80:83]
  ds_read_b128 v[220:223], v235 offset:36864
  s_waitcnt lgkmcnt(5)
  v_mfma_f32_16x16x32_bf16 v[80:83], v[200:203], v[144:147], v[80:83]
  v_max3_f32 v250, v250, v66, v67
  ds_read_b128 v[192:195], v232 offset:40960
  s_waitcnt lgkmcnt(5)
  v_mfma_f32_16x16x32_bf16 v[80:83], v[204:207], v[152:155], v[80:83]
  ds_read_b128 v[196:199], v233 offset:40960
  v_max3_f32 v250, v250, v68, v69
  s_waitcnt lgkmcnt(5)
  v_mfma_f32_16x16x32_bf16 v[84:87], v[208:211], v[128:131], 0
  ds_read_b128 v[200:203], v234 offset:40960
  s_waitcnt lgkmcnt(5)
  v_mfma_f32_16x16x32_bf16 v[84:87], v[212:215], v[136:139], v[84:87]
  v_max3_f32 v250, v250, v70, v71
  ds_read_b128 v[204:207], v235 offset:40960
  s_waitcnt lgkmcnt(5)
  v_mfma_f32_16x16x32_bf16 v[84:87], v[216:219], v[144:147], v[84:87]
  ds_read_b128 v[208:211], v232 offset:45056
  s_waitcnt lgkmcnt(5)
  v_mfma_f32_16x16x32_bf16 v[84:87], v[220:223], v[152:155], v[84:87]
  v_max3_f32 v250, v250, v72, v73
  ds_read_b128 v[212:215], v233 offset:45056
  s_waitcnt lgkmcnt(5)
  v_mfma_f32_16x16x32_bf16 v[88:91], v[192:195], v[128:131], 0
  ds_read_b128 v[216:219], v234 offset:45056
  v_max3_f32 v250, v250, v74, v75
  s_waitcnt lgkmcnt(5)
  v_mfma_f32_16x16x32_bf16 v[88:91], v[196:199], v[136:139], v[88:91]
  ds_read_b128 v[220:223], v235 offset:45056
  s_waitcnt lgkmcnt(5)
  v_mfma_f32_16x16x32_bf16 v[88:91], v[200:203], v[144:147], v[88:91]
  v_max3_f32 v250, v250, v76, v77
  s_waitcnt lgkmcnt(4)
  v_mfma_f32_16x16x32_bf16 v[88:91], v[204:207], v[152:155], v[88:91]
  s_waitcnt lgkmcnt(3)
  v_mfma_f32_16x16x32_bf16 v[92:95], v[208:211], v[128:131], 0
  s_waitcnt lgkmcnt(2)
  v_mfma_f32_16x16x32_bf16 v[92:95], v[212:215], v[136:139], v[92:95]
  v_max3_f32 v250, v250, v78, v79
  s_waitcnt lgkmcnt(1)
  v_mfma_f32_16x16x32_bf16 v[92:95], v[216:219], v[144:147], v[92:95]
  s_waitcnt lgkmcnt(0)
  v_mfma_f32_16x16x32_bf16 v[92:95], v[220:223], v[152:155], v[92:95]
  s_barrier
  ds_read_b128 v[192:195], v232 offset:49152
  ds_read_b128 v[196:199], v233 offset:49152
  ds_read_b128 v[200:203], v234 offset:49152
  ds_read_b128 v[204:207], v235 offset:49152
  ds_read_b128 v[208:211], v232 offset:53248
  ds_read_b128 v[212:215], v233 offset:53248
  s_waitcnt lgkmcnt(5)
  v_mfma_f32_16x16x32_bf16 v[96:99], v[192:195], v[128:131], 0
  ds_read_b128 v[216:219], v234 offset:53248
  v_max3_f32 v250, v250, v80, v81
  s_waitcnt lgkmcnt(5)
  v_mfma_f32_16x16x32_bf16 v[96:99], v[196:199], v[136:139], v[96:99]
  ds_read_b128 v[220:223], v235 offset:53248
  s_waitcnt lgkmcnt(5)
  v_mfma_f32_16x16x32_bf16 v[96:99], v[200:203], v[144:147], v[96:99]
  v_max3_f32 v250, v250, v82, v83
  ds_read_b128 v[192:195], v232 offset:57344
  s_waitcnt lgkmcnt(5)
  v_mfma_f32_16x16x32_bf16 v[96:99], v[204:207], v[152:155], v[96:99]
  ds_read_b128 v[196:199], v233 offset:57344
  v_max3_f32 v250, v250, v84, v85
  s_waitcnt lgkmcnt(5)
  v_mfma_f32_16x16x32_bf16 v[100:103], v[208:211], v[128:131], 0
  ds_read_b128 v[200:203], v234 offset:57344
  s_waitcnt lgkmcnt(5)
  v_mfma_f32_16x16x32_bf16 v[100:103], v[212:215], v[136:139], v[100:103]
  v_max3_f32 v250, v250, v86, v87
  ds_read_b128 v[204:207], v235 offset:57344
  s_waitcnt lgkmcnt(5)
  v_mfma_f32_16x16x32_bf16 v[100:103], v[216:219], v[144:147], v[100:103]
  ds_read_b128 v[208:211], v232 offset:61440
  s_waitcnt lgkmcnt(5)
  v_mfma_f32_16x16x32_bf16 v[100:103], v[220:223], v[152:155], v[100:103]
  v_max3_f32 v250, v250, v88, v89
  ds_read_b128 v[212:215], v233 offset:61440
  s_waitcnt lgkmcnt(5)
  v_mfma_f32_16x16x32_bf16 v[104:107], v[192:195], v[128:131], 0
  ds_read_b128 v[216:219], v234 offset:61440
  v_max3_f32 v250, v250, v90, v91
  s_waitcnt lgkmcnt(5)
  v_mfma_f32_16x16x32_bf16 v[104:107], v[196:199], v[136:139], v[104:107]
  ds_read_b128 v[220:223], v235 offset:61440
  s_waitcnt lgkmcnt(5)
  v_mfma_f32_16x16x32_bf16 v[104:107], v[200:203], v[144:147], v[104:107]
  v_max3_f32 v250, v250, v92, v93
  s_waitcnt lgkmcnt(4)
  v_mfma_f32_16x16x32_bf16 v[104:107], v[204:207], v[152:155], v[104:107]
  s_waitcnt lgkmcnt(3)
  v_mfma_f32_16x16x32_bf16 v[108:111], v[208:211], v[128:131], 0
  s_waitcnt lgkmcnt(2)
  v_mfma_f32_16x16x32_bf16 v[108:111], v[212:215], v[136:139], v[108:111]
  v_max3_f32 v250, v250, v94, v95
  s_waitcnt lgkmcnt(1)
  v_mfma_f32_16x16x32_bf16 v[108:111], v[216:219], v[144:147], v[108:111]
  s_waitcnt lgkmcnt(0)
  v_mfma_f32_16x16x32_bf16 v[108:111], v[220:223], v[152:155], v[108:111]
  s_barrier
  v_add_u32 v232, 131072, v232
  v_add_u32 v233, 131072, v233
  v_add_u32 v234, 131072, v234
  v_add_u32 v235, 131072, v235
  ds_read_b128 v[192:195], v232 offset:16384
  ds_read_b128 v[196:199], v233 offset:16384
  ds_read_b128 v[200:203], v234 offset:16384
  ds_read_b128 v[204:207], v235 offset:16384
  ds_read_b128 v[208:211], v232 offset:20480
  ds_read_b128 v[212:215], v233 offset:20480
  s_waitcnt lgkmcnt(5)
  v_mfma_f32_16x16x32_bf16 v[112:115], v[192:195], v[128:131], 0
  ds_read_b128 v[216:219], v234 offset:20480
  v_max3_f32 v250, v250, v96, v97
  s_waitcnt lgkmcnt(5)
  v_mfma_f32_16x16x32_bf16 v[112:115], v[196:199], v[136:139], v[112:115]
  ds_read_b128 v[220:223], v235 offset:20480
  s_waitcnt lgkmcnt(5)
  v_mfma_f32_16x16x32_bf16 v[112:115], v[200:203], v[144:147], v[112:115]
  v_max3_f32 v250, v250, v98, v99
  ds_read_b128 v[192:195], v232 offset:24576
  s_waitcnt lgkmcnt(5)
  v_mfma_f32_16x16x32_bf16 v[112:115], v[204:207], v[152:155], v[112:115]
  ds_read_b128 v[196:199], v233 offset:24576
  v_max3_f32 v250, v250, v100, v101
  s_waitcnt lgkmcnt(5)
  v_mfma_f32_16x16x32_bf16 v[116:119], v[208:211], v[128:131], 0
  ds_read_b128 v[200:203], v234 offset:24576
  s_waitcnt lgkmcnt(5)
  v_mfma_f32_16x16x32_bf16 v[116:119], v[212:215], v[136:139], v[116:119]
  v_max3_f32 v250, v250, v102, v103
  ds_read_b128 v[204:207], v235 offset:24576
  s_waitcnt lgkmcnt(5)
  v_mfma_f32_16x16x32_bf16 v[116:119], v[216:219], v[144:147], v[116:119]
  ds_read_b128 v[208:211], v232 offset:28672
  s_waitcnt lgkmcnt(5)
  v_mfma_f32_16x16x32_bf16 v[116:119], v[220:223], v[152:155], v[116:119]
  v_max3_f32 v250, v250, v104, v105
  ds_read_b128 v[212:215], v233 offset:28672
  s_waitcnt lgkmcnt(5)
  v_mfma_f32_16x16x32_bf16 v[120:123], v[192:195], v[128:131], 0
  ds_read_b128 v[216:219], v234 offset:28672
  v_max3_f32 v250, v250, v106, v107
  s_waitcnt lgkmcnt(5)
  v_mfma_f32_16x16x32_bf16 v[120:123], v[196:199], v[136:139], v[120:123]
  ds_read_b128 v[220:223], v235 offset:28672
  s_waitcnt lgkmcnt(5)
  v_mfma_f32_16x16x32_bf16 v[120:123], v[200:203], v[144:147], v[120:123]
  v_max3_f32 v250, v250, v108, v109
  s_waitcnt lgkmcnt(4)
  v_mfma_f32_16x16x32_bf16 v[120:123], v[204:207], v[152:155], v[120:123]
  s_waitcnt lgkmcnt(3)
  v_mfma_f32_16x16x32_bf16 v[124:127], v[208:211], v[128:131], 0
  s_waitcnt lgkmcnt(2)
  v_mfma_f32_16x16x32_bf16 v[124:127], v[212:215], v[136:139], v[124:127]
  v_max3_f32 v250, v250, v110, v111
  s_waitcnt lgkmcnt(1)
  v_mfma_f32_16x16x32_bf16 v[124:127], v[216:219], v[144:147], v[124:127]
  s_waitcnt lgkmcnt(0)
  v_mfma_f32_16x16x32_bf16 v[124:127], v[220:223], v[152:155], v[124:127]
  s_barrier
  v_add_u32 v236, 65536, v236
  v_add_u32 v237, 65536, v237
  v_add_u32 v238, 65536, v238
  v_add_u32 v239, 65536, v239
  v_add_u32 v240, 65536, v240
  v_add_u32 v241, 65536, v241
  v_add_u32 v242, 65536, v242
  v_add_u32 v243, 65536, v243
  ds_read_b64_tr_b16 v[192:193], v236 offset:49152
  ds_read_b64_tr_b16 v[194:195], v236 offset:53248
  ds_read_b64_tr_b16 v[196:197], v237 offset:49152
  ds_read_b64_tr_b16 v[198:199], v237 offset:53248
  ds_read_b64_tr_b16 v[200:201], v238 offset:49152
  ds_read_b64_tr_b16 v[202:203], v238 offset:53248
  ds_read_b64_tr_b16 v[204:205], v239 offset:49152
  ds_read_b64_tr_b16 v[206:207], v239 offset:53248
  ds_read_b64_tr_b16 v[208:209], v240 offset:49152
  ds_read_b64_tr_b16 v[210:211], v240 offset:53248
  ds_read_b64_tr_b16 v[212:213], v241 offset:49152
  ds_read_b64_tr_b16 v[214:215], v241 offset:53248
  v_max3_f32 v250, v250, v112, v113
  v_max3_f32 v250, v250, v114, v115
  v_max3_f32 v250, v250, v116, v117
  v_max3_f32 v250, v250, v118, v119
  v_max3_f32 v250, v250, v120, v121
  v_max3_f32 v250, v250, v122, v123
  v_max3_f32 v250, v250, v124, v125
  v_max3_f32 v250, v250, v126, v127
  v_mov_b32 v251, v250
  s_nop 1
  v_permlane32_swap_b32 v250, v251
  v_max_f32 v250, v250, v251
  v_mov_b32 v251, v250
  s_nop 1
  v_permlane16_swap_b32 v250, v251
  v_max_f32 v250, v250, v251
  v_mul_f32 v252, s40, v250
  v_fma_f32 v0, v0, s40, -v252
  v_fma_f32 v1, v1, s40, -v252
  v_fma_f32 v2, v2, s40, -v252
  v_fma_f32 v3, v3, s40, -v252
  v_fma_f32 v4, v4, s40, -v252
  v_fma_f32 v5, v5, s40, -v252
  v_fma_f32 v6, v6, s40, -v252
  v_fma_f32 v7, v7, s40, -v252
  v_exp_f32 v0, v0
  v_exp_f32 v1, v1
  v_exp_f32 v2, v2
  v_exp_f32 v3, v3
  v_exp_f32 v4, v4
  v_exp_f32 v5, v5
  v_exp_f32 v6, v6
  v_exp_f32 v7, v7
  v_cvt_pk_bf16_f32 v0, v0, v1
  v_cvt_pk_bf16_f32 v1, v2, v3
  v_cvt_pk_bf16_f32 v2, v4, v5
  v_cvt_pk_bf16_f32 v3, v6, v7
  v_fma_f32 v8, v8, s40, -v252
  v_fma_f32 v9, v9, s40, -v252
  v_fma_f32 v10, v10, s40, -v252
  v_fma_f32 v11, v11, s40, -v252
  v_fma_f32 v12, v12, s40, -v252
  v_fma_f32 v13, v13, s40, -v252
  v_fma_f32 v14, v14, s40, -v252
  v_fma_f32 v15, v15, s40, -v252
  v_exp_f32 v8, v8
  v_exp_f32 v9, v9
  v_exp_f32 v10, v10
  v_exp_f32 v11, v11
  v_exp_f32 v12, v12
  v_exp_f32 v13, v13
  v_exp_f32 v14, v14
  v_exp_f32 v15, v15
  v_cvt_pk_bf16_f32 v8, v8, v9
  v_cvt_pk_bf16_f32 v9, v10, v11
  v_cvt_pk_bf16_f32 v10, v12, v13
  v_cvt_pk_bf16_f32 v11, v14, v15
  v_fma_f32 v16, v16, s40, -v252
  s_waitcnt lgkmcnt(10)
  v_mfma_f32_16x16x32_bf16 v[132:135], v[192:195], v[0:3], 0
  v_fma_f32 v17, v17, s40, -v252
  ds_read_b64_tr_b16 v[216:217], v242 offset:49152
  v_fma_f32 v18, v18, s40, -v252
  ds_read_b64_tr_b16 v[218:219], v242 offset:53248
  v_fma_f32 v19, v19, s40, -v252
  s_waitcnt lgkmcnt(10)
  v_mfma_f32_16x16x32_bf16 v[140:143], v[196:199], v[0:3], 0
  v_fma_f32 v20, v20, s40, -v252
  ds_read_b64_tr_b16 v[220:221], v243 offset:49152
  v_fma_f32 v21, v21, s40, -v252
  ds_read_b64_tr_b16 v[222:223], v243 offset:53248
  v_fma_f32 v22, v22, s40, -v252
  s_waitcnt lgkmcnt(10)
  v_mfma_f32_16x16x32_bf16 v[148:151], v[200:203], v[0:3], 0
  v_fma_f32 v23, v23, s40, -v252
  ds_read_b64_tr_b16 v[192:193], v236 offset:57344
  v_exp_f32 v16, v16
  ds_read_b64_tr_b16 v[194:195], v236 offset:61440
  v_exp_f32 v17, v17
  s_waitcnt lgkmcnt(10)
  v_mfma_f32_16x16x32_bf16 v[156:159], v[204:207], v[0:3], 0
  v_exp_f32 v18, v18
  ds_read_b64_tr_b16 v[196:197], v237 offset:57344
  v_exp_f32 v19, v19
  ds_read_b64_tr_b16 v[198:199], v237 offset:61440
  v_exp_f32 v20, v20
  s_waitcnt lgkmcnt(10)
  v_mfma_f32_16x16x32_bf16 v[164:167], v[208:211], v[0:3], 0
  v_exp_f32 v21, v21
  ds_read_b64_tr_b16 v[200:201], v238 offset:57344
  v_exp_f32 v22, v22
  ds_read_b64_tr_b16 v[202:203], v238 offset:61440
  v_exp_f32 v23, v23
  s_waitcnt lgkmcnt(10)
  v_mfma_f32_16x16x32_bf16 v[172:175], v[212:215], v[0:3], 0
  v_cvt_pk_bf16_f32 v16, v16, v17
  ds_read_b64_tr_b16 v[204:205], v239 offset:57344
  v_cvt_pk_bf16_f32 v17, v18, v19
  ds_read_b64_tr_b16 v[206:207], v239 offset:61440
  v_cvt_pk_bf16_f32 v18, v20, v21
  s_waitcnt lgkmcnt(10)
  v_mfma_f32_16x16x32_bf16 v[180:183], v[216:219], v[0:3], 0
  v_cvt_pk_bf16_f32 v19, v22, v23
  v_fma_f32 v24, v24, s40, -v252
  ds_read_b64_tr_b16 v[208:209], v240 offset:57344
  v_fma_f32 v25, v25, s40, -v252
  ds_read_b64_tr_b16 v[210:211], v240 offset:61440
  v_fma_f32 v26, v26, s40, -v252
  s_waitcnt lgkmcnt(10)
  v_mfma_f32_16x16x32_bf16 v[188:191], v[220:223], v[0:3], 0
  v_fma_f32 v27, v27, s40, -v252
  v_mfma_f32_16x16x32_bf16 v[224:227], v[228:231], v[0:3], 0
  v_fma_f32 v28, v28, s40, -v252
  ds_read_b64_tr_b16 v[212:213], v241 offset:57344
  v_fma_f32 v29, v29, s40, -v252
  ds_read_b64_tr_b16 v[214:215], v241 offset:61440
  v_fma_f32 v30, v30, s40, -v252
  s_waitcnt lgkmcnt(10)
  v_mfma_f32_16x16x32_bf16 v[132:135], v[192:195], v[8:11], v[132:135]
  v_fma_f32 v31, v31, s40, -v252
  ds_read_b64_tr_b16 v[216:217], v242 offset:57344
  v_exp_f32 v24, v24
  ds_read_b64_tr_b16 v[218:219], v242 offset:61440
  v_exp_f32 v25, v25
  s_waitcnt lgkmcnt(10)
  v_mfma_f32_16x16x32_bf16 v[140:143], v[196:199], v[8:11], v[140:143]
  v_exp_f32 v26, v26
  ds_read_b64_tr_b16 v[220:221], v243 offset:57344
  v_exp_f32 v27, v27
  ds_read_b64_tr_b16 v[222:223], v243 offset:61440
  v_exp_f32 v28, v28
  s_waitcnt lgkmcnt(10)
  v_mfma_f32_16x16x32_bf16 v[148:151], v[200:203], v[8:11], v[148:151]
  v_exp_f32 v29, v29
  s_waitcnt lgkmcnt(8)
  v_mfma_f32_16x16x32_bf16 v[156:159], v[204:207], v[8:11], v[156:159]
  v_exp_f32 v30, v30
  s_waitcnt lgkmcnt(6)
  v_mfma_f32_16x16x32_bf16 v[164:167], v[208:211], v[8:11], v[164:167]
  v_exp_f32 v31, v31
  s_waitcnt lgkmcnt(4)
  v_mfma_f32_16x16x32_bf16 v[172:175], v[212:215], v[8:11], v[172:175]
  v_cvt_pk_bf16_f32 v24, v24, v25
  s_waitcnt lgkmcnt(2)
  v_mfma_f32_16x16x32_bf16 v[180:183], v[216:219], v[8:11], v[180:183]
  v_cvt_pk_bf16_f32 v25, v26, v27
  s_waitcnt lgkmcnt(0)
  v_mfma_f32_16x16x32_bf16 v[188:191], v[220:223], v[8:11], v[188:191]
  v_cvt_pk_bf16_f32 v26, v28, v29
  v_mfma_f32_16x16x32_bf16 v[224:227], v[228:231], v[8:11], v[224:227]
  v_cvt_pk_bf16_f32 v27, v30, v31
  s_barrier
  v_add_u32 v236, 65536, v236
  v_add_u32 v237, 65536, v237
  v_add_u32 v238, 65536, v238
  v_add_u32 v239, 65536, v239
  v_add_u32 v240, 65536, v240
  v_add_u32 v241, 65536, v241
  v_add_u32 v242, 65536, v242
  v_add_u32 v243, 65536, v243
  ds_read_b64_tr_b16 v[192:193], v236 offset:0
  ds_read_b64_tr_b16 v[194:195], v236 offset:4096
  ds_read_b64_tr_b16 v[196:197], v237 offset:0
  ds_read_b64_tr_b16 v[198:199], v237 offset:4096
  ds_read_b64_tr_b16 v[200:201], v238 offset:0
  ds_read_b64_tr_b16 v[202:203], v238 offset:4096
  ds_read_b64_tr_b16 v[204:205], v239 offset:0
  ds_read_b64_tr_b16 v[206:207], v239 offset:4096
  ds_read_b64_tr_b16 v[208:209], v240 offset:0
  ds_read_b64_tr_b16 v[210:211], v240 offset:4096
  ds_read_b64_tr_b16 v[212:213], v241 offset:0
  ds_read_b64_tr_b16 v[214:215], v241 offset:4096
  v_fma_f32 v32, v32, s40, -v252
  s_waitcnt lgkmcnt(10)
  v_mfma_f32_16x16x32_bf16 v[132:135], v[192:195], v[16:19], v[132:135]
  v_fma_f32 v33, v33, s40, -v252
  ds_read_b64_tr_b16 v[216:217], v242 offset:0
  v_fma_f32 v34, v34, s40, -v252
  ds_read_b64_tr_b16 v[218:219], v242 offset:4096
  v_fma_f32 v35, v35, s40, -v252
  s_waitcnt lgkmcnt(10)
  v_mfma_f32_16x16x32_bf16 v[140:143], v[196:199], v[16:19], v[140:143]
  v_fma_f32 v36, v36, s40, -v252
  ds_read_b64_tr_b16 v[220:221], v243 offset:0
  v_fma_f32 v37, v37, s40, -v252
  ds_read_b64_tr_b16 v[222:223], v243 offset:4096
  v_fma_f32 v38, v38, s40, -v252
  s_waitcnt lgkmcnt(10)
  v_mfma_f32_16x16x32_bf16 v[148:151], v[200:203], v[16:19], v[148:151]
  v_fma_f32 v39, v39, s40, -v252
  ds_read_b64_tr_b16 v[192:193], v236 offset:8192
  v_exp_f32 v32, v32
  ds_read_b64_tr_b16 v[194:195], v236 offset:12288
  v_exp_f32 v33, v33
  s_waitcnt lgkmcnt(10)
  v_mfma_f32_16x16x32_bf16 v[156:159], v[204:207], v[16:19], v[156:159]
  v_exp_f32 v34, v34
  ds_read_b64_tr_b16 v[196:197], v237 offset:8192
  v_exp_f32 v35, v35
  ds_read_b64_tr_b16 v[198:199], v237 offset:12288
  v_exp_f32 v36, v36
  s_waitcnt lgkmcnt(10)
  v_mfma_f32_16x16x32_bf16 v[164:167], v[208:211], v[16:19], v[164:167]
  v_exp_f32 v37, v37
  ds_read_b64_tr_b16 v[200:201], v238 offset:8192
  v_exp_f32 v38, v38
  ds_read_b64_tr_b16 v[202:203], v238 offset:12288
  v_exp_f32 v39, v39
  s_waitcnt lgkmcnt(10)
  v_mfma_f32_16x16x32_bf16 v[172:175], v[212:215], v[16:19], v[172:175]
  v_cvt_pk_bf16_f32 v32, v32, v33
  ds_read_b64_tr_b16 v[204:205], v239 offset:8192
  v_cvt_pk_bf16_f32 v33, v34, v35
  ds_read_b64_tr_b16 v[206:207], v239 offset:12288
  v_cvt_pk_bf16_f32 v34, v36, v37
  s_waitcnt lgkmcnt(10)
  v_mfma_f32_16x16x32_bf16 v[180:183], v[216:219], v[16:19], v[180:183]
  v_cvt_pk_bf16_f32 v35, v38, v39
  v_fma_f32 v40, v40, s40, -v252
  ds_read_b64_tr_b16 v[208:209], v240 offset:8192
  v_fma_f32 v41, v41, s40, -v252
  ds_read_b64_tr_b16 v[210:211], v240 offset:12288
  v_fma_f32 v42, v42, s40, -v252
  s_waitcnt lgkmcnt(10)
  v_mfma_f32_16x16x32_bf16 v[188:191], v[220:223], v[16:19], v[188:191]
  v_fma_f32 v43, v43, s40, -v252
  v_mfma_f32_16x16x32_bf16 v[224:227], v[228:231], v[16:19], v[224:227]
  v_fma_f32 v44, v44, s40, -v252
  ds_read_b64_tr_b16 v[212:213], v241 offset:8192
  v_fma_f32 v45, v45, s40, -v252
  ds_read_b64_tr_b16 v[214:215], v241 offset:12288
  v_fma_f32 v46, v46, s40, -v252
  s_waitcnt lgkmcnt(10)
  v_mfma_f32_16x16x32_bf16 v[132:135], v[192:195], v[24:27], v[132:135]
  v_fma_f32 v47, v47, s40, -v252
  ds_read_b64_tr_b16 v[216:217], v242 offset:8192
  v_exp_f32 v40, v40
  ds_read_b64_tr_b16 v[218:219], v242 offset:12288
  v_exp_f32 v41, v41
  s_waitcnt lgkmcnt(10)
  v_mfma_f32_16x16x32_bf16 v[140:143], v[196:199], v[24:27], v[140:143]
  v_exp_f32 v42, v42
  ds_read_b64_tr_b16 v[220:221], v243 offset:8192
  v_exp_f32 v43, v43
  ds_read_b64_tr_b16 v[222:223], v243 offset:12288
  v_exp_f32 v44, v44
  s_waitcnt lgkmcnt(10)
  v_mfma_f32_16x16x32_bf16 v[148:151], v[200:203], v[24:27], v[148:151]
  v_exp_f32 v45, v45
  s_waitcnt lgkmcnt(8)
  v_mfma_f32_16x16x32_bf16 v[156:159], v[204:207], v[24:27], v[156:159]
  v_exp_f32 v46, v46
  s_waitcnt lgkmcnt(6)
  v_mfma_f32_16x16x32_bf16 v[164:167], v[208:211], v[24:27], v[164:167]
  v_exp_f32 v47, v47
  s_waitcnt lgkmcnt(4)
  v_mfma_f32_16x16x32_bf16 v[172:175], v[212:215], v[24:27], v[172:175]
  v_cvt_pk_bf16_f32 v40, v40, v41
  s_waitcnt lgkmcnt(2)
  v_mfma_f32_16x16x32_bf16 v[180:183], v[216:219], v[24:27], v[180:183]
  v_cvt_pk_bf16_f32 v41, v42, v43
  s_waitcnt lgkmcnt(0)
  v_mfma_f32_16x16x32_bf16 v[188:191], v[220:223], v[24:27], v[188:191]
  v_cvt_pk_bf16_f32 v42, v44, v45
  v_mfma_f32_16x16x32_bf16 v[224:227], v[228:231], v[24:27], v[224:227]
  v_cvt_pk_bf16_f32 v43, v46, v47
  s_barrier
  v_subrev_u32 v236, 65536, v236
  v_subrev_u32 v237, 65536, v237
  v_subrev_u32 v238, 65536, v238
  v_subrev_u32 v239, 65536, v239
  v_subrev_u32 v240, 65536, v240
  v_subrev_u32 v241, 65536, v241
  v_subrev_u32 v242, 65536, v242
  v_subrev_u32 v243, 65536, v243
  ds_read_b64_tr_b16 v[192:193], v236 offset:0
  ds_read_b64_tr_b16 v[194:195], v236 offset:4096
  ds_read_b64_tr_b16 v[196:197], v237 offset:0
  ds_read_b64_tr_b16 v[198:199], v237 offset:4096
  ds_read_b64_tr_b16 v[200:201], v238 offset:0
  ds_read_b64_tr_b16 v[202:203], v238 offset:4096
  ds_read_b64_tr_b16 v[204:205], v239 offset:0
  ds_read_b64_tr_b16 v[206:207], v239 offset:4096
  ds_read_b64_tr_b16 v[208:209], v240 offset:0
  ds_read_b64_tr_b16 v[210:211], v240 offset:4096
  ds_read_b64_tr_b16 v[212:213], v241 offset:0
  ds_read_b64_tr_b16 v[214:215], v241 offset:4096
  v_fma_f32 v48, v48, s40, -v252
  s_waitcnt lgkmcnt(10)
  v_mfma_f32_16x16x32_bf16 v[132:135], v[192:195], v[32:35], v[132:135]
  v_fma_f32 v49, v49, s40, -v252
  ds_read_b64_tr_b16 v[216:217], v242 offset:0
  v_fma_f32 v50, v50, s40, -v252
  ds_read_b64_tr_b16 v[218:219], v242 offset:4096
  v_fma_f32 v51, v51, s40, -v252
  s_waitcnt lgkmcnt(10)
  v_mfma_f32_16x16x32_bf16 v[140:143], v[196:199], v[32:35], v[140:143]
  v_fma_f32 v52, v52, s40, -v252
  ds_read_b64_tr_b16 v[220:221], v243 offset:0
  v_fma_f32 v53, v53, s40, -v252
  ds_read_b64_tr_b16 v[222:223], v243 offset:4096
  v_fma_f32 v54, v54, s40, -v252
  s_waitcnt lgkmcnt(10)
  v_mfma_f32_16x16x32_bf16 v[148:151], v[200:203], v[32:35], v[148:151]
  v_fma_f32 v55, v55, s40, -v252
  ds_read_b64_tr_b16 v[192:193], v236 offset:8192
  v_exp_f32 v48, v48
  ds_read_b64_tr_b16 v[194:195], v236 offset:12288
  v_exp_f32 v49, v49
  s_waitcnt lgkmcnt(10)
  v_mfma_f32_16x16x32_bf16 v[156:159], v[204:207], v[32:35], v[156:159]
  v_exp_f32 v50, v50
  ds_read_b64_tr_b16 v[196:197], v237 offset:8192
  v_exp_f32 v51, v51
  ds_read_b64_tr_b16 v[198:199], v237 offset:12288
  v_exp_f32 v52, v52
  s_waitcnt lgkmcnt(10)
  v_mfma_f32_16x16x32_bf16 v[164:167], v[208:211], v[32:35], v[164:167]
  v_exp_f32 v53, v53
  ds_read_b64_tr_b16 v[200:201], v238 offset:8192
  v_exp_f32 v54, v54
  ds_read_b64_tr_b16 v[202:203], v238 offset:12288
  v_exp_f32 v55, v55
  s_waitcnt lgkmcnt(10)
  v_mfma_f32_16x16x32_bf16 v[172:175], v[212:215], v[32:35], v[172:175]
  v_cvt_pk_bf16_f32 v48, v48, v49
  ds_read_b64_tr_b16 v[204:205], v239 offset:8192
  v_cvt_pk_bf16_f32 v49, v50, v51
  ds_read_b64_tr_b16 v[206:207], v239 offset:12288
  v_cvt_pk_bf16_f32 v50, v52, v53
  s_waitcnt lgkmcnt(10)
  v_mfma_f32_16x16x32_bf16 v[180:183], v[216:219], v[32:35], v[180:183]
  v_cvt_pk_bf16_f32 v51, v54, v55
  v_fma_f32 v56, v56, s40, -v252
  ds_read_b64_tr_b16 v[208:209], v240 offset:8192
  v_fma_f32 v57, v57, s40, -v252
  ds_read_b64_tr_b16 v[210:211], v240 offset:12288
  v_fma_f32 v58, v58, s40, -v252
  s_waitcnt lgkmcnt(10)
  v_mfma_f32_16x16x32_bf16 v[188:191], v[220:223], v[32:35], v[188:191]
  v_fma_f32 v59, v59, s40, -v252
  v_mfma_f32_16x16x32_bf16 v[224:227], v[228:231], v[32:35], v[224:227]
  v_fma_f32 v60, v60, s40, -v252
  ds_read_b64_tr_b16 v[212:213], v241 offset:8192
  v_fma_f32 v61, v61, s40, -v252
  ds_read_b64_tr_b16 v[214:215], v241 offset:12288
  v_fma_f32 v62, v62, s40, -v252
  s_waitcnt lgkmcnt(10)
  v_mfma_f32_16x16x32_bf16 v[132:135], v[192:195], v[40:43], v[132:135]
  v_fma_f32 v63, v63, s40, -v252
  ds_read_b64_tr_b16 v[216:217], v242 offset:8192
  v_exp_f32 v56, v56
  ds_read_b64_tr_b16 v[218:219], v242 offset:12288
  v_exp_f32 v57, v57
  s_waitcnt lgkmcnt(10)
  v_mfma_f32_16x16x32_bf16 v[140:143], v[196:199], v[40:43], v[140:143]
  v_exp_f32 v58, v58
  ds_read_b64_tr_b16 v[220:221], v243 offset:8192
  v_exp_f32 v59, v59
  ds_read_b64_tr_b16 v[222:223], v243 offset:12288
  v_exp_f32 v60, v60
  s_waitcnt lgkmcnt(10)
  v_mfma_f32_16x16x32_bf16 v[148:151], v[200:203], v[40:43], v[148:151]
  v_exp_f32 v61, v61
  s_waitcnt lgkmcnt(8)
  v_mfma_f32_16x16x32_bf16 v[156:159], v[204:207], v[40:43], v[156:159]
  v_exp_f32 v62, v62
  s_waitcnt lgkmcnt(6)
  v_mfma_f32_16x16x32_bf16 v[164:167], v[208:211], v[40:43], v[164:167]
  v_exp_f32 v63, v63
  s_waitcnt lgkmcnt(4)
  v_mfma_f32_16x16x32_bf16 v[172:175], v[212:215], v[40:43], v[172:175]
  v_cvt_pk_bf16_f32 v56, v56, v57
  s_waitcnt lgkmcnt(2)
  v_mfma_f32_16x16x32_bf16 v[180:183], v[216:219], v[40:43], v[180:183]
  v_cvt_pk_bf16_f32 v57, v58, v59
  s_waitcnt lgkmcnt(0)
  v_mfma_f32_16x16x32_bf16 v[188:191], v[220:223], v[40:43], v[188:191]
  v_cvt_pk_bf16_f32 v58, v60, v61
  v_mfma_f32_16x16x32_bf16 v[224:227], v[228:231], v[40:43], v[224:227]
  v_cvt_pk_bf16_f32 v59, v62, v63
  s_barrier
  s_movk_i32 s98, 4608
  buffer_load_dwordx2 v[246:247], v249, s[68:71], s98 offen sc1
  ds_read_b64_tr_b16 v[192:193], v236 offset:16384
  ds_read_b64_tr_b16 v[194:195], v236 offset:20480
  ds_read_b64_tr_b16 v[196:197], v237 offset:16384
  ds_read_b64_tr_b16 v[198:199], v237 offset:20480
  ds_read_b64_tr_b16 v[200:201], v238 offset:16384
  ds_read_b64_tr_b16 v[202:203], v238 offset:20480
  ds_read_b64_tr_b16 v[204:205], v239 offset:16384
  ds_read_b64_tr_b16 v[206:207], v239 offset:20480
  ds_read_b64_tr_b16 v[208:209], v240 offset:16384
  ds_read_b64_tr_b16 v[210:211], v240 offset:20480
  ds_read_b64_tr_b16 v[212:213], v241 offset:16384
  ds_read_b64_tr_b16 v[214:215], v241 offset:20480
  v_fma_f32 v64, v64, s40, -v252
  s_waitcnt lgkmcnt(10)
  v_mfma_f32_16x16x32_bf16 v[132:135], v[192:195], v[48:51], v[132:135]
  v_fma_f32 v65, v65, s40, -v252
  ds_read_b64_tr_b16 v[216:217], v242 offset:16384
  v_fma_f32 v66, v66, s40, -v252
  ds_read_b64_tr_b16 v[218:219], v242 offset:20480
  v_fma_f32 v67, v67, s40, -v252
  s_waitcnt lgkmcnt(10)
  v_mfma_f32_16x16x32_bf16 v[140:143], v[196:199], v[48:51], v[140:143]
  v_fma_f32 v68, v68, s40, -v252
  ds_read_b64_tr_b16 v[220:221], v243 offset:16384
  v_fma_f32 v69, v69, s40, -v252
  ds_read_b64_tr_b16 v[222:223], v243 offset:20480
  v_fma_f32 v70, v70, s40, -v252
  s_waitcnt lgkmcnt(10)
  v_mfma_f32_16x16x32_bf16 v[148:151], v[200:203], v[48:51], v[148:151]
  v_fma_f32 v71, v71, s40, -v252
  ds_read_b64_tr_b16 v[192:193], v236 offset:24576
  v_exp_f32 v64, v64
  ds_read_b64_tr_b16 v[194:195], v236 offset:28672
  v_exp_f32 v65, v65
  s_waitcnt lgkmcnt(10)
  v_mfma_f32_16x16x32_bf16 v[156:159], v[204:207], v[48:51], v[156:159]
  v_exp_f32 v66, v66
  ds_read_b64_tr_b16 v[196:197], v237 offset:24576
  v_exp_f32 v67, v67
  ds_read_b64_tr_b16 v[198:199], v237 offset:28672
  v_exp_f32 v68, v68
  s_waitcnt lgkmcnt(10)
  v_mfma_f32_16x16x32_bf16 v[164:167], v[208:211], v[48:51], v[164:167]
  v_exp_f32 v69, v69
  ds_read_b64_tr_b16 v[200:201], v238 offset:24576
  v_exp_f32 v70, v70
  ds_read_b64_tr_b16 v[202:203], v238 offset:28672
  v_exp_f32 v71, v71
  s_waitcnt lgkmcnt(10)
  v_mfma_f32_16x16x32_bf16 v[172:175], v[212:215], v[48:51], v[172:175]
  v_cvt_pk_bf16_f32 v64, v64, v65
  ds_read_b64_tr_b16 v[204:205], v239 offset:24576
  v_cvt_pk_bf16_f32 v65, v66, v67
  ds_read_b64_tr_b16 v[206:207], v239 offset:28672
  v_cvt_pk_bf16_f32 v66, v68, v69
  s_waitcnt lgkmcnt(10)
  v_mfma_f32_16x16x32_bf16 v[180:183], v[216:219], v[48:51], v[180:183]
  v_cvt_pk_bf16_f32 v67, v70, v71
  v_fma_f32 v72, v72, s40, -v252
  ds_read_b64_tr_b16 v[208:209], v240 offset:24576
  v_fma_f32 v73, v73, s40, -v252
  ds_read_b64_tr_b16 v[210:211], v240 offset:28672
  v_fma_f32 v74, v74, s40, -v252
  s_waitcnt lgkmcnt(10)
  v_mfma_f32_16x16x32_bf16 v[188:191], v[220:223], v[48:51], v[188:191]
  v_fma_f32 v75, v75, s40, -v252
  v_mfma_f32_16x16x32_bf16 v[224:227], v[228:231], v[48:51], v[224:227]
  v_fma_f32 v76, v76, s40, -v252
  ds_read_b64_tr_b16 v[212:213], v241 offset:24576
  v_fma_f32 v77, v77, s40, -v252
  ds_read_b64_tr_b16 v[214:215], v241 offset:28672
  v_fma_f32 v78, v78, s40, -v252
  s_waitcnt lgkmcnt(10)
  v_mfma_f32_16x16x32_bf16 v[132:135], v[192:195], v[56:59], v[132:135]
  v_fma_f32 v79, v79, s40, -v252
  ds_read_b64_tr_b16 v[216:217], v242 offset:24576
  v_exp_f32 v72, v72
  ds_read_b64_tr_b16 v[218:219], v242 offset:28672
  v_exp_f32 v73, v73
  s_waitcnt lgkmcnt(10)
  v_mfma_f32_16x16x32_bf16 v[140:143], v[196:199], v[56:59], v[140:143]
  v_exp_f32 v74, v74
  ds_read_b64_tr_b16 v[220:221], v243 offset:24576
  v_exp_f32 v75, v75
  ds_read_b64_tr_b16 v[222:223], v243 offset:28672
  v_exp_f32 v76, v76
  s_waitcnt lgkmcnt(10)
  v_mfma_f32_16x16x32_bf16 v[148:151], v[200:203], v[56:59], v[148:151]
  v_exp_f32 v77, v77
  s_waitcnt lgkmcnt(8)
  v_mfma_f32_16x16x32_bf16 v[156:159], v[204:207], v[56:59], v[156:159]
  v_exp_f32 v78, v78
  s_waitcnt lgkmcnt(6)
  v_mfma_f32_16x16x32_bf16 v[164:167], v[208:211], v[56:59], v[164:167]
  v_exp_f32 v79, v79
  s_waitcnt lgkmcnt(4)
  v_mfma_f32_16x16x32_bf16 v[172:175], v[212:215], v[56:59], v[172:175]
  v_cvt_pk_bf16_f32 v72, v72, v73
  s_waitcnt lgkmcnt(2)
  v_mfma_f32_16x16x32_bf16 v[180:183], v[216:219], v[56:59], v[180:183]
  v_cvt_pk_bf16_f32 v73, v74, v75
  s_waitcnt lgkmcnt(0)
  v_mfma_f32_16x16x32_bf16 v[188:191], v[220:223], v[56:59], v[188:191]
  v_cvt_pk_bf16_f32 v74, v76, v77
  v_mfma_f32_16x16x32_bf16 v[224:227], v[228:231], v[56:59], v[224:227]
  v_cvt_pk_bf16_f32 v75, v78, v79
  s_barrier
  ds_read_b64_tr_b16 v[192:193], v236 offset:32768
  ds_read_b64_tr_b16 v[194:195], v236 offset:36864
  ds_read_b64_tr_b16 v[196:197], v237 offset:32768
  ds_read_b64_tr_b16 v[198:199], v237 offset:36864
  ds_read_b64_tr_b16 v[200:201], v238 offset:32768
  ds_read_b64_tr_b16 v[202:203], v238 offset:36864
  ds_read_b64_tr_b16 v[204:205], v239 offset:32768
  ds_read_b64_tr_b16 v[206:207], v239 offset:36864
  ds_read_b64_tr_b16 v[208:209], v240 offset:32768
  ds_read_b64_tr_b16 v[210:211], v240 offset:36864
  ds_read_b64_tr_b16 v[212:213], v241 offset:32768
  ds_read_b64_tr_b16 v[214:215], v241 offset:36864
  v_fma_f32 v80, v80, s40, -v252
  s_waitcnt lgkmcnt(10)
  v_mfma_f32_16x16x32_bf16 v[132:135], v[192:195], v[64:67], v[132:135]
  v_fma_f32 v81, v81, s40, -v252
  ds_read_b64_tr_b16 v[216:217], v242 offset:32768
  v_fma_f32 v82, v82, s40, -v252
  ds_read_b64_tr_b16 v[218:219], v242 offset:36864
  v_fma_f32 v83, v83, s40, -v252
  s_waitcnt lgkmcnt(10)
  v_mfma_f32_16x16x32_bf16 v[140:143], v[196:199], v[64:67], v[140:143]
  v_fma_f32 v84, v84, s40, -v252
  ds_read_b64_tr_b16 v[220:221], v243 offset:32768
  v_fma_f32 v85, v85, s40, -v252
  ds_read_b64_tr_b16 v[222:223], v243 offset:36864
  v_fma_f32 v86, v86, s40, -v252
  s_waitcnt lgkmcnt(10)
  v_mfma_f32_16x16x32_bf16 v[148:151], v[200:203], v[64:67], v[148:151]
  v_fma_f32 v87, v87, s40, -v252
  ds_read_b64_tr_b16 v[192:193], v236 offset:40960
  v_exp_f32 v80, v80
  ds_read_b64_tr_b16 v[194:195], v236 offset:45056
  v_exp_f32 v81, v81
  s_waitcnt lgkmcnt(10)
  v_mfma_f32_16x16x32_bf16 v[156:159], v[204:207], v[64:67], v[156:159]
  v_exp_f32 v82, v82
  ds_read_b64_tr_b16 v[196:197], v237 offset:40960
  v_exp_f32 v83, v83
  ds_read_b64_tr_b16 v[198:199], v237 offset:45056
  v_exp_f32 v84, v84
  s_waitcnt lgkmcnt(10)
  v_mfma_f32_16x16x32_bf16 v[164:167], v[208:211], v[64:67], v[164:167]
  v_exp_f32 v85, v85
  ds_read_b64_tr_b16 v[200:201], v238 offset:40960
  v_exp_f32 v86, v86
  ds_read_b64_tr_b16 v[202:203], v238 offset:45056
  v_exp_f32 v87, v87
  s_waitcnt lgkmcnt(10)
  v_mfma_f32_16x16x32_bf16 v[172:175], v[212:215], v[64:67], v[172:175]
  v_cvt_pk_bf16_f32 v80, v80, v81
  ds_read_b64_tr_b16 v[204:205], v239 offset:40960
  v_cvt_pk_bf16_f32 v81, v82, v83
  ds_read_b64_tr_b16 v[206:207], v239 offset:45056
  v_cvt_pk_bf16_f32 v82, v84, v85
  s_waitcnt lgkmcnt(10)
  v_mfma_f32_16x16x32_bf16 v[180:183], v[216:219], v[64:67], v[180:183]
  v_cvt_pk_bf16_f32 v83, v86, v87
  v_fma_f32 v88, v88, s40, -v252
  ds_read_b64_tr_b16 v[208:209], v240 offset:40960
  v_fma_f32 v89, v89, s40, -v252
  ds_read_b64_tr_b16 v[210:211], v240 offset:45056
  v_fma_f32 v90, v90, s40, -v252
  s_waitcnt lgkmcnt(10)
  v_mfma_f32_16x16x32_bf16 v[188:191], v[220:223], v[64:67], v[188:191]
  v_fma_f32 v91, v91, s40, -v252
  v_mfma_f32_16x16x32_bf16 v[224:227], v[228:231], v[64:67], v[224:227]
  v_fma_f32 v92, v92, s40, -v252
  ds_read_b64_tr_b16 v[212:213], v241 offset:40960
  v_fma_f32 v93, v93, s40, -v252
  ds_read_b64_tr_b16 v[214:215], v241 offset:45056
  v_fma_f32 v94, v94, s40, -v252
  s_waitcnt lgkmcnt(10)
  v_mfma_f32_16x16x32_bf16 v[132:135], v[192:195], v[72:75], v[132:135]
  v_fma_f32 v95, v95, s40, -v252
  ds_read_b64_tr_b16 v[216:217], v242 offset:40960
  v_exp_f32 v88, v88
  ds_read_b64_tr_b16 v[218:219], v242 offset:45056
  v_exp_f32 v89, v89
  s_waitcnt lgkmcnt(10)
  v_mfma_f32_16x16x32_bf16 v[140:143], v[196:199], v[72:75], v[140:143]
  v_exp_f32 v90, v90
  ds_read_b64_tr_b16 v[220:221], v243 offset:40960
  v_exp_f32 v91, v91
  ds_read_b64_tr_b16 v[222:223], v243 offset:45056
  v_exp_f32 v92, v92
  s_waitcnt lgkmcnt(10)
  v_mfma_f32_16x16x32_bf16 v[148:151], v[200:203], v[72:75], v[148:151]
  v_exp_f32 v93, v93
  s_waitcnt lgkmcnt(8)
  v_mfma_f32_16x16x32_bf16 v[156:159], v[204:207], v[72:75], v[156:159]
  v_exp_f32 v94, v94
  s_waitcnt lgkmcnt(6)
  v_mfma_f32_16x16x32_bf16 v[164:167], v[208:211], v[72:75], v[164:167]
  v_exp_f32 v95, v95
  s_waitcnt lgkmcnt(4)
  v_mfma_f32_16x16x32_bf16 v[172:175], v[212:215], v[72:75], v[172:175]
  v_cvt_pk_bf16_f32 v88, v88, v89
  s_waitcnt lgkmcnt(2)
  v_mfma_f32_16x16x32_bf16 v[180:183], v[216:219], v[72:75], v[180:183]
  v_cvt_pk_bf16_f32 v89, v90, v91
  s_waitcnt lgkmcnt(0)
  v_mfma_f32_16x16x32_bf16 v[188:191], v[220:223], v[72:75], v[188:191]
  v_cvt_pk_bf16_f32 v90, v92, v93
  v_mfma_f32_16x16x32_bf16 v[224:227], v[228:231], v[72:75], v[224:227]
  v_cvt_pk_bf16_f32 v91, v94, v95
  s_barrier
  v_subrev_u32 v236, 65536, v236
  v_subrev_u32 v237, 65536, v237
  v_subrev_u32 v238, 65536, v238
  v_subrev_u32 v239, 65536, v239
  v_subrev_u32 v240, 65536, v240
  v_subrev_u32 v241, 65536, v241
  v_subrev_u32 v242, 65536, v242
  v_subrev_u32 v243, 65536, v243
  ds_read_b64_tr_b16 v[192:193], v236 offset:0
  ds_read_b64_tr_b16 v[194:195], v236 offset:4096
  ds_read_b64_tr_b16 v[196:197], v237 offset:0
  ds_read_b64_tr_b16 v[198:199], v237 offset:4096
  ds_read_b64_tr_b16 v[200:201], v238 offset:0
  ds_read_b64_tr_b16 v[202:203], v238 offset:4096
  ds_read_b64_tr_b16 v[204:205], v239 offset:0
  ds_read_b64_tr_b16 v[206:207], v239 offset:4096
  ds_read_b64_tr_b16 v[208:209], v240 offset:0
  ds_read_b64_tr_b16 v[210:211], v240 offset:4096
  ds_read_b64_tr_b16 v[212:213], v241 offset:0
  ds_read_b64_tr_b16 v[214:215], v241 offset:4096
  v_fma_f32 v96, v96, s40, -v252
  s_waitcnt lgkmcnt(10)
  v_mfma_f32_16x16x32_bf16 v[132:135], v[192:195], v[80:83], v[132:135]
  v_fma_f32 v97, v97, s40, -v252
  ds_read_b64_tr_b16 v[216:217], v242 offset:0
  v_fma_f32 v98, v98, s40, -v252
  ds_read_b64_tr_b16 v[218:219], v242 offset:4096
  v_fma_f32 v99, v99, s40, -v252
  s_waitcnt lgkmcnt(10)
  v_mfma_f32_16x16x32_bf16 v[140:143], v[196:199], v[80:83], v[140:143]
  v_fma_f32 v100, v100, s40, -v252
  ds_read_b64_tr_b16 v[220:221], v243 offset:0
  v_fma_f32 v101, v101, s40, -v252
  ds_read_b64_tr_b16 v[222:223], v243 offset:4096
  v_fma_f32 v102, v102, s40, -v252
  s_waitcnt lgkmcnt(10)
  v_mfma_f32_16x16x32_bf16 v[148:151], v[200:203], v[80:83], v[148:151]
  v_fma_f32 v103, v103, s40, -v252
  ds_read_b64_tr_b16 v[192:193], v236 offset:8192
  v_exp_f32 v96, v96
  ds_read_b64_tr_b16 v[194:195], v236 offset:12288
  v_exp_f32 v97, v97
  s_waitcnt lgkmcnt(10)
  v_mfma_f32_16x16x32_bf16 v[156:159], v[204:207], v[80:83], v[156:159]
  v_exp_f32 v98, v98
  ds_read_b64_tr_b16 v[196:197], v237 offset:8192
  v_exp_f32 v99, v99
  ds_read_b64_tr_b16 v[198:199], v237 offset:12288
  v_exp_f32 v100, v100
  s_waitcnt lgkmcnt(10)
  v_mfma_f32_16x16x32_bf16 v[164:167], v[208:211], v[80:83], v[164:167]
  v_exp_f32 v101, v101
  ds_read_b64_tr_b16 v[200:201], v238 offset:8192
  v_exp_f32 v102, v102
  ds_read_b64_tr_b16 v[202:203], v238 offset:12288
  v_exp_f32 v103, v103
  s_waitcnt lgkmcnt(10)
  v_mfma_f32_16x16x32_bf16 v[172:175], v[212:215], v[80:83], v[172:175]
  v_cvt_pk_bf16_f32 v96, v96, v97
  ds_read_b64_tr_b16 v[204:205], v239 offset:8192
  v_cvt_pk_bf16_f32 v97, v98, v99
  ds_read_b64_tr_b16 v[206:207], v239 offset:12288
  v_cvt_pk_bf16_f32 v98, v100, v101
  s_waitcnt lgkmcnt(10)
  v_mfma_f32_16x16x32_bf16 v[180:183], v[216:219], v[80:83], v[180:183]
  v_cvt_pk_bf16_f32 v99, v102, v103
  v_fma_f32 v104, v104, s40, -v252
  ds_read_b64_tr_b16 v[208:209], v240 offset:8192
  v_fma_f32 v105, v105, s40, -v252
  ds_read_b64_tr_b16 v[210:211], v240 offset:12288
  v_fma_f32 v106, v106, s40, -v252
  s_waitcnt lgkmcnt(10)
  v_mfma_f32_16x16x32_bf16 v[188:191], v[220:223], v[80:83], v[188:191]
  v_fma_f32 v107, v107, s40, -v252
  v_mfma_f32_16x16x32_bf16 v[224:227], v[228:231], v[80:83], v[224:227]
  v_fma_f32 v108, v108, s40, -v252
  ds_read_b64_tr_b16 v[212:213], v241 offset:8192
  v_fma_f32 v109, v109, s40, -v252
  ds_read_b64_tr_b16 v[214:215], v241 offset:12288
  v_fma_f32 v110, v110, s40, -v252
  s_waitcnt lgkmcnt(10)
  v_mfma_f32_16x16x32_bf16 v[132:135], v[192:195], v[88:91], v[132:135]
  v_fma_f32 v111, v111, s40, -v252
  ds_read_b64_tr_b16 v[216:217], v242 offset:8192
  v_exp_f32 v104, v104
  ds_read_b64_tr_b16 v[218:219], v242 offset:12288
  v_exp_f32 v105, v105
  s_waitcnt lgkmcnt(10)
  v_mfma_f32_16x16x32_bf16 v[140:143], v[196:199], v[88:91], v[140:143]
  v_exp_f32 v106, v106
  ds_read_b64_tr_b16 v[220:221], v243 offset:8192
  v_exp_f32 v107, v107
  ds_read_b64_tr_b16 v[222:223], v243 offset:12288
  v_exp_f32 v108, v108
  s_waitcnt lgkmcnt(10)
  v_mfma_f32_16x16x32_bf16 v[148:151], v[200:203], v[88:91], v[148:151]
  v_exp_f32 v109, v109
  s_waitcnt lgkmcnt(8)
  v_mfma_f32_16x16x32_bf16 v[156:159], v[204:207], v[88:91], v[156:159]
  v_exp_f32 v110, v110
  s_waitcnt lgkmcnt(6)
  v_mfma_f32_16x16x32_bf16 v[164:167], v[208:211], v[88:91], v[164:167]
  v_exp_f32 v111, v111
  s_waitcnt lgkmcnt(4)
  v_mfma_f32_16x16x32_bf16 v[172:175], v[212:215], v[88:91], v[172:175]
  v_cvt_pk_bf16_f32 v104, v104, v105
  s_waitcnt lgkmcnt(2)
  v_mfma_f32_16x16x32_bf16 v[180:183], v[216:219], v[88:91], v[180:183]
  v_cvt_pk_bf16_f32 v105, v106, v107
  s_waitcnt lgkmcnt(0)
  v_mfma_f32_16x16x32_bf16 v[188:191], v[220:223], v[88:91], v[188:191]
  v_cvt_pk_bf16_f32 v106, v108, v109
  v_mfma_f32_16x16x32_bf16 v[224:227], v[228:231], v[88:91], v[224:227]
  v_cvt_pk_bf16_f32 v107, v110, v111
  s_barrier
  ds_read_b64_tr_b16 v[192:193], v236 offset:16384
  ds_read_b64_tr_b16 v[194:195], v236 offset:20480
  ds_read_b64_tr_b16 v[196:197], v237 offset:16384
  ds_read_b64_tr_b16 v[198:199], v237 offset:20480
  ds_read_b64_tr_b16 v[200:201], v238 offset:16384
  ds_read_b64_tr_b16 v[202:203], v238 offset:20480
  ds_read_b64_tr_b16 v[204:205], v239 offset:16384
  ds_read_b64_tr_b16 v[206:207], v239 offset:20480
  ds_read_b64_tr_b16 v[208:209], v240 offset:16384
  ds_read_b64_tr_b16 v[210:211], v240 offset:20480
  ds_read_b64_tr_b16 v[212:213], v241 offset:16384
  ds_read_b64_tr_b16 v[214:215], v241 offset:20480
  v_fma_f32 v112, v112, s40, -v252
  s_waitcnt lgkmcnt(10)
  v_mfma_f32_16x16x32_bf16 v[132:135], v[192:195], v[96:99], v[132:135]
  v_fma_f32 v113, v113, s40, -v252
  ds_read_b64_tr_b16 v[216:217], v242 offset:16384
  v_fma_f32 v114, v114, s40, -v252
  ds_read_b64_tr_b16 v[218:219], v242 offset:20480
  v_fma_f32 v115, v115, s40, -v252
  s_waitcnt lgkmcnt(10)
  v_mfma_f32_16x16x32_bf16 v[140:143], v[196:199], v[96:99], v[140:143]
  v_fma_f32 v116, v116, s40, -v252
  ds_read_b64_tr_b16 v[220:221], v243 offset:16384
  v_fma_f32 v117, v117, s40, -v252
  ds_read_b64_tr_b16 v[222:223], v243 offset:20480
  v_fma_f32 v118, v118, s40, -v252
  s_waitcnt lgkmcnt(10)
  v_mfma_f32_16x16x32_bf16 v[148:151], v[200:203], v[96:99], v[148:151]
  v_fma_f32 v119, v119, s40, -v252
  ds_read_b64_tr_b16 v[192:193], v236 offset:24576
  v_exp_f32 v112, v112
  ds_read_b64_tr_b16 v[194:195], v236 offset:28672
  v_exp_f32 v113, v113
  s_waitcnt lgkmcnt(10)
  v_mfma_f32_16x16x32_bf16 v[156:159], v[204:207], v[96:99], v[156:159]
  v_exp_f32 v114, v114
  ds_read_b64_tr_b16 v[196:197], v237 offset:24576
  v_exp_f32 v115, v115
  ds_read_b64_tr_b16 v[198:199], v237 offset:28672
  v_exp_f32 v116, v116
  s_waitcnt lgkmcnt(10)
  v_mfma_f32_16x16x32_bf16 v[164:167], v[208:211], v[96:99], v[164:167]
  v_exp_f32 v117, v117
  ds_read_b64_tr_b16 v[200:201], v238 offset:24576
  v_exp_f32 v118, v118
  ds_read_b64_tr_b16 v[202:203], v238 offset:28672
  v_exp_f32 v119, v119
  s_waitcnt lgkmcnt(10)
  v_mfma_f32_16x16x32_bf16 v[172:175], v[212:215], v[96:99], v[172:175]
  v_cvt_pk_bf16_f32 v112, v112, v113
  ds_read_b64_tr_b16 v[204:205], v239 offset:24576
  v_cvt_pk_bf16_f32 v113, v114, v115
  ds_read_b64_tr_b16 v[206:207], v239 offset:28672
  v_cvt_pk_bf16_f32 v114, v116, v117
  s_waitcnt lgkmcnt(10)
  v_mfma_f32_16x16x32_bf16 v[180:183], v[216:219], v[96:99], v[180:183]
  v_cvt_pk_bf16_f32 v115, v118, v119
  v_fma_f32 v120, v120, s40, -v252
  ds_read_b64_tr_b16 v[208:209], v240 offset:24576
  v_fma_f32 v121, v121, s40, -v252
  ds_read_b64_tr_b16 v[210:211], v240 offset:28672
  v_fma_f32 v122, v122, s40, -v252
  s_waitcnt lgkmcnt(10)
  v_mfma_f32_16x16x32_bf16 v[188:191], v[220:223], v[96:99], v[188:191]
  v_fma_f32 v123, v123, s40, -v252
  v_mfma_f32_16x16x32_bf16 v[224:227], v[228:231], v[96:99], v[224:227]
  v_fma_f32 v124, v124, s40, -v252
  ds_read_b64_tr_b16 v[212:213], v241 offset:24576
  v_fma_f32 v125, v125, s40, -v252
  ds_read_b64_tr_b16 v[214:215], v241 offset:28672
  v_fma_f32 v126, v126, s40, -v252
  s_waitcnt lgkmcnt(10)
  v_mfma_f32_16x16x32_bf16 v[132:135], v[192:195], v[104:107], v[132:135]
  v_fma_f32 v127, v127, s40, -v252
  ds_read_b64_tr_b16 v[216:217], v242 offset:24576
  v_exp_f32 v120, v120
  ds_read_b64_tr_b16 v[218:219], v242 offset:28672
  v_exp_f32 v121, v121
  s_waitcnt lgkmcnt(10)
  v_mfma_f32_16x16x32_bf16 v[140:143], v[196:199], v[104:107], v[140:143]
  v_exp_f32 v122, v122
  ds_read_b64_tr_b16 v[220:221], v243 offset:24576
  v_exp_f32 v123, v123
  ds_read_b64_tr_b16 v[222:223], v243 offset:28672
  v_exp_f32 v124, v124
  s_waitcnt lgkmcnt(10)
  v_mfma_f32_16x16x32_bf16 v[148:151], v[200:203], v[104:107], v[148:151]
  v_exp_f32 v125, v125
  s_waitcnt lgkmcnt(8)
  v_mfma_f32_16x16x32_bf16 v[156:159], v[204:207], v[104:107], v[156:159]
  v_exp_f32 v126, v126
  s_waitcnt lgkmcnt(6)
  v_mfma_f32_16x16x32_bf16 v[164:167], v[208:211], v[104:107], v[164:167]
  v_exp_f32 v127, v127
  s_waitcnt lgkmcnt(4)
  v_mfma_f32_16x16x32_bf16 v[172:175], v[212:215], v[104:107], v[172:175]
  v_cvt_pk_bf16_f32 v120, v120, v121
  s_waitcnt lgkmcnt(2)
  v_mfma_f32_16x16x32_bf16 v[180:183], v[216:219], v[104:107], v[180:183]
  v_cvt_pk_bf16_f32 v121, v122, v123
  s_waitcnt lgkmcnt(0)
  v_mfma_f32_16x16x32_bf16 v[188:191], v[220:223], v[104:107], v[188:191]
  v_cvt_pk_bf16_f32 v122, v124, v125
  v_mfma_f32_16x16x32_bf16 v[224:227], v[228:231], v[104:107], v[224:227]
  v_cvt_pk_bf16_f32 v123, v126, v127
  s_barrier
  ds_read_b64_tr_b16 v[192:193], v236 offset:32768
  ds_read_b64_tr_b16 v[194:195], v236 offset:36864
  ds_read_b64_tr_b16 v[196:197], v237 offset:32768
  ds_read_b64_tr_b16 v[198:199], v237 offset:36864
  ds_read_b64_tr_b16 v[200:201], v238 offset:32768
  ds_read_b64_tr_b16 v[202:203], v238 offset:36864
  ds_read_b64_tr_b16 v[204:205], v239 offset:32768
  ds_read_b64_tr_b16 v[206:207], v239 offset:36864
  ds_read_b64_tr_b16 v[208:209], v240 offset:32768
  ds_read_b64_tr_b16 v[210:211], v240 offset:36864
  ds_read_b64_tr_b16 v[212:213], v241 offset:32768
  ds_read_b64_tr_b16 v[214:215], v241 offset:36864
  s_waitcnt lgkmcnt(10)
  v_mfma_f32_16x16x32_bf16 v[132:135], v[192:195], v[112:115], v[132:135]
  ds_read_b64_tr_b16 v[216:217], v242 offset:32768
  ds_read_b64_tr_b16 v[218:219], v242 offset:36864
  s_waitcnt lgkmcnt(10)
  v_mfma_f32_16x16x32_bf16 v[140:143], v[196:199], v[112:115], v[140:143]
  ds_read_b64_tr_b16 v[220:221], v243 offset:32768
  ds_read_b64_tr_b16 v[222:223], v243 offset:36864
  s_waitcnt lgkmcnt(10)
  v_mfma_f32_16x16x32_bf16 v[148:151], v[200:203], v[112:115], v[148:151]
  ds_read_b64_tr_b16 v[192:193], v236 offset:40960
  ds_read_b64_tr_b16 v[194:195], v236 offset:45056
  s_waitcnt lgkmcnt(10)
  v_mfma_f32_16x16x32_bf16 v[156:159], v[204:207], v[112:115], v[156:159]
  ds_read_b64_tr_b16 v[196:197], v237 offset:40960
  ds_read_b64_tr_b16 v[198:199], v237 offset:45056
  s_waitcnt lgkmcnt(10)
  v_mfma_f32_16x16x32_bf16 v[164:167], v[208:211], v[112:115], v[164:167]
  ds_read_b64_tr_b16 v[200:201], v238 offset:40960
  ds_read_b64_tr_b16 v[202:203], v238 offset:45056
  s_waitcnt lgkmcnt(10)
  v_mfma_f32_16x16x32_bf16 v[172:175], v[212:215], v[112:115], v[172:175]
  ds_read_b64_tr_b16 v[204:205], v239 offset:40960
  ds_read_b64_tr_b16 v[206:207], v239 offset:45056
  s_waitcnt lgkmcnt(10)
  v_mfma_f32_16x16x32_bf16 v[180:183], v[216:219], v[112:115], v[180:183]
  ds_read_b64_tr_b16 v[208:209], v240 offset:40960
  ds_read_b64_tr_b16 v[210:211], v240 offset:45056
  s_waitcnt lgkmcnt(10)
  v_mfma_f32_16x16x32_bf16 v[188:191], v[220:223], v[112:115], v[188:191]
  v_mfma_f32_16x16x32_bf16 v[224:227], v[228:231], v[112:115], v[224:227]
  ds_read_b64_tr_b16 v[212:213], v241 offset:40960
  ds_read_b64_tr_b16 v[214:215], v241 offset:45056
  s_waitcnt lgkmcnt(10)
  v_mfma_f32_16x16x32_bf16 v[132:135], v[192:195], v[120:123], v[132:135]
  ds_read_b64_tr_b16 v[216:217], v242 offset:40960
  ds_read_b64_tr_b16 v[218:219], v242 offset:45056
  s_waitcnt lgkmcnt(10)
  v_mfma_f32_16x16x32_bf16 v[140:143], v[196:199], v[120:123], v[140:143]
  ds_read_b64_tr_b16 v[220:221], v243 offset:40960
  ds_read_b64_tr_b16 v[222:223], v243 offset:45056
  s_waitcnt lgkmcnt(10)
  v_mfma_f32_16x16x32_bf16 v[148:151], v[200:203], v[120:123], v[148:151]
  s_waitcnt lgkmcnt(8)
  v_mfma_f32_16x16x32_bf16 v[156:159], v[204:207], v[120:123], v[156:159]
  s_waitcnt lgkmcnt(6)
  v_mfma_f32_16x16x32_bf16 v[164:167], v[208:211], v[120:123], v[164:167]
  s_waitcnt lgkmcnt(4)
  v_mfma_f32_16x16x32_bf16 v[172:175], v[212:215], v[120:123], v[172:175]
  s_waitcnt lgkmcnt(2)
  v_mfma_f32_16x16x32_bf16 v[180:183], v[216:219], v[120:123], v[180:183]
  s_waitcnt lgkmcnt(0)
  v_mfma_f32_16x16x32_bf16 v[188:191], v[220:223], v[120:123], v[188:191]
  v_mfma_f32_16x16x32_bf16 v[224:227], v[228:231], v[120:123], v[224:227]
  s_barrier
  v_sub_u32 v251, v246, v254
  v_cmp_eq_u32 vcc, s49, v251
  v_cmp_eq_u32_e64 s[98:99], v247, v255
  s_nop 1
  s_and_b32 s98, s98, vcc_lo
  s_cmp_eq_u32 s98, -1
  s_cselect_b32 s67, 1, s67
  v_subrev_u32 v232, 131072, v232
  v_subrev_u32 v233, 131072, v233
  v_subrev_u32 v234, 131072, v234
  v_subrev_u32 v235, 131072, v235
  ds_read_b128 v[192:195], v232 offset:49152
  ds_read_b128 v[196:199], v233 offset:49152
  ds_read_b128 v[200:203], v234 offset:49152
  ds_read_b128 v[204:207], v235 offset:49152
  ds_read_b128 v[208:211], v232 offset:53248
  ds_read_b128 v[212:215], v233 offset:53248
  v_rcp_f32 v251, v224
  s_waitcnt lgkmcnt(5)
  v_mfma_f32_16x16x32_bf16 v[0:3], v[192:195], v[160:163], 0
  v_mul_f32 v132, v132, v251
  v_mul_f32 v133, v133, v251
  v_mul_f32 v134, v134, v251
  ds_read_b128 v[216:219], v234 offset:53248
  v_mul_f32 v135, v135, v251
  v_mul_f32 v140, v140, v251
  s_waitcnt lgkmcnt(5)
  v_mfma_f32_16x16x32_bf16 v[0:3], v[196:199], v[168:171], v[0:3]
  v_mul_f32 v141, v141, v251
  v_mul_f32 v142, v142, v251
  v_mul_f32 v143, v143, v251
  ds_read_b128 v[220:223], v235 offset:53248
  v_cvt_pk_bf16_f32 v132, v132, v133
  v_cvt_pk_bf16_f32 v133, v134, v135
  s_waitcnt lgkmcnt(5)
  v_mfma_f32_16x16x32_bf16 v[0:3], v[200:203], v[176:179], v[0:3]
  v_cvt_pk_bf16_f32 v134, v140, v141
  v_cvt_pk_bf16_f32 v135, v142, v143
  v_cndmask_b32_e64 v128, v132, v134, s[42:43]
  ds_read_b128 v[192:195], v232 offset:57344
  v_cndmask_b32_e64 v129, v133, v135, s[42:43]
  v_cndmask_b32_e64 v130, v134, v132, s[42:43]
  s_waitcnt lgkmcnt(5)
  v_mfma_f32_16x16x32_bf16 v[0:3], v[204:207], v[184:187], v[0:3]
  v_cndmask_b32_e64 v131, v135, v133, s[42:43]
  v_mul_f32 v148, v148, v251
  v_mul_f32 v149, v149, v251
  ds_read_b128 v[196:199], v233 offset:57344
  v_mul_f32 v150, v150, v251
  v_mul_f32 v151, v151, v251
  s_waitcnt lgkmcnt(5)
  v_mfma_f32_16x16x32_bf16 v[4:7], v[208:211], v[160:163], 0
  v_mul_f32 v156, v156, v251
  v_mul_f32 v157, v157, v251
  v_mul_f32 v158, v158, v251
  ds_read_b128 v[200:203], v234 offset:57344
  v_mul_f32 v159, v159, v251
  v_cvt_pk_bf16_f32 v148, v148, v149
  s_waitcnt lgkmcnt(5)
  v_mfma_f32_16x16x32_bf16 v[4:7], v[212:215], v[168:171], v[4:7]
  v_cvt_pk_bf16_f32 v149, v150, v151
  v_cvt_pk_bf16_f32 v150, v156, v157
  v_cvt_pk_bf16_f32 v151, v158, v159
  ds_read_b128 v[204:207], v235 offset:57344
  v_cndmask_b32_e64 v136, v148, v150, s[42:43]
  v_cndmask_b32_e64 v137, v149, v151, s[42:43]
  s_waitcnt lgkmcnt(5)
  v_mfma_f32_16x16x32_bf16 v[4:7], v[216:219], v[176:179], v[4:7]
  v_cndmask_b32_e64 v138, v150, v148, s[42:43]
  v_cndmask_b32_e64 v139, v151, v149, s[42:43]
  v_mul_f32 v164, v164, v251
  ds_read_b128 v[208:211], v232 offset:61440
  v_mul_f32 v165, v165, v251
  v_mul_f32 v166, v166, v251
  s_waitcnt lgkmcnt(5)
  v_mfma_f32_16x16x32_bf16 v[4:7], v[220:223], v[184:187], v[4:7]
  v_mul_f32 v167, v167, v251
  v_mul_f32 v172, v172, v251
  v_mul_f32 v173, v173, v251
  ds_read_b128 v[212:215], v233 offset:61440
  v_mul_f32 v174, v174, v251
  v_mul_f32 v175, v175, v251
  s_waitcnt lgkmcnt(5)
  v_mfma_f32_16x16x32_bf16 v[8:11], v[192:195], v[160:163], 0
  v_cvt_pk_bf16_f32 v164, v164, v165
  v_cvt_pk_bf16_f32 v165, v166, v167
  v_cvt_pk_bf16_f32 v166, v172, v173
  ds_read_b128 v[216:219], v234 offset:61440
  v_cvt_pk_bf16_f32 v167, v174, v175
  v_cndmask_b32_e64 v144, v164, v166, s[42:43]
  s_waitcnt lgkmcnt(5)
  v_mfma_f32_16x16x32_bf16 v[8:11], v[196:199], v[168:171], v[8:11]
  v_cndmask_b32_e64 v145, v165, v167, s[42:43]
  v_cndmask_b32_e64 v146, v166, v164, s[42:43]
  v_cndmask_b32_e64 v147, v167, v165, s[42:43]
  ds_read_b128 v[220:223], v235 offset:61440
  v_mul_f32 v180, v180, v251
  v_mul_f32 v181, v181, v251
  s_waitcnt lgkmcnt(5)
  v_mfma_f32_16x16x32_bf16 v[8:11], v[200:203], v[176:179], v[8:11]
  v_mul_f32 v182, v182, v251
  v_mul_f32 v183, v183, v251
  v_mul_f32 v188, v188, v251
  s_waitcnt lgkmcnt(4)
  v_mfma_f32_16x16x32_bf16 v[8:11], v[204:207], v[184:187], v[8:11]
  v_mul_f32 v189, v189, v251
  v_mul_f32 v190, v190, v251
  s_waitcnt lgkmcnt(3)
  v_mfma_f32_16x16x32_bf16 v[12:15], v[208:211], v[160:163], 0
  v_mul_f32 v191, v191, v251
  v_cvt_pk_bf16_f32 v180, v180, v181
  v_cvt_pk_bf16_f32 v181, v182, v183
  s_waitcnt lgkmcnt(2)
  v_mfma_f32_16x16x32_bf16 v[12:15], v[212:215], v[168:171], v[12:15]
  v_cvt_pk_bf16_f32 v182, v188, v189
  v_cvt_pk_bf16_f32 v183, v190, v191
  s_waitcnt lgkmcnt(1)
  v_mfma_f32_16x16x32_bf16 v[12:15], v[216:219], v[176:179], v[12:15]
  v_cndmask_b32_e64 v152, v180, v182, s[42:43]
  v_cndmask_b32_e64 v153, v181, v183, s[42:43]
  v_cndmask_b32_e64 v154, v182, v180, s[42:43]
  s_waitcnt lgkmcnt(0)
  v_mfma_f32_16x16x32_bf16 v[12:15], v[220:223], v[184:187], v[12:15]
  v_cndmask_b32_e64 v155, v183, v181, s[42:43]
  s_cmp_lg_u32 s67, 0
  s_cbranch_scc1 L_x3
  buffer_store_dwordx4 v[128:131], v253, s[32:35], 0 offen offset:0 sc1
  buffer_store_dwordx4 v[136:139], v253, s[32:35], 0 offen offset:1024 sc1
  buffer_store_dwordx4 v[144:147], v253, s[32:35], 0 offen offset:2048 sc1
  buffer_store_dwordx4 v[152:155], v253, s[32:35], 0 offen offset:3072 sc1
  s_branch L_x4
L_x3:
  buffer_store_dwordx4 v[128:131], v253, s[32:35], 0 offen offset:0
  buffer_store_dwordx4 v[136:139], v253, s[32:35], 0 offen offset:1024
  buffer_store_dwordx4 v[144:147], v253, s[32:35], 0 offen offset:2048
  buffer_store_dwordx4 v[152:155], v253, s[32:35], 0 offen offset:3072
L_x4:
  s_barrier
  v_lshlrev_b32 v251, 3, v248
  buffer_load_dwordx2 v[246:247], v251, s[20:23], 0 offen sc1
  v_add_u32 v232, 131072, v232
  v_add_u32 v233, 131072, v233
  v_add_u32 v234, 131072, v234
  v_add_u32 v235, 131072, v235
  ds_read_b128 v[192:195], v232 offset:16384
  ds_read_b128 v[196:199], v233 offset:16384
  ds_read_b128 v[200:203], v234 offset:16384
  ds_read_b128 v[204:207], v235 offset:16384
  ds_read_b128 v[208:211], v232 offset:20480
  ds_read_b128 v[212:215], v233 offset:20480
  s_waitcnt lgkmcnt(5)
  v_mfma_f32_16x16x32_bf16 v[16:19], v[192:195], v[160:163], 0
  ds_read_b128 v[216:219], v234 offset:20480
  v_max3_f32 v250, v0, v1, v2
  s_waitcnt lgkmcnt(5)
  v_mfma_f32_16x16x32_bf16 v[16:19], v[196:199], v[168:171], v[16:19]
  ds_read_b128 v[220:223], v235 offset:20480
  s_waitcnt lgkmcnt(5)
  v_mfma_f32_16x16x32_bf16 v[16:19], v[200:203], v[176:179], v[16:19]
  v_max_f32 v250, v250, v3
  ds_read_b128 v[192:195], v232 offset:24576
  s_waitcnt lgkmcnt(5)
  v_mfma_f32_16x16x32_bf16 v[16:19], v[204:207], v[184:187], v[16:19]
  ds_read_b128 v[196:199], v233 offset:24576
  v_max3_f32 v250, v250, v4, v5
  s_waitcnt lgkmcnt(5)
  v_mfma_f32_16x16x32_bf16 v[20:23], v[208:211], v[160:163], 0
  ds_read_b128 v[200:203], v234 offset:24576
  s_waitcnt lgkmcnt(5)
  v_mfma_f32_16x16x32_bf16 v[20:23], v[212:215], v[168:171], v[20:23]
  v_max3_f32 v250, v250, v6, v7
  ds_read_b128 v[204:207], v235 offset:24576
  s_waitcnt lgkmcnt(5)
  v_mfma_f32_16x16x32_bf16 v[20:23], v[216:219], v[176:179], v[20:23]
  ds_read_b128 v[208:211], v232 offset:28672
  s_waitcnt lgkmcnt(5)
  v_mfma_f32_16x16x32_bf16 v[20:23], v[220:223], v[184:187], v[20:23]
  v_max3_f32 v250, v250, v8, v9
  ds_read_b128 v[212:215], v233 offset:28672
  s_waitcnt lgkmcnt(5)
  v_mfma_f32_16x16x32_bf16 v[24:27], v[192:195], v[160:163], 0
  ds_read_b128 v[216:219], v234 offset:28672
  v_max3_f32 v250, v250, v10, v11
  s_waitcnt lgkmcnt(5)
  v_mfma_f32_16x16x32_bf16 v[24:27], v[196:199], v[168:171], v[24:27]
  ds_read_b128 v[220:223], v235 offset:28672
  s_waitcnt lgkmcnt(5)
  v_mfma_f32_16x16x32_bf16 v[24:27], v[200:203], v[176:179], v[24:27]
  v_max3_f32 v250, v250, v12, v13
  s_waitcnt lgkmcnt(4)
  v_mfma_f32_16x16x32_bf16 v[24:27], v[204:207], v[184:187], v[24:27]
  s_waitcnt lgkmcnt(3)
  v_mfma_f32_16x16x32_bf16 v[28:31], v[208:211], v[160:163], 0
  s_waitcnt lgkmcnt(2)
  v_mfma_f32_16x16x32_bf16 v[28:31], v[212:215], v[168:171], v[28:31]
  v_max3_f32 v250, v250, v14, v15
  s_waitcnt lgkmcnt(1)
  v_mfma_f32_16x16x32_bf16 v[28:31], v[216:219], v[176:179], v[28:31]
  s_waitcnt lgkmcnt(0)
  v_mfma_f32_16x16x32_bf16 v[28:31], v[220:223], v[184:187], v[28:31]
  s_barrier
  v_subrev_u32 v232, 65536, v232
  v_subrev_u32 v233, 65536, v233
  v_subrev_u32 v234, 65536, v234
  v_subrev_u32 v235, 65536, v235
  ds_read_b128 v[192:195], v232 offset:49152
  ds_read_b128 v[196:199], v233 offset:49152
  ds_read_b128 v[200:203], v234 offset:49152
  ds_read_b128 v[204:207], v235 offset:49152
  ds_read_b128 v[208:211], v232 offset:53248
  ds_read_b128 v[212:215], v233 offset:53248
  s_waitcnt lgkmcnt(5)
  v_mfma_f32_16x16x32_bf16 v[32:35], v[192:195], v[160:163], 0
  ds_read_b128 v[216:219], v234 offset:53248
  v_max3_f32 v250, v250, v16, v17
  s_waitcnt lgkmcnt(5)
  v_mfma_f32_16x16x32_bf16 v[32:35], v[196:199], v[168:171], v[32:35]
  ds_read_b128 v[220:223], v235 offset:53248
  s_waitcnt lgkmcnt(5)
  v_mfma_f32_16x16x32_bf16 v[32:35], v[200:203], v[176:179], v[32:35]
  v_max3_f32 v250, v250, v18, v19
  ds_read_b128 v[192:195], v232 offset:57344
  s_waitcnt lgkmcnt(5)
  v_mfma_f32_16x16x32_bf16 v[32:35], v[204:207], v[184:187], v[32:35]
  ds_read_b128 v[196:199], v233 offset:57344
  v_max3_f32 v250, v250, v20, v21
  s_waitcnt lgkmcnt(5)
  v_mfma_f32_16x16x32_bf16 v[36:39], v[208:211], v[160:163], 0
  ds_read_b128 v[200:203], v234 offset:57344
  s_waitcnt lgkmcnt(5)
  v_mfma_f32_16x16x32_bf16 v[36:39], v[212:215], v[168:171], v[36:39]
  v_max3_f32 v250, v250, v22, v23
  ds_read_b128 v[204:207], v235 offset:57344
  s_waitcnt lgkmcnt(5)
  v_mfma_f32_16x16x32_bf16 v[36:39], v[216:219], v[176:179], v[36:39]
  ds_read_b128 v[208:211], v232 offset:61440
  s_waitcnt lgkmcnt(5)
  v_mfma_f32_16x16x32_bf16 v[36:39], v[220:223], v[184:187], v[36:39]
  v_max3_f32 v250, v250, v24, v25
  ds_read_b128 v[212:215], v233 offset:61440
  s_waitcnt lgkmcnt(5)
  v_mfma_f32_16x16x32_bf16 v[40:43], v[192:195], v[160:163], 0
  ds_read_b128 v[216:219], v234 offset:61440
  v_max3_f32 v250, v250, v26, v27
  s_waitcnt lgkmcnt(5)
  v_mfma_f32_16x16x32_bf16 v[40:43], v[196:199], v[168:171], v[40:43]
  ds_read_b128 v[220:223], v235 offset:61440
  s_waitcnt lgkmcnt(5)
  v_mfma_f32_16x16x32_bf16 v[40:43], v[200:203], v[176:179], v[40:43]
  v_max3_f32 v250, v250, v28, v29
  s_waitcnt lgkmcnt(4)
  v_mfma_f32_16x16x32_bf16 v[40:43], v[204:207], v[184:187], v[40:43]
  s_waitcnt lgkmcnt(3)
  v_mfma_f32_16x16x32_bf16 v[44:47], v[208:211], v[160:163], 0
  s_waitcnt lgkmcnt(2)
  v_mfma_f32_16x16x32_bf16 v[44:47], v[212:215], v[168:171], v[44:47]
  v_max3_f32 v250, v250, v30, v31
  s_waitcnt lgkmcnt(1)
  v_mfma_f32_16x16x32_bf16 v[44:47], v[216:219], v[176:179], v[44:47]
  s_waitcnt lgkmcnt(0)
  v_mfma_f32_16x16x32_bf16 v[44:47], v[220:223], v[184:187], v[44:47]
  s_waitcnt vmcnt(0)
  s_mov_b64 exec, 1
  s_cmp_lg_u32 s67, 0
  s_cbranch_scc1 L_x5
  buffer_store_dwordx2 v[254:255], off, s[68:71], s52 offset:0 sc1
  s_branch L_x6
L_x5:
  buffer_store_dwordx2 v[254:255], off, s[68:71], s52 offset:0
L_x6:
  s_mov_b64 exec, -1
  v_xor_b32 v244, v246, v254
  v_and_b32 v244, -16, v244
  v_xor_b32 v245, v247, v255
  v_or_b32 v244, v244, v245
  v_cmp_ne_u32 vcc, 0, v244
  v_mov_b32 v244, v254
  v_mov_b32 v245, v255
  s_and_b32 s98, vcc_lo, 3
  s_cbranch_scc0 L_x7
  s_mov_b32 exec_lo, s98
  s_mov_b32 exec_hi, 0
  buffer_atomic_cmpswap_x2 v[244:247], v251, s[20:23], 0 offen sc1
  s_mov_b64 exec, -1
L_x7:
  s_barrier
  s_nop 1
  v_mov_b32 v244, 0
  v_mov_b32 v245, 0
  v_mov_b32 v246, 0
  v_mov_b32 v247, 0
  v_add_u32 v232, 65536, v232
  v_add_u32 v233, 65536, v233
  v_add_u32 v234, 65536, v234
  v_add_u32 v235, 65536, v235
  ds_read_b128 v[192:195], v232 offset:0
  ds_read_b128 v[196:199], v233 offset:0
  ds_read_b128 v[200:203], v234 offset:0
  ds_read_b128 v[204:207], v235 offset:0
  ds_read_b128 v[208:211], v232 offset:4096
  ds_read_b128 v[212:215], v233 offset:4096
  s_waitcnt lgkmcnt(5)
  v_mfma_f32_16x16x32_bf16 v[48:51], v[192:195], v[160:163], 0
  ds_read_b128 v[216:219], v234 offset:4096
  v_max3_f32 v250, v250, v32, v33
  s_waitcnt lgkmcnt(5)
  v_mfma_f32_16x16x32_bf16 v[48:51], v[196:199], v[168:171], v[48:51]
  ds_read_b128 v[220:223], v235 offset:4096
  s_waitcnt lgkmcnt(5)
  v_mfma_f32_16x16x32_bf16 v[48:51], v[200:203], v[176:179], v[48:51]
  v_max3_f32 v250, v250, v34, v35
  ds_read_b128 v[192:195], v232 offset:8192
  s_waitcnt lgkmcnt(5)
  v_mfma_f32_16x16x32_bf16 v[48:51], v[204:207], v[184:187], v[48:51]
  ds_read_b128 v[196:199], v233 offset:8192
  v_max3_f32 v250, v250, v36, v37
  s_waitcnt lgkmcnt(5)
  v_mfma_f32_16x16x32_bf16 v[52:55], v[208:211], v[160:163], 0
  ds_read_b128 v[200:203], v234 offset:8192
  s_waitcnt lgkmcnt(5)
  v_mfma_f32_16x16x32_bf16 v[52:55], v[212:215], v[168:171], v[52:55]
  v_max3_f32 v250, v250, v38, v39
  ds_read_b128 v[204:207], v235 offset:8192
  s_waitcnt lgkmcnt(5)
  v_mfma_f32_16x16x32_bf16 v[52:55], v[216:219], v[176:179], v[52:55]
  ds_read_b128 v[208:211], v232 offset:12288
  s_waitcnt lgkmcnt(5)
  v_mfma_f32_16x16x32_bf16 v[52:55], v[220:223], v[184:187], v[52:55]
  v_max3_f32 v250, v250, v40, v41
  ds_read_b128 v[212:215], v233 offset:12288
  s_waitcnt lgkmcnt(5)
  v_mfma_f32_16x16x32_bf16 v[56:59], v[192:195], v[160:163], 0
  ds_read_b128 v[216:219], v234 offset:12288
  v_max3_f32 v250, v250, v42, v43
  s_waitcnt lgkmcnt(5)
  v_mfma_f32_16x16x32_bf16 v[56:59], v[196:199], v[168:171], v[56:59]
  ds_read_b128 v[220:223], v235 offset:12288
  s_waitcnt lgkmcnt(5)
  v_mfma_f32_16x16x32_bf16 v[56:59], v[200:203], v[176:179], v[56:59]
  v_max3_f32 v250, v250, v44, v45
  s_waitcnt lgkmcnt(4)
  v_mfma_f32_16x16x32_bf16 v[56:59], v[204:207], v[184:187], v[56:59]
  s_waitcnt lgkmcnt(3)
  v_mfma_f32_16x16x32_bf16 v[60:63], v[208:211], v[160:163], 0
  s_waitcnt lgkmcnt(2)
  v_mfma_f32_16x16x32_bf16 v[60:63], v[212:215], v[168:171], v[60:63]
  v_max3_f32 v250, v250, v46, v47
  s_waitcnt lgkmcnt(1)
  v_mfma_f32_16x16x32_bf16 v[60:63], v[216:219], v[176:179], v[60:63]
  s_waitcnt lgkmcnt(0)
  v_mfma_f32_16x16x32_bf16 v[60:63], v[220:223], v[184:187], v[60:63]
  s_barrier
  v_subrev_u32 v232, 65536, v232
  v_subrev_u32 v233, 65536, v233
  v_subrev_u32 v234, 65536, v234
  v_subrev_u32 v235, 65536, v235
  ds_read_b128 v[192:195], v232 offset:0
  ds_read_b128 v[196:199], v233 offset:0
  ds_read_b128 v[200:203], v234 offset:0
  ds_read_b128 v[204:207], v235 offset:0
  ds_read_b128 v[208:211], v232 offset:4096
  ds_read_b128 v[212:215], v233 offset:4096
  s_waitcnt lgkmcnt(5)
  v_mfma_f32_16x16x32_bf16 v[64:67], v[192:195], v[160:163], 0
  ds_read_b128 v[216:219], v234 offset:4096
  v_max3_f32 v250, v250, v48, v49
  s_waitcnt lgkmcnt(5)
  v_mfma_f32_16x16x32_bf16 v[64:67], v[196:199], v[168:171], v[64:67]
  ds_read_b128 v[220:223], v235 offset:4096
  s_waitcnt lgkmcnt(5)
  v_mfma_f32_16x16x32_bf16 v[64:67], v[200:203], v[176:179], v[64:67]
  v_max3_f32 v250, v250, v50, v51
  ds_read_b128 v[192:195], v232 offset:8192
  s_waitcnt lgkmcnt(5)
  v_mfma_f32_16x16x32_bf16 v[64:67], v[204:207], v[184:187], v[64:67]
  ds_read_b128 v[196:199], v233 offset:8192
  v_max3_f32 v250, v250, v52, v53
  s_waitcnt lgkmcnt(5)
  v_mfma_f32_16x16x32_bf16 v[68:71], v[208:211], v[160:163], 0
  ds_read_b128 v[200:203], v234 offset:8192
  s_waitcnt lgkmcnt(5)
  v_mfma_f32_16x16x32_bf16 v[68:71], v[212:215], v[168:171], v[68:71]
  v_max3_f32 v250, v250, v54, v55
  ds_read_b128 v[204:207], v235 offset:8192
  s_waitcnt lgkmcnt(5)
  v_mfma_f32_16x16x32_bf16 v[68:71], v[216:219], v[176:179], v[68:71]
  ds_read_b128 v[208:211], v232 offset:12288
  s_waitcnt lgkmcnt(5)
  v_mfma_f32_16x16x32_bf16 v[68:71], v[220:223], v[184:187], v[68:71]
  v_max3_f32 v250, v250, v56, v57
  ds_read_b128 v[212:215], v233 offset:12288
  s_waitcnt lgkmcnt(5)
  v_mfma_f32_16x16x32_bf16 v[72:75], v[192:195], v[160:163], 0
  ds_read_b128 v[216:219], v234 offset:12288
  v_max3_f32 v250, v250, v58, v59
  s_waitcnt lgkmcnt(5)
  v_mfma_f32_16x16x32_bf16 v[72:75], v[196:199], v[168:171], v[72:75]
  ds_read_b128 v[220:223], v235 offset:12288
  s_waitcnt lgkmcnt(5)
  v_mfma_f32_16x16x32_bf16 v[72:75], v[200:203], v[176:179], v[72:75]
  v_max3_f32 v250, v250, v60, v61
  s_waitcnt lgkmcnt(4)
  v_mfma_f32_16x16x32_bf16 v[72:75], v[204:207], v[184:187], v[72:75]
  s_waitcnt lgkmcnt(3)
  v_mfma_f32_16x16x32_bf16 v[76:79], v[208:211], v[160:163], 0
  s_waitcnt lgkmcnt(2)
  v_mfma_f32_16x16x32_bf16 v[76:79], v[212:215], v[168:171], v[76:79]
  v_max3_f32 v250, v250, v62, v63
  s_waitcnt lgkmcnt(1)
  v_mfma_f32_16x16x32_bf16 v[76:79], v[216:219], v[176:179], v[76:79]
  s_waitcnt lgkmcnt(0)
  v_mfma_f32_16x16x32_bf16 v[76:79], v[220:223], v[184:187], v[76:79]
  s_barrier
  ds_read_b128 v[192:195], v232 offset:16384
  ds_read_b128 v[196:199], v233 offset:16384
  ds_read_b128 v[200:203], v234 offset:16384
  ds_read_b128 v[204:207], v235 offset:16384
  ds_read_b128 v[208:211], v232 offset:20480
  ds_read_b128 v[212:215], v233 offset:20480
  s_waitcnt lgkmcnt(5)
  v_mfma_f32_16x16x32_bf16 v[80:83], v[192:195], v[160:163], 0
  ds_read_b128 v[216:219], v234 offset:20480
  v_max3_f32 v250, v250, v64, v65
  s_waitcnt lgkmcnt(5)
  v_mfma_f32_16x16x32_bf16 v[80:83], v[196:199], v[168:171], v[80:83]
  ds_read_b128 v[220:223], v235 offset:20480
  s_waitcnt lgkmcnt(5)
  v_mfma_f32_16x16x32_bf16 v[80:83], v[200:203], v[176:179], v[80:83]
  v_max3_f32 v250, v250, v66, v67
  ds_read_b128 v[192:195], v232 offset:24576
  s_waitcnt lgkmcnt(5)
  v_mfma_f32_16x16x32_bf16 v[80:83], v[204:207], v[184:187], v[80:83]
  ds_read_b128 v[196:199], v233 offset:24576
  v_max3_f32 v250, v250, v68, v69
  s_waitcnt lgkmcnt(5)
  v_mfma_f32_16x16x32_bf16 v[84:87], v[208:211], v[160:163], 0
  ds_read_b128 v[200:203], v234 offset:24576
  s_waitcnt lgkmcnt(5)
  v_mfma_f32_16x16x32_bf16 v[84:87], v[212:215], v[168:171], v[84:87]
  v_max3_f32 v250, v250, v70, v71
  ds_read_b128 v[204:207], v235 offset:24576
  s_waitcnt lgkmcnt(5)
  v_mfma_f32_16x16x32_bf16 v[84:87], v[216:219], v[176:179], v[84:87]
  ds_read_b128 v[208:211], v232 offset:28672
  s_waitcnt lgkmcnt(5)
  v_mfma_f32_16x16x32_bf16 v[84:87], v[220:223], v[184:187], v[84:87]
  v_max3_f32 v250, v250, v72, v73
  ds_read_b128 v[212:215], v233 offset:28672
  s_waitcnt lgkmcnt(5)
  v_mfma_f32_16x16x32_bf16 v[88:91], v[192:195], v[160:163], 0
  ds_read_b128 v[216:219], v234 offset:28672
  v_max3_f32 v250, v250, v74, v75
  s_waitcnt lgkmcnt(5)
  v_mfma_f32_16x16x32_bf16 v[88:91], v[196:199], v[168:171], v[88:91]
  ds_read_b128 v[220:223], v235 offset:28672
  s_waitcnt lgkmcnt(5)
  v_mfma_f32_16x16x32_bf16 v[88:91], v[200:203], v[176:179], v[88:91]
  v_max3_f32 v250, v250, v76, v77
  s_waitcnt lgkmcnt(4)
  v_mfma_f32_16x16x32_bf16 v[88:91], v[204:207], v[184:187], v[88:91]
  s_waitcnt lgkmcnt(3)
  v_mfma_f32_16x16x32_bf16 v[92:95], v[208:211], v[160:163], 0
  s_waitcnt lgkmcnt(2)
  v_mfma_f32_16x16x32_bf16 v[92:95], v[212:215], v[168:171], v[92:95]
  v_max3_f32 v250, v250, v78, v79
  s_waitcnt lgkmcnt(1)
  v_mfma_f32_16x16x32_bf16 v[92:95], v[216:219], v[176:179], v[92:95]
  s_waitcnt lgkmcnt(0)
  v_mfma_f32_16x16x32_bf16 v[92:95], v[220:223], v[184:187], v[92:95]
  s_barrier
  ds_read_b128 v[192:195], v232 offset:32768
  ds_read_b128 v[196:199], v233 offset:32768
  ds_read_b128 v[200:203], v234 offset:32768
  ds_read_b128 v[204:207], v235 offset:32768
  ds_read_b128 v[208:211], v232 offset:36864
  ds_read_b128 v[212:215], v233 offset:36864
  s_waitcnt lgkmcnt(5)
  v_mfma_f32_16x16x32_bf16 v[96:99], v[192:195], v[160:163], 0
  ds_read_b128 v[216:219], v234 offset:36864
  v_max3_f32 v250, v250, v80, v81
  s_waitcnt lgkmcnt(5)
  v_mfma_f32_16x16x32_bf16 v[96:99], v[196:199], v[168:171], v[96:99]
  ds_read_b128 v[220:223], v235 offset:36864
  s_waitcnt lgkmcnt(5)
  v_mfma_f32_16x16x32_bf16 v[96:99], v[200:203], v[176:179], v[96:99]
  v_max3_f32 v250, v250, v82, v83
  ds_read_b128 v[192:195], v232 offset:40960
  s_waitcnt lgkmcnt(5)
  v_mfma_f32_16x16x32_bf16 v[96:99], v[204:207], v[184:187], v[96:99]
  ds_read_b128 v[196:199], v233 offset:40960
  v_max3_f32 v250, v250, v84, v85
  s_waitcnt lgkmcnt(5)
  v_mfma_f32_16x16x32_bf16 v[100:103], v[208:211], v[160:163], 0
  ds_read_b128 v[200:203], v234 offset:40960
  s_waitcnt lgkmcnt(5)
  v_mfma_f32_16x16x32_bf16 v[100:103], v[212:215], v[168:171], v[100:103]
  v_max3_f32 v250, v250, v86, v87
  ds_read_b128 v[204:207], v235 offset:40960
  s_waitcnt lgkmcnt(5)
  v_mfma_f32_16x16x32_bf16 v[100:103], v[216:219], v[176:179], v[100:103]
  ds_read_b128 v[208:211], v232 offset:45056
  s_waitcnt lgkmcnt(5)
  v_mfma_f32_16x16x32_bf16 v[100:103], v[220:223], v[184:187], v[100:103]
  v_max3_f32 v250, v250, v88, v89
  ds_read_b128 v[212:215], v233 offset:45056
  s_waitcnt lgkmcnt(5)
  v_mfma_f32_16x16x32_bf16 v[104:107], v[192:195], v[160:163], 0
  ds_read_b128 v[216:219], v234 offset:45056
  v_max3_f32 v250, v250, v90, v91
  s_waitcnt lgkmcnt(5)
  v_mfma_f32_16x16x32_bf16 v[104:107], v[196:199], v[168:171], v[104:107]
  ds_read_b128 v[220:223], v235 offset:45056
  s_waitcnt lgkmcnt(5)
  v_mfma_f32_16x16x32_bf16 v[104:107], v[200:203], v[176:179], v[104:107]
  v_max3_f32 v250, v250, v92, v93
  s_waitcnt lgkmcnt(4)
  v_mfma_f32_16x16x32_bf16 v[104:107], v[204:207], v[184:187], v[104:107]
  s_waitcnt lgkmcnt(3)
  v_mfma_f32_16x16x32_bf16 v[108:111], v[208:211], v[160:163], 0
  s_waitcnt lgkmcnt(2)
  v_mfma_f32_16x16x32_bf16 v[108:111], v[212:215], v[168:171], v[108:111]
  v_max3_f32 v250, v250, v94, v95
  s_waitcnt lgkmcnt(1)
  v_mfma_f32_16x16x32_bf16 v[108:111], v[216:219], v[176:179], v[108:111]
  s_waitcnt lgkmcnt(0)
  v_mfma_f32_16x16x32_bf16 v[108:111], v[220:223], v[184:187], v[108:111]
  s_barrier
  v_subrev_u32 v232, 65536, v232
  v_subrev_u32 v233, 65536, v233
  v_subrev_u32 v234, 65536, v234
  v_subrev_u32 v235, 65536, v235
  ds_read_b128 v[192:195], v232 offset:0
  ds_read_b128 v[196:199], v233 offset:0
  ds_read_b128 v[200:203], v234 offset:0
  ds_read_b128 v[204:207], v235 offset:0
  ds_read_b128 v[208:211], v232 offset:4096
  ds_read_b128 v[212:215], v233 offset:4096
  s_waitcnt lgkmcnt(5)
  v_mfma_f32_16x16x32_bf16 v[112:115], v[192:195], v[160:163], 0
  ds_read_b128 v[216:219], v234 offset:4096
  v_max3_f32 v250, v250, v96, v97
  s_waitcnt lgkmcnt(5)
  v_mfma_f32_16x16x32_bf16 v[112:115], v[196:199], v[168:171], v[112:115]
  ds_read_b128 v[220:223], v235 offset:4096
  s_waitcnt lgkmcnt(5)
  v_mfma_f32_16x16x32_bf16 v[112:115], v[200:203], v[176:179], v[112:115]
  v_max3_f32 v250, v250, v98, v99
  ds_read_b128 v[192:195], v232 offset:8192
  s_waitcnt lgkmcnt(5)
  v_mfma_f32_16x16x32_bf16 v[112:115], v[204:207], v[184:187], v[112:115]
  ds_read_b128 v[196:199], v233 offset:8192
  v_max3_f32 v250, v250, v100, v101
  s_waitcnt lgkmcnt(5)
  v_mfma_f32_16x16x32_bf16 v[116:119], v[208:211], v[160:163], 0
  ds_read_b128 v[200:203], v234 offset:8192
  s_waitcnt lgkmcnt(5)
  v_mfma_f32_16x16x32_bf16 v[116:119], v[212:215], v[168:171], v[116:119]
  v_max3_f32 v250, v250, v102, v103
  ds_read_b128 v[204:207], v235 offset:8192
  s_waitcnt lgkmcnt(5)
  v_mfma_f32_16x16x32_bf16 v[116:119], v[216:219], v[176:179], v[116:119]
  ds_read_b128 v[208:211], v232 offset:12288
  s_waitcnt lgkmcnt(5)
  v_mfma_f32_16x16x32_bf16 v[116:119], v[220:223], v[184:187], v[116:119]
  v_max3_f32 v250, v250, v104, v105
  ds_read_b128 v[212:215], v233 offset:12288
  s_waitcnt lgkmcnt(5)
  v_mfma_f32_16x16x32_bf16 v[120:123], v[192:195], v[160:163], 0
  ds_read_b128 v[216:219], v234 offset:12288
  v_max3_f32 v250, v250, v106, v107
  s_waitcnt lgkmcnt(5)
  v_mfma_f32_16x16x32_bf16 v[120:123], v[196:199], v[168:171], v[120:123]
  ds_read_b128 v[220:223], v235 offset:12288
  s_waitcnt lgkmcnt(5)
  v_mfma_f32_16x16x32_bf16 v[120:123], v[200:203], v[176:179], v[120:123]
  v_max3_f32 v250, v250, v108, v109
  s_waitcnt lgkmcnt(4)
  v_mfma_f32_16x16x32_bf16 v[120:123], v[204:207], v[184:187], v[120:123]
  s_waitcnt lgkmcnt(3)
  v_mfma_f32_16x16x32_bf16 v[124:127], v[208:211], v[160:163], 0
  s_waitcnt lgkmcnt(2)
  v_mfma_f32_16x16x32_bf16 v[124:127], v[212:215], v[168:171], v[124:127]
  v_max3_f32 v250, v250, v110, v111
  s_waitcnt lgkmcnt(1)
  v_mfma_f32_16x16x32_bf16 v[124:127], v[216:219], v[176:179], v[124:127]
  s_waitcnt lgkmcnt(0)
  v_mfma_f32_16x16x32_bf16 v[124:127], v[220:223], v[184:187], v[124:127]
  s_barrier
  ds_read_b64_tr_b16 v[192:193], v236 offset:16384
  ds_read_b64_tr_b16 v[194:195], v236 offset:20480
  ds_read_b64_tr_b16 v[196:197], v237 offset:16384
  ds_read_b64_tr_b16 v[198:199], v237 offset:20480
  ds_read_b64_tr_b16 v[200:201], v238 offset:16384
  ds_read_b64_tr_b16 v[202:203], v238 offset:20480
  ds_read_b64_tr_b16 v[204:205], v239 offset:16384
  ds_read_b64_tr_b16 v[206:207], v239 offset:20480
  ds_read_b64_tr_b16 v[208:209], v236 offset:24576
  ds_read_b64_tr_b16 v[210:211], v236 offset:28672
  ds_read_b64_tr_b16 v[212:213], v237 offset:24576
  ds_read_b64_tr_b16 v[214:215], v237 offset:28672
  s_mov_b64 exec, 0xff
  buffer_load_dwordx2 v[244:245], v249, s[68:71], s53 offen offset:0 sc1
  s_mov_b64 exec, -1
  v_max3_f32 v250, v250, v112, v113
  v_max3_f32 v250, v250, v114, v115
  v_max3_f32 v250, v250, v116, v117
  v_max3_f32 v250, v250, v118, v119
  v_max3_f32 v250, v250, v120, v121
  v_max3_f32 v250, v250, v122, v123
  v_max3_f32 v250, v250, v124, v125
  v_max3_f32 v250, v250, v126, v127
  v_mov_b32 v251, v250
  s_nop 1
  v_permlane32_swap_b32 v250, v251
  v_max_f32 v250, v250, v251
  v_mov_b32 v251, v250
  s_nop 1
  v_permlane16_swap_b32 v250, v251
  v_max_f32 v250, v250, v251
  v_mul_f32 v252, s40, v250
  v_fma_f32 v0, v0, s40, -v252
  v_fma_f32 v1, v1, s40, -v252
  v_fma_f32 v2, v2, s40, -v252
  v_fma_f32 v3, v3, s40, -v252
  v_fma_f32 v4, v4, s40, -v252
  v_fma_f32 v5, v5, s40, -v252
  v_fma_f32 v6, v6, s40, -v252
  v_fma_f32 v7, v7, s40, -v252
  v_exp_f32 v0, v0
  v_exp_f32 v1, v1
  v_exp_f32 v2, v2
  v_exp_f32 v3, v3
  v_exp_f32 v4, v4
  v_exp_f32 v5, v5
  v_exp_f32 v6, v6
  v_exp_f32 v7, v7
  v_cvt_pk_bf16_f32 v0, v0, v1
  v_cvt_pk_bf16_f32 v1, v2, v3
  v_cvt_pk_bf16_f32 v2, v4, v5
  v_cvt_pk_bf16_f32 v3, v6, v7
  v_fma_f32 v8, v8, s40, -v252
  v_fma_f32 v9, v9, s40, -v252
  v_fma_f32 v10, v10, s40, -v252
  v_fma_f32 v11, v11, s40, -v252
  v_fma_f32 v12, v12, s40, -v252
  v_fma_f32 v13, v13, s40, -v252
  v_fma_f32 v14, v14, s40, -v252
  v_fma_f32 v15, v15, s40, -v252
  v_exp_f32 v8, v8
  v_exp_f32 v9, v9
  v_exp_f32 v10, v10
  v_exp_f32 v11, v11
  v_exp_f32 v12, v12
  v_exp_f32 v13, v13
  v_exp_f32 v14, v14
  v_exp_f32 v15, v15
  v_cvt_pk_bf16_f32 v8, v8, v9
  v_cvt_pk_bf16_f32 v9, v10, v11
  v_cvt_pk_bf16_f32 v10, v12, v13
  v_cvt_pk_bf16_f32 v11, v14, v15
  v_fma_f32 v16, v16, s40, -v252
  s_waitcnt lgkmcnt(10)
  v_mfma_f32_16x16x32_bf16 v[132:135], v[192:195], v[0:3], 0
  v_fma_f32 v17, v17, s40, -v252
  ds_read_b64_tr_b16 v[216:217], v238 offset:24576
  v_fma_f32 v18, v18, s40, -v252
  v_fma_f32 v19, v19, s40, -v252
  ds_read_b64_tr_b16 v[218:219], v238 offset:28672
  v_fma_f32 v20, v20, s40, -v252
  s_waitcnt lgkmcnt(10)
  v_mfma_f32_16x16x32_bf16 v[140:143], v[196:199], v[0:3], 0
  v_fma_f32 v21, v21, s40, -v252
  v_fma_f32 v22, v22, s40, -v252
  ds_read_b64_tr_b16 v[220:221], v239 offset:24576
  v_fma_f32 v23, v23, s40, -v252
  ds_read_b64_tr_b16 v[222:223], v239 offset:28672
  v_exp_f32 v16, v16
  v_exp_f32 v17, v17
  s_waitcnt lgkmcnt(10)
  v_mfma_f32_16x16x32_bf16 v[148:151], v[200:203], v[0:3], 0
  v_exp_f32 v18, v18
  v_exp_f32 v19, v19
  ds_read_b64_tr_b16 v[192:193], v240 offset:16384
  v_exp_f32 v20, v20
  ds_read_b64_tr_b16 v[194:195], v240 offset:20480
  v_exp_f32 v21, v21
  v_exp_f32 v22, v22
  s_waitcnt lgkmcnt(10)
  v_mfma_f32_16x16x32_bf16 v[156:159], v[204:207], v[0:3], 0
  v_exp_f32 v23, v23
  v_mfma_f32_16x16x32_bf16 v[224:227], v[228:231], v[0:3], 0
  v_cvt_pk_bf16_f32 v16, v16, v17
  v_cvt_pk_bf16_f32 v17, v18, v19
  ds_read_b64_tr_b16 v[196:197], v241 offset:16384
  v_cvt_pk_bf16_f32 v18, v20, v21
  ds_read_b64_tr_b16 v[198:199], v241 offset:20480
  v_cvt_pk_bf16_f32 v19, v22, v23
  v_fma_f32 v24, v24, s40, -v252
  s_waitcnt lgkmcnt(10)
  v_mfma_f32_16x16x32_bf16 v[132:135], v[208:211], v[8:11], v[132:135]
  v_fma_f32 v25, v25, s40, -v252
  ds_read_b64_tr_b16 v[200:201], v242 offset:16384
  v_fma_f32 v26, v26, s40, -v252
  v_fma_f32 v27, v27, s40, -v252
  ds_read_b64_tr_b16 v[202:203], v242 offset:20480
  v_fma_f32 v28, v28, s40, -v252
  s_waitcnt lgkmcnt(10)
  v_mfma_f32_16x16x32_bf16 v[140:143], v[212:215], v[8:11], v[140:143]
  v_fma_f32 v29, v29, s40, -v252
  v_fma_f32 v30, v30, s40, -v252
  ds_read_b64_tr_b16 v[204:205], v243 offset:16384
  v_fma_f32 v31, v31, s40, -v252
  ds_read_b64_tr_b16 v[206:207], v243 offset:20480
  v_exp_f32 v24, v24
  v_exp_f32 v25, v25
  s_waitcnt lgkmcnt(10)
  v_mfma_f32_16x16x32_bf16 v[148:151], v[216:219], v[8:11], v[148:151]
  v_exp_f32 v26, v26
  v_exp_f32 v27, v27
  ds_read_b64_tr_b16 v[208:209], v240 offset:24576
  v_exp_f32 v28, v28
  ds_read_b64_tr_b16 v[210:211], v240 offset:28672
  v_exp_f32 v29, v29
  v_exp_f32 v30, v30
  s_waitcnt lgkmcnt(10)
  v_mfma_f32_16x16x32_bf16 v[156:159], v[220:223], v[8:11], v[156:159]
  v_exp_f32 v31, v31
  v_mfma_f32_16x16x32_bf16 v[224:227], v[228:231], v[8:11], v[224:227]
  v_cvt_pk_bf16_f32 v24, v24, v25
  v_cvt_pk_bf16_f32 v25, v26, v27
  ds_read_b64_tr_b16 v[212:213], v241 offset:24576
  v_cvt_pk_bf16_f32 v26, v28, v29
  ds_read_b64_tr_b16 v[214:215], v241 offset:28672
  v_cvt_pk_bf16_f32 v27, v30, v31
  v_fma_f32 v32, v32, s40, -v252
  s_waitcnt lgkmcnt(10)
  v_mfma_f32_16x16x32_bf16 v[132:135], v[192:195], v[16:19], v[132:135]
  v_fma_f32 v33, v33, s40, -v252
  v_fma_f32 v34, v34, s40, -v252
  v_fma_f32 v35, v35, s40, -v252
  ds_read_b64_tr_b16 v[216:217], v242 offset:24576
  v_fma_f32 v36, v36, s40, -v252
  v_fma_f32 v37, v37, s40, -v252
  v_fma_f32 v38, v38, s40, -v252
  ds_read_b64_tr_b16 v[218:219], v242 offset:28672
  v_fma_f32 v39, v39, s40, -v252
  v_exp_f32 v32, v32
  v_exp_f32 v33, v33
  s_waitcnt lgkmcnt(10)
  v_mfma_f32_16x16x32_bf16 v[140:143], v[196:199], v[16:19], v[140:143]
  v_exp_f32 v34, v34
  v_exp_f32 v35, v35
  v_exp_f32 v36, v36
  ds_read_b64_tr_b16 v[220:221], v243 offset:24576
  v_exp_f32 v37, v37
  v_exp_f32 v38, v38
  v_exp_f32 v39, v39
  ds_read_b64_tr_b16 v[222:223], v243 offset:28672
  v_cvt_pk_bf16_f32 v32, v32, v33
  v_cvt_pk_bf16_f32 v33, v34, v35
  v_cvt_pk_bf16_f32 v34, v36, v37
  s_waitcnt lgkmcnt(10)
  v_mfma_f32_16x16x32_bf16 v[148:151], v[200:203], v[16:19], v[148:151]
  v_cvt_pk_bf16_f32 v35, v38, v39
  v_fma_f32 v40, v40, s40, -v252
  s_waitcnt lgkmcnt(8)
  v_mfma_f32_16x16x32_bf16 v[156:159], v[204:207], v[16:19], v[156:159]
  v_fma_f32 v41, v41, s40, -v252
  v_fma_f32 v42, v42, s40, -v252
  v_fma_f32 v43, v43, s40, -v252
  v_mfma_f32_16x16x32_bf16 v[224:227], v[228:231], v[16:19], v[224:227]
  v_fma_f32 v44, v44, s40, -v252
  v_fma_f32 v45, v45, s40, -v252
  v_fma_f32 v46, v46, s40, -v252
  s_waitcnt lgkmcnt(6)
  v_mfma_f32_16x16x32_bf16 v[132:135], v[208:211], v[24:27], v[132:135]
  v_fma_f32 v47, v47, s40, -v252
  v_exp_f32 v40, v40
  v_exp_f32 v41, v41
  s_waitcnt lgkmcnt(4)
  v_mfma_f32_16x16x32_bf16 v[140:143], v[212:215], v[24:27], v[140:143]
  v_exp_f32 v42, v42
  v_exp_f32 v43, v43
  v_exp_f32 v44, v44
  s_waitcnt lgkmcnt(2)
  v_mfma_f32_16x16x32_bf16 v[148:151], v[216:219], v[24:27], v[148:151]
  v_exp_f32 v45, v45
  v_exp_f32 v46, v46
  v_exp_f32 v47, v47
  s_waitcnt lgkmcnt(0)
  v_mfma_f32_16x16x32_bf16 v[156:159], v[220:223], v[24:27], v[156:159]
  v_cvt_pk_bf16_f32 v40, v40, v41
  v_cvt_pk_bf16_f32 v41, v42, v43
  v_cvt_pk_bf16_f32 v42, v44, v45
  v_mfma_f32_16x16x32_bf16 v[224:227], v[228:231], v[24:27], v[224:227]
  v_cvt_pk_bf16_f32 v43, v46, v47
  s_barrier
  s_movk_i32 s98, 4608
  buffer_load_dwordx2 v[246:247], v249, s[68:71], s98 offen sc1
  ds_read_b64_tr_b16 v[192:193], v236 offset:32768
  ds_read_b64_tr_b16 v[194:195], v236 offset:36864
  ds_read_b64_tr_b16 v[196:197], v237 offset:32768
  ds_read_b64_tr_b16 v[198:199], v237 offset:36864
  ds_read_b64_tr_b16 v[200:201], v238 offset:32768
  ds_read_b64_tr_b16 v[202:203], v238 offset:36864
  ds_read_b64_tr_b16 v[204:205], v239 offset:32768
  ds_read_b64_tr_b16 v[206:207], v239 offset:36864
  ds_read_b64_tr_b16 v[208:209], v236 offset:40960
  ds_read_b64_tr_b16 v[210:211], v236 offset:45056
  ds_read_b64_tr_b16 v[212:213], v237 offset:40960
  ds_read_b64_tr_b16 v[214:215], v237 offset:45056
  s_cmp_lg_u32 s55, 0
  s_cbranch_scc1 L_x8
  v_cmp_eq_u64 vcc, v[244:245], v[254:255]
  s_nop 4
  s_and_b32 s98, vcc_lo, 0xff
  s_cmp_eq_u32 s98, s59
  s_cbranch_scc0 L_x9
  s_mov_b32 s55, 1
L_x8:
  buffer_load_dwordx4 v[4:7], v248, s[80:83], s89 offen offset:0 sc1
  buffer_load_dwordx4 v[12:15], v248, s[80:83], s89 offen offset:1024 sc1
  buffer_load_dwordx4 v[20:23], v248, s[80:83], s89 offen offset:2048 sc1
  buffer_load_dwordx4 v[28:31], v248, s[80:83], s89 offen offset:3072 sc1
  s_branch L_x10
L_x9:
  s_mov_b64 exec, 0xff
  buffer_load_dwordx2 v[244:245], v249, s[68:71], s53 offen offset:0 sc1
  s_mov_b64 exec, -1
L_x10:
  v_fma_f32 v48, v48, s40, -v252
  s_waitcnt lgkmcnt(10)
  v_mfma_f32_16x16x32_bf16 v[132:135], v[192:195], v[32:35], v[132:135]
  v_fma_f32 v49, v49, s40, -v252
  ds_read_b64_tr_b16 v[216:217], v238 offset:40960
  v_fma_f32 v50, v50, s40, -v252
  v_fma_f32 v51, v51, s40, -v252
  ds_read_b64_tr_b16 v[218:219], v238 offset:45056
  v_fma_f32 v52, v52, s40, -v252
  s_waitcnt lgkmcnt(10)
  v_mfma_f32_16x16x32_bf16 v[140:143], v[196:199], v[32:35], v[140:143]
  v_fma_f32 v53, v53, s40, -v252
  v_fma_f32 v54, v54, s40, -v252
  ds_read_b64_tr_b16 v[220:221], v239 offset:40960
  v_fma_f32 v55, v55, s40, -v252
  ds_read_b64_tr_b16 v[222:223], v239 offset:45056
  v_exp_f32 v48, v48
  v_exp_f32 v49, v49
  s_waitcnt lgkmcnt(10)
  v_mfma_f32_16x16x32_bf16 v[148:151], v[200:203], v[32:35], v[148:151]
  v_exp_f32 v50, v50
  v_exp_f32 v51, v51
  ds_read_b64_tr_b16 v[192:193], v240 offset:32768
  v_exp_f32 v52, v52
  ds_read_b64_tr_b16 v[194:195], v240 offset:36864
  v_exp_f32 v53, v53
  v_exp_f32 v54, v54
  s_waitcnt lgkmcnt(10)
  v_mfma_f32_16x16x32_bf16 v[156:159], v[204:207], v[32:35], v[156:159]
  v_exp_f32 v55, v55
  v_mfma_f32_16x16x32_bf16 v[224:227], v[228:231], v[32:35], v[224:227]
  v_cvt_pk_bf16_f32 v48, v48, v49
  v_cvt_pk_bf16_f32 v49, v50, v51
  ds_read_b64_tr_b16 v[196:197], v241 offset:32768
  v_cvt_pk_bf16_f32 v50, v52, v53
  ds_read_b64_tr_b16 v[198:199], v241 offset:36864
  v_cvt_pk_bf16_f32 v51, v54, v55
  v_fma_f32 v56, v56, s40, -v252
  s_waitcnt lgkmcnt(10)
  v_mfma_f32_16x16x32_bf16 v[132:135], v[208:211], v[40:43], v[132:135]
  v_fma_f32 v57, v57, s40, -v252
  ds_read_b64_tr_b16 v[200:201], v242 offset:32768
  v_fma_f32 v58, v58, s40, -v252
  v_fma_f32 v59, v59, s40, -v252
  ds_read_b64_tr_b16 v[202:203], v242 offset:36864
  v_fma_f32 v60, v60, s40, -v252
  s_waitcnt lgkmcnt(10)
  v_mfma_f32_16x16x32_bf16 v[140:143], v[212:215], v[40:43], v[140:143]
  v_fma_f32 v61, v61, s40, -v252
  v_fma_f32 v62, v62, s40, -v252
  ds_read_b64_tr_b16 v[204:205], v243 offset:32768
  v_fma_f32 v63, v63, s40, -v252
  ds_read_b64_tr_b16 v[206:207], v243 offset:36864
  v_exp_f32 v56, v56
  v_exp_f32 v57, v57
  s_waitcnt lgkmcnt(10)
  v_mfma_f32_16x16x32_bf16 v[148:151], v[216:219], v[40:43], v[148:151]
  v_exp_f32 v58, v58
  v_exp_f32 v59, v59
  ds_read_b64_tr_b16 v[208:209], v240 offset:40960
  v_exp_f32 v60, v60
  ds_read_b64_tr_b16 v[210:211], v240 offset:45056
  v_exp_f32 v61, v61
  v_exp_f32 v62, v62
  s_waitcnt lgkmcnt(10)
  v_mfma_f32_16x16x32_bf16 v[156:159], v[220:223], v[40:43], v[156:159]
  v_exp_f32 v63, v63
  v_mfma_f32_16x16x32_bf16 v[224:227], v[228:231], v[40:43], v[224:227]
  v_cvt_pk_bf16_f32 v56, v56, v57
  v_cvt_pk_bf16_f32 v57, v58, v59
  ds_read_b64_tr_b16 v[212:213], v241 offset:40960
  v_cvt_pk_bf16_f32 v58, v60, v61
  ds_read_b64_tr_b16 v[214:215], v241 offset:45056
  v_cvt_pk_bf16_f32 v59, v62, v63
  v_fma_f32 v64, v64, s40, -v252
  s_waitcnt lgkmcnt(10)
  v_mfma_f32_16x16x32_bf16 v[132:135], v[192:195], v[48:51], v[132:135]
  v_fma_f32 v65, v65, s40, -v252
  v_fma_f32 v66, v66, s40, -v252
  v_fma_f32 v67, v67, s40, -v252
  ds_read_b64_tr_b16 v[216:217], v242 offset:40960
  v_fma_f32 v68, v68, s40, -v252
  v_fma_f32 v69, v69, s40, -v252
  v_fma_f32 v70, v70, s40, -v252
  ds_read_b64_tr_b16 v[218:219], v242 offset:45056
  v_fma_f32 v71, v71, s40, -v252
  v_exp_f32 v64, v64
  v_exp_f32 v65, v65
  s_waitcnt lgkmcnt(10)
  v_mfma_f32_16x16x32_bf16 v[140:143], v[196:199], v[48:51], v[140:143]
  v_exp_f32 v66, v66
  v_exp_f32 v67, v67
  v_exp_f32 v68, v68
  ds_read_b64_tr_b16 v[220:221], v243 offset:40960
  v_exp_f32 v69, v69
  v_exp_f32 v70, v70
  v_exp_f32 v71, v71
  ds_read_b64_tr_b16 v[222:223], v243 offset:45056
  v_cvt_pk_bf16_f32 v64, v64, v65
  v_cvt_pk_bf16_f32 v65, v66, v67
  v_cvt_pk_bf16_f32 v66, v68, v69
  s_waitcnt lgkmcnt(10)
  v_mfma_f32_16x16x32_bf16 v[148:151], v[200:203], v[48:51], v[148:151]
  v_cvt_pk_bf16_f32 v67, v70, v71
  v_fma_f32 v72, v72, s40, -v252
  s_waitcnt lgkmcnt(8)
  v_mfma_f32_16x16x32_bf16 v[156:159], v[204:207], v[48:51], v[156:159]
  v_fma_f32 v73, v73, s40, -v252
  v_fma_f32 v74, v74, s40, -v252
  v_fma_f32 v75, v75, s40, -v252
  v_mfma_f32_16x16x32_bf16 v[224:227], v[228:231], v[48:51], v[224:227]
  v_fma_f32 v76, v76, s40, -v252
  v_fma_f32 v77, v77, s40, -v252
  v_fma_f32 v78, v78, s40, -v252
  s_waitcnt lgkmcnt(6)
  v_mfma_f32_16x16x32_bf16 v[132:135], v[208:211], v[56:59], v[132:135]
  v_fma_f32 v79, v79, s40, -v252
  v_exp_f32 v72, v72
  v_exp_f32 v73, v73
  s_waitcnt lgkmcnt(4)
  v_mfma_f32_16x16x32_bf16 v[140:143], v[212:215], v[56:59], v[140:143]
  v_exp_f32 v74, v74
  v_exp_f32 v75, v75
  v_exp_f32 v76, v76
  s_waitcnt lgkmcnt(2)
  v_mfma_f32_16x16x32_bf16 v[148:151], v[216:219], v[56:59], v[148:151]
  v_exp_f32 v77, v77
  v_exp_f32 v78, v78
  v_exp_f32 v79, v79
  s_waitcnt lgkmcnt(0)
  v_mfma_f32_16x16x32_bf16 v[156:159], v[220:223], v[56:59], v[156:159]
  v_cvt_pk_bf16_f32 v72, v72, v73
  v_cvt_pk_bf16_f32 v73, v74, v75
  v_cvt_pk_bf16_f32 v74, v76, v77
  v_mfma_f32_16x16x32_bf16 v[224:227], v[228:231], v[56:59], v[224:227]
  v_cvt_pk_bf16_f32 v75, v78, v79
  s_barrier
  ds_read_b64_tr_b16 v[192:193], v236 offset:49152
  ds_read_b64_tr_b16 v[194:195], v236 offset:53248
  ds_read_b64_tr_b16 v[196:197], v237 offset:49152
  ds_read_b64_tr_b16 v[198:199], v237 offset:53248
  ds_read_b64_tr_b16 v[200:201], v238 offset:49152
  ds_read_b64_tr_b16 v[202:203], v238 offset:53248
  ds_read_b64_tr_b16 v[204:205], v239 offset:49152
  ds_read_b64_tr_b16 v[206:207], v239 offset:53248
  ds_read_b64_tr_b16 v[208:209], v236 offset:57344
  ds_read_b64_tr_b16 v[210:211], v236 offset:61440
  ds_read_b64_tr_b16 v[212:213], v237 offset:57344
  ds_read_b64_tr_b16 v[214:215], v237 offset:61440
  s_cmp_lg_u32 s55, 0
  s_cbranch_scc1 L_x11
  v_cmp_eq_u64 vcc, v[244:245], v[254:255]
  s_nop 4
  s_and_b32 s98, vcc_lo, 0xff
  s_cmp_eq_u32 s98, s59
  s_cbranch_scc0 L_x12
  s_mov_b32 s55, 1
  buffer_load_dwordx4 v[4:7], v248, s[80:83], s89 offen offset:0 sc1
  buffer_load_dwordx4 v[12:15], v248, s[80:83], s89 offen offset:1024 sc1
  buffer_load_dwordx4 v[20:23], v248, s[80:83], s89 offen offset:2048 sc1
  buffer_load_dwordx4 v[28:31], v248, s[80:83], s89 offen offset:3072 sc1
L_x11:
  buffer_load_dwordx4 v[36:39], v248, s[80:83], s90 offen offset:0 sc1
  buffer_load_dwordx4 v[44:47], v248, s[80:83], s90 offen offset:1024 sc1
  buffer_load_dwordx4 v[52:55], v248, s[80:83], s90 offen offset:2048 sc1
  buffer_load_dwordx4 v[60:63], v248, s[80:83], s90 offen offset:3072 sc1
  s_branch L_x13
L_x12:
  s_mov_b64 exec, 0xff
  buffer_load_dwordx2 v[244:245], v249, s[68:71], s53 offen offset:0 sc1
  s_mov_b64 exec, -1
L_x13:
  v_fma_f32 v80, v80, s40, -v252
  s_waitcnt lgkmcnt(10)
  v_mfma_f32_16x16x32_bf16 v[132:135], v[192:195], v[64:67], v[132:135]
  v_fma_f32 v81, v81, s40, -v252
  ds_read_b64_tr_b16 v[216:217], v238 offset:57344
  v_fma_f32 v82, v82, s40, -v252
  v_fma_f32 v83, v83, s40, -v252
  ds_read_b64_tr_b16 v[218:219], v238 offset:61440
  v_fma_f32 v84, v84, s40, -v252
  s_waitcnt lgkmcnt(10)
  v_mfma_f32_16x16x32_bf16 v[140:143], v[196:199], v[64:67], v[140:143]
  v_fma_f32 v85, v85, s40, -v252
  v_fma_f32 v86, v86, s40, -v252
  ds_read_b64_tr_b16 v[220:221], v239 offset:57344
  v_fma_f32 v87, v87, s40, -v252
  ds_read_b64_tr_b16 v[222:223], v239 offset:61440
  v_exp_f32 v80, v80
  v_exp_f32 v81, v81
  s_waitcnt lgkmcnt(10)
  v_mfma_f32_16x16x32_bf16 v[148:151], v[200:203], v[64:67], v[148:151]
  v_exp_f32 v82, v82
  v_exp_f32 v83, v83
  ds_read_b64_tr_b16 v[192:193], v240 offset:49152
  v_exp_f32 v84, v84
  ds_read_b64_tr_b16 v[194:195], v240 offset:53248
  v_exp_f32 v85, v85
  v_exp_f32 v86, v86
  s_waitcnt lgkmcnt(10)
  v_mfma_f32_16x16x32_bf16 v[156:159], v[204:207], v[64:67], v[156:159]
  v_exp_f32 v87, v87
  v_mfma_f32_16x16x32_bf16 v[224:227], v[228:231], v[64:67], v[224:227]
  v_cvt_pk_bf16_f32 v80, v80, v81
  v_cvt_pk_bf16_f32 v81, v82, v83
  ds_read_b64_tr_b16 v[196:197], v241 offset:49152
  v_cvt_pk_bf16_f32 v82, v84, v85
  ds_read_b64_tr_b16 v[198:199], v241 offset:53248
  v_cvt_pk_bf16_f32 v83, v86, v87
  v_fma_f32 v88, v88, s40, -v252
  s_waitcnt lgkmcnt(10)
  v_mfma_f32_16x16x32_bf16 v[132:135], v[208:211], v[72:75], v[132:135]
  v_fma_f32 v89, v89, s40, -v252
  ds_read_b64_tr_b16 v[200:201], v242 offset:49152
  v_fma_f32 v90, v90, s40, -v252
  v_fma_f32 v91, v91, s40, -v252
  ds_read_b64_tr_b16 v[202:203], v242 offset:53248
  v_fma_f32 v92, v92, s40, -v252
  s_waitcnt lgkmcnt(10)
  v_mfma_f32_16x16x32_bf16 v[140:143], v[212:215], v[72:75], v[140:143]
  v_fma_f32 v93, v93, s40, -v252
  v_fma_f32 v94, v94, s40, -v252
  ds_read_b64_tr_b16 v[204:205], v243 offset:49152
  v_fma_f32 v95, v95, s40, -v252
  ds_read_b64_tr_b16 v[206:207], v243 offset:53248
  v_exp_f32 v88, v88
  v_exp_f32 v89, v89
  s_waitcnt lgkmcnt(10)
  v_mfma_f32_16x16x32_bf16 v[148:151], v[216:219], v[72:75], v[148:151]
  v_exp_f32 v90, v90
  v_exp_f32 v91, v91
  ds_read_b64_tr_b16 v[208:209], v240 offset:57344
  v_exp_f32 v92, v92
  ds_read_b64_tr_b16 v[210:211], v240 offset:61440
  v_exp_f32 v93, v93
  v_exp_f32 v94, v94
  s_waitcnt lgkmcnt(10)
  v_mfma_f32_16x16x32_bf16 v[156:159], v[220:223], v[72:75], v[156:159]
  v_exp_f32 v95, v95
  v_mfma_f32_16x16x32_bf16 v[224:227], v[228:231], v[72:75], v[224:227]
  v_cvt_pk_bf16_f32 v88, v88, v89
  v_cvt_pk_bf16_f32 v89, v90, v91
  ds_read_b64_tr_b16 v[212:213], v241 offset:57344
  v_cvt_pk_bf16_f32 v90, v92, v93
  ds_read_b64_tr_b16 v[214:215], v241 offset:61440
  v_cvt_pk_bf16_f32 v91, v94, v95
  v_fma_f32 v96, v96, s40, -v252
  s_waitcnt lgkmcnt(10)
  v_mfma_f32_16x16x32_bf16 v[132:135], v[192:195], v[80:83], v[132:135]
  v_fma_f32 v97, v97, s40, -v252
  v_fma_f32 v98, v98, s40, -v252
  v_fma_f32 v99, v99, s40, -v252
  ds_read_b64_tr_b16 v[216:217], v242 offset:57344
  v_fma_f32 v100, v100, s40, -v252
  v_fma_f32 v101, v101, s40, -v252
  v_fma_f32 v102, v102, s40, -v252
  ds_read_b64_tr_b16 v[218:219], v242 offset:61440
  v_fma_f32 v103, v103, s40, -v252
  v_exp_f32 v96, v96
  v_exp_f32 v97, v97
  s_waitcnt lgkmcnt(10)
  v_mfma_f32_16x16x32_bf16 v[140:143], v[196:199], v[80:83], v[140:143]
  v_exp_f32 v98, v98
  v_exp_f32 v99, v99
  v_exp_f32 v100, v100
  ds_read_b64_tr_b16 v[220:221], v243 offset:57344
  v_exp_f32 v101, v101
  v_exp_f32 v102, v102
  v_exp_f32 v103, v103
  ds_read_b64_tr_b16 v[222:223], v243 offset:61440
  v_cvt_pk_bf16_f32 v96, v96, v97
  v_cvt_pk_bf16_f32 v97, v98, v99
  v_cvt_pk_bf16_f32 v98, v100, v101
  s_waitcnt lgkmcnt(10)
  v_mfma_f32_16x16x32_bf16 v[148:151], v[200:203], v[80:83], v[148:151]
  v_cvt_pk_bf16_f32 v99, v102, v103
  v_fma_f32 v104, v104, s40, -v252
  s_waitcnt lgkmcnt(8)
  v_mfma_f32_16x16x32_bf16 v[156:159], v[204:207], v[80:83], v[156:159]
  v_fma_f32 v105, v105, s40, -v252
  v_fma_f32 v106, v106, s40, -v252
  v_fma_f32 v107, v107, s40, -v252
  v_mfma_f32_16x16x32_bf16 v[224:227], v[228:231], v[80:83], v[224:227]
  v_fma_f32 v108, v108, s40, -v252
  v_fma_f32 v109, v109, s40, -v252
  v_fma_f32 v110, v110, s40, -v252
  s_waitcnt lgkmcnt(6)
  v_mfma_f32_16x16x32_bf16 v[132:135], v[208:211], v[88:91], v[132:135]
  v_fma_f32 v111, v111, s40, -v252
  v_exp_f32 v104, v104
  v_exp_f32 v105, v105
  s_waitcnt lgkmcnt(4)
  v_mfma_f32_16x16x32_bf16 v[140:143], v[212:215], v[88:91], v[140:143]
  v_exp_f32 v106, v106
  v_exp_f32 v107, v107
  v_exp_f32 v108, v108
  s_waitcnt lgkmcnt(2)
  v_mfma_f32_16x16x32_bf16 v[148:151], v[216:219], v[88:91], v[148:151]
  v_exp_f32 v109, v109
  v_exp_f32 v110, v110
  v_exp_f32 v111, v111
  s_waitcnt lgkmcnt(0)
  v_mfma_f32_16x16x32_bf16 v[156:159], v[220:223], v[88:91], v[156:159]
  v_cvt_pk_bf16_f32 v104, v104, v105
  v_cvt_pk_bf16_f32 v105, v106, v107
  v_cvt_pk_bf16_f32 v106, v108, v109
  v_mfma_f32_16x16x32_bf16 v[224:227], v[228:231], v[88:91], v[224:227]
  v_cvt_pk_bf16_f32 v107, v110, v111
  s_barrier
  v_add_u32 v236, 131072, v236
  v_add_u32 v237, 131072, v237
  v_add_u32 v238, 131072, v238
  v_add_u32 v239, 131072, v239
  v_add_u32 v240, 131072, v240
  v_add_u32 v241, 131072, v241
  v_add_u32 v242, 131072, v242
  v_add_u32 v243, 131072, v243
  ds_read_b64_tr_b16 v[192:193], v236 offset:16384
  ds_read_b64_tr_b16 v[194:195], v236 offset:20480
  ds_read_b64_tr_b16 v[196:197], v237 offset:16384
  ds_read_b64_tr_b16 v[198:199], v237 offset:20480
  ds_read_b64_tr_b16 v[200:201], v238 offset:16384
  ds_read_b64_tr_b16 v[202:203], v238 offset:20480
  ds_read_b64_tr_b16 v[204:205], v239 offset:16384
  ds_read_b64_tr_b16 v[206:207], v239 offset:20480
  ds_read_b64_tr_b16 v[208:209], v236 offset:24576
  ds_read_b64_tr_b16 v[210:211], v236 offset:28672
  ds_read_b64_tr_b16 v[212:213], v237 offset:24576
  ds_read_b64_tr_b16 v[214:215], v237 offset:28672
  s_cmp_lg_u32 s55, 0
  s_cbranch_scc1 L_x14
  v_cmp_eq_u64 vcc, v[244:245], v[254:255]
  s_nop 4
  s_and_b32 s98, vcc_lo, 0xff
  s_cmp_eq_u32 s98, s59
  s_cbranch_scc0 L_x15
  s_mov_b32 s55, 1
  buffer_load_dwordx4 v[4:7], v248, s[80:83], s89 offen offset:0 sc1
  buffer_load_dwordx4 v[12:15], v248, s[80:83], s89 offen offset:1024 sc1
  buffer_load_dwordx4 v[20:23], v248, s[80:83], s89 offen offset:2048 sc1
  buffer_load_dwordx4 v[28:31], v248, s[80:83], s89 offen offset:3072 sc1
  buffer_load_dwordx4 v[36:39], v248, s[80:83], s90 offen offset:0 sc1
  buffer_load_dwordx4 v[44:47], v248, s[80:83], s90 offen offset:1024 sc1
  buffer_load_dwordx4 v[52:55], v248, s[80:83], s90 offen offset:2048 sc1
  buffer_load_dwordx4 v[60:63], v248, s[80:83], s90 offen offset:3072 sc1
L_x14:
  buffer_load_dwordx4 v[68:71], v248, s[80:83], s91 offen offset:0 sc1
  buffer_load_dwordx4 v[76:79], v248, s[80:83], s91 offen offset:1024 sc1
  buffer_load_dwordx4 v[84:87], v248, s[80:83], s91 offen offset:2048 sc1
  buffer_load_dwordx4 v[92:95], v248, s[80:83], s91 offen offset:3072 sc1
  s_branch L_x16
L_x15:
  s_mov_b64 exec, 0xff
  buffer_load_dwordx2 v[244:245], v249, s[68:71], s53 offen offset:0 sc1
  s_mov_b64 exec, -1
L_x16:
  v_fma_f32 v112, v112, s40, -v252
  s_waitcnt lgkmcnt(10)
  v_mfma_f32_16x16x32_bf16 v[132:135], v[192:195], v[96:99], v[132:135]
  v_fma_f32 v113, v113, s40, -v252
  ds_read_b64_tr_b16 v[216:217], v238 offset:24576
  v_fma_f32 v114, v114, s40, -v252
  v_fma_f32 v115, v115, s40, -v252
  ds_read_b64_tr_b16 v[218:219], v238 offset:28672
  v_fma_f32 v116, v116, s40, -v252
  s_waitcnt lgkmcnt(10)
  v_mfma_f32_16x16x32_bf16 v[140:143], v[196:199], v[96:99], v[140:143]
  v_fma_f32 v117, v117, s40, -v252
  v_fma_f32 v118, v118, s40, -v252
  ds_read_b64_tr_b16 v[220:221], v239 offset:24576
  v_fma_f32 v119, v119, s40, -v252
  ds_read_b64_tr_b16 v[222:223], v239 offset:28672
  v_exp_f32 v112, v112
  v_exp_f32 v113, v113
  s_waitcnt lgkmcnt(10)
  v_mfma_f32_16x16x32_bf16 v[148:151], v[200:203], v[96:99], v[148:151]
  v_exp_f32 v114, v114
  v_exp_f32 v115, v115
  ds_read_b64_tr_b16 v[192:193], v240 offset:16384
  v_exp_f32 v116, v116
  ds_read_b64_tr_b16 v[194:195], v240 offset:20480
  v_exp_f32 v117, v117
  v_exp_f32 v118, v118
  s_waitcnt lgkmcnt(10)
  v_mfma_f32_16x16x32_bf16 v[156:159], v[204:207], v[96:99], v[156:159]
  v_exp_f32 v119, v119
  v_mfma_f32_16x16x32_bf16 v[224:227], v[228:231], v[96:99], v[224:227]
  v_cvt_pk_bf16_f32 v112, v112, v113
  v_cvt_pk_bf16_f32 v113, v114, v115
  ds_read_b64_tr_b16 v[196:197], v241 offset:16384
  v_cvt_pk_bf16_f32 v114, v116, v117
  ds_read_b64_tr_b16 v[198:199], v241 offset:20480
  v_cvt_pk_bf16_f32 v115, v118, v119
  v_fma_f32 v120, v120, s40, -v252
  s_waitcnt lgkmcnt(10)
  v_mfma_f32_16x16x32_bf16 v[132:135], v[208:211], v[104:107], v[132:135]
  v_fma_f32 v121, v121, s40, -v252
  ds_read_b64_tr_b16 v[200:201], v242 offset:16384
  v_fma_f32 v122, v122, s40, -v252
  v_fma_f32 v123, v123, s40, -v252
  ds_read_b64_tr_b16 v[202:203], v242 offset:20480
  v_fma_f32 v124, v124, s40, -v252
  s_waitcnt lgkmcnt(10)
  v_mfma_f32_16x16x32_bf16 v[140:143], v[212:215], v[104:107], v[140:143]
  v_fma_f32 v125, v125, s40, -v252
  v_fma_f32 v126, v126, s40, -v252
  ds_read_b64_tr_b16 v[204:205], v243 offset:16384
  v_fma_f32 v127, v127, s40, -v252
  ds_read_b64_tr_b16 v[206:207], v243 offset:20480
  v_exp_f32 v120, v120
  v_exp_f32 v121, v121
  s_waitcnt lgkmcnt(10)
  v_mfma_f32_16x16x32_bf16 v[148:151], v[216:219], v[104:107], v[148:151]
  v_exp_f32 v122, v122
  v_exp_f32 v123, v123
  ds_read_b64_tr_b16 v[208:209], v240 offset:24576
  v_exp_f32 v124, v124
  ds_read_b64_tr_b16 v[210:211], v240 offset:28672
  v_exp_f32 v125, v125
  v_exp_f32 v126, v126
  s_waitcnt lgkmcnt(10)
  v_mfma_f32_16x16x32_bf16 v[156:159], v[220:223], v[104:107], v[156:159]
  v_exp_f32 v127, v127
  v_mfma_f32_16x16x32_bf16 v[224:227], v[228:231], v[104:107], v[224:227]
  v_cvt_pk_bf16_f32 v120, v120, v121
  v_cvt_pk_bf16_f32 v121, v122, v123
  ds_read_b64_tr_b16 v[212:213], v241 offset:24576
  v_cvt_pk_bf16_f32 v122, v124, v125
  ds_read_b64_tr_b16 v[214:215], v241 offset:28672
  v_cvt_pk_bf16_f32 v123, v126, v127
  s_waitcnt lgkmcnt(10)
  v_mfma_f32_16x16x32_bf16 v[132:135], v[192:195], v[112:115], v[132:135]
  ds_read_b64_tr_b16 v[216:217], v242 offset:24576
  ds_read_b64_tr_b16 v[218:219], v242 offset:28672
  s_waitcnt lgkmcnt(10)
  v_mfma_f32_16x16x32_bf16 v[140:143], v[196:199], v[112:115], v[140:143]
  ds_read_b64_tr_b16 v[220:221], v243 offset:24576
  ds_read_b64_tr_b16 v[222:223], v243 offset:28672
  s_waitcnt lgkmcnt(10)
  v_mfma_f32_16x16x32_bf16 v[148:151], v[200:203], v[112:115], v[148:151]
  s_waitcnt lgkmcnt(8)
  v_mfma_f32_16x16x32_bf16 v[156:159], v[204:207], v[112:115], v[156:159]
  v_mfma_f32_16x16x32_bf16 v[224:227], v[228:231], v[112:115], v[224:227]
  s_waitcnt lgkmcnt(6)
  v_mfma_f32_16x16x32_bf16 v[132:135], v[208:211], v[120:123], v[132:135]
  s_waitcnt lgkmcnt(4)
  v_mfma_f32_16x16x32_bf16 v[140:143], v[212:215], v[120:123], v[140:143]
  s_waitcnt lgkmcnt(2)
  v_mfma_f32_16x16x32_bf16 v[148:151], v[216:219], v[120:123], v[148:151]
  s_waitcnt lgkmcnt(0)
  v_mfma_f32_16x16x32_bf16 v[156:159], v[220:223], v[120:123], v[156:159]
  v_mfma_f32_16x16x32_bf16 v[224:227], v[228:231], v[120:123], v[224:227]
  s_barrier
  v_sub_u32 v251, v246, v254
  v_cmp_eq_u32 vcc, s49, v251
  v_cmp_eq_u32_e64 s[98:99], v247, v255
  s_nop 1
  s_and_b32 s98, s98, vcc_lo
  s_cmp_eq_u32 s98, -1
  s_cselect_b32 s67, 1, s67
  v_subrev_u32 v236, 65536, v236
  v_subrev_u32 v237, 65536, v237
  v_subrev_u32 v238, 65536, v238
  v_subrev_u32 v239, 65536, v239
  v_subrev_u32 v240, 65536, v240
  v_subrev_u32 v241, 65536, v241
  v_subrev_u32 v242, 65536, v242
  v_subrev_u32 v243, 65536, v243
  ds_read_b64_tr_b16 v[192:193], v236 offset:49152
  ds_read_b64_tr_b16 v[194:195], v236 offset:53248
  ds_read_b64_tr_b16 v[196:197], v237 offset:49152
  ds_read_b64_tr_b16 v[198:199], v237 offset:53248
  ds_read_b64_tr_b16 v[200:201], v238 offset:49152
  ds_read_b64_tr_b16 v[202:203], v238 offset:53248
  ds_read_b64_tr_b16 v[204:205], v239 offset:49152
  ds_read_b64_tr_b16 v[206:207], v239 offset:53248
  ds_read_b64_tr_b16 v[208:209], v236 offset:57344
  ds_read_b64_tr_b16 v[210:211], v236 offset:61440
  ds_read_b64_tr_b16 v[212:213], v237 offset:57344
  ds_read_b64_tr_b16 v[214:215], v237 offset:61440
  s_cmp_lg_u32 s55, 0
  s_cbranch_scc1 L_x17
  v_cmp_eq_u64 vcc, v[244:245], v[254:255]
  s_nop 4
  s_and_b32 s98, vcc_lo, 0xff
  s_cmp_eq_u32 s98, s59
  s_cbranch_scc0 L_x18
  s_mov_b32 s55, 1
  buffer_load_dwordx4 v[4:7], v248, s[80:83], s89 offen offset:0 sc1
  buffer_load_dwordx4 v[12:15], v248, s[80:83], s89 offen offset:1024 sc1
  buffer_load_dwordx4 v[20:23], v248, s[80:83], s89 offen offset:2048 sc1
  buffer_load_dwordx4 v[28:31], v248, s[80:83], s89 offen offset:3072 sc1
  buffer_load_dwordx4 v[36:39], v248, s[80:83], s90 offen offset:0 sc1
  buffer_load_dwordx4 v[44:47], v248, s[80:83], s90 offen offset:1024 sc1
  buffer_load_dwordx4 v[52:55], v248, s[80:83], s90 offen offset:2048 sc1
  buffer_load_dwordx4 v[60:63], v248, s[80:83], s90 offen offset:3072 sc1
  buffer_load_dwordx4 v[68:71], v248, s[80:83], s91 offen offset:0 sc1
  buffer_load_dwordx4 v[76:79], v248, s[80:83], s91 offen offset:1024 sc1
  buffer_load_dwordx4 v[84:87], v248, s[80:83], s91 offen offset:2048 sc1
  buffer_load_dwordx4 v[92:95], v248, s[80:83], s91 offen offset:3072 sc1
L_x17:
  buffer_load_dwordx4 v[100:103], v248, s[80:83], s92 offen offset:0 sc1
  buffer_load_dwordx4 v[108:111], v248, s[80:83], s92 offen offset:1024 sc1
  buffer_load_dwordx4 v[116:119], v248, s[80:83], s92 offen offset:2048 sc1
  buffer_load_dwordx4 v[124:127], v248, s[80:83], s92 offen offset:3072 sc1
  s_branch L_x19
L_x18:
  s_mov_b64 exec, 0xff
  buffer_load_dwordx2 v[244:245], v249, s[68:71], s53 offen offset:0 sc1
  s_mov_b64 exec, -1
L_x19:
  s_waitcnt lgkmcnt(10)
  v_mfma_f32_16x16x32_bf16 v[164:167], v[192:195], v[0:3], 0
  v_rcp_f32 v251, v224
  ds_read_b64_tr_b16 v[216:217], v238 offset:57344
  v_mul_f32 v132, v132, v251
  ds_read_b64_tr_b16 v[218:219], v238 offset:61440
  v_mul_f32 v133, v133, v251
  s_waitcnt lgkmcnt(10)
  v_mfma_f32_16x16x32_bf16 v[172:175], v[196:199], v[0:3], 0
  v_mul_f32 v134, v134, v251
  ds_read_b64_tr_b16 v[220:221], v239 offset:57344
  v_mul_f32 v135, v135, v251
  ds_read_b64_tr_b16 v[222:223], v239 offset:61440
  v_mul_f32 v140, v140, v251
  s_waitcnt lgkmcnt(10)
  v_mfma_f32_16x16x32_bf16 v[180:183], v[200:203], v[0:3], 0
  v_mul_f32 v141, v141, v251
  ds_read_b64_tr_b16 v[192:193], v240 offset:49152
  v_mul_f32 v142, v142, v251
  ds_read_b64_tr_b16 v[194:195], v240 offset:53248
  v_mul_f32 v143, v143, v251
  s_waitcnt lgkmcnt(10)
  v_mfma_f32_16x16x32_bf16 v[188:191], v[204:207], v[0:3], 0
  v_cvt_pk_bf16_f32 v132, v132, v133
  ds_read_b64_tr_b16 v[196:197], v241 offset:49152
  v_cvt_pk_bf16_f32 v133, v134, v135
  ds_read_b64_tr_b16 v[198:199], v241 offset:53248
  s_waitcnt lgkmcnt(10)
  v_mfma_f32_16x16x32_bf16 v[164:167], v[208:211], v[8:11], v[164:167]
  v_cvt_pk_bf16_f32 v134, v140, v141
  ds_read_b64_tr_b16 v[200:201], v242 offset:49152
  v_cvt_pk_bf16_f32 v135, v142, v143
  ds_read_b64_tr_b16 v[202:203], v242 offset:53248
  v_cndmask_b32_e64 v160, v132, v134, s[42:43]
  s_waitcnt lgkmcnt(10)
  v_mfma_f32_16x16x32_bf16 v[172:175], v[212:215], v[8:11], v[172:175]
  v_cndmask_b32_e64 v161, v133, v135, s[42:43]
  ds_read_b64_tr_b16 v[204:205], v243 offset:49152
  v_cndmask_b32_e64 v162, v134, v132, s[42:43]
  ds_read_b64_tr_b16 v[206:207], v243 offset:53248
  v_cndmask_b32_e64 v163, v135, v133, s[42:43]
  s_waitcnt lgkmcnt(10)
  v_mfma_f32_16x16x32_bf16 v[180:183], v[216:219], v[8:11], v[180:183]
  v_mul_f32 v148, v148, v251
  ds_read_b64_tr_b16 v[208:209], v240 offset:57344
  v_mul_f32 v149, v149, v251
  ds_read_b64_tr_b16 v[210:211], v240 offset:61440
  v_mul_f32 v150, v150, v251
  s_waitcnt lgkmcnt(10)
  v_mfma_f32_16x16x32_bf16 v[188:191], v[220:223], v[8:11], v[188:191]
  v_mul_f32 v151, v151, v251
  ds_read_b64_tr_b16 v[212:213], v241 offset:57344
  v_mul_f32 v156, v156, v251
  ds_read_b64_tr_b16 v[214:215], v241 offset:61440
  s_waitcnt lgkmcnt(10)
  v_mfma_f32_16x16x32_bf16 v[164:167], v[192:195], v[16:19], v[164:167]
  v_mul_f32 v157, v157, v251
  ds_read_b64_tr_b16 v[216:217], v242 offset:57344
  v_mul_f32 v158, v158, v251
  ds_read_b64_tr_b16 v[218:219], v242 offset:61440
  v_mul_f32 v159, v159, v251
  s_waitcnt lgkmcnt(10)
  v_mfma_f32_16x16x32_bf16 v[172:175], v[196:199], v[16:19], v[172:175]
  v_cvt_pk_bf16_f32 v148, v148, v149
  ds_read_b64_tr_b16 v[220:221], v243 offset:57344
  v_cvt_pk_bf16_f32 v149, v150, v151
  ds_read_b64_tr_b16 v[222:223], v243 offset:61440
  v_cvt_pk_bf16_f32 v150, v156, v157
  s_waitcnt lgkmcnt(10)
  v_mfma_f32_16x16x32_bf16 v[180:183], v[200:203], v[16:19], v[180:183]
  v_cvt_pk_bf16_f32 v151, v158, v159
  s_waitcnt lgkmcnt(8)
  v_mfma_f32_16x16x32_bf16 v[188:191], v[204:207], v[16:19], v[188:191]
  v_cndmask_b32_e64 v168, v148, v150, s[42:43]
  s_waitcnt lgkmcnt(6)
  v_mfma_f32_16x16x32_bf16 v[164:167], v[208:211], v[24:27], v[164:167]
  v_cndmask_b32_e64 v169, v149, v151, s[42:43]
  s_waitcnt lgkmcnt(4)
  v_mfma_f32_16x16x32_bf16 v[172:175], v[212:215], v[24:27], v[172:175]
  v_cndmask_b32_e64 v170, v150, v148, s[42:43]
  s_waitcnt lgkmcnt(2)
  v_mfma_f32_16x16x32_bf16 v[180:183], v[216:219], v[24:27], v[180:183]
  v_cndmask_b32_e64 v171, v151, v149, s[42:43]
  s_waitcnt lgkmcnt(0)
  v_mfma_f32_16x16x32_bf16 v[188:191], v[220:223], v[24:27], v[188:191]
  s_cmp_lg_u32 s67, 0
  s_cbranch_scc1 L_x20
  buffer_store_dwordx4 v[160:163], v253, s[32:35], s41 offen offset:0 sc1
  buffer_store_dwordx4 v[168:171], v253, s[32:35], s41 offen offset:1024 sc1
  s_branch L_x21
L_x20:
  buffer_store_dwordx4 v[160:163], v253, s[32:35], s41 offen offset:0
  buffer_store_dwordx4 v[168:171], v253, s[32:35], s41 offen offset:1024
L_x21:
  s_barrier
  v_add_u32 v236, 65536, v236
  v_add_u32 v237, 65536, v237
  v_add_u32 v238, 65536, v238
  v_add_u32 v239, 65536, v239
  v_add_u32 v240, 65536, v240
  v_add_u32 v241, 65536, v241
  v_add_u32 v242, 65536, v242
  v_add_u32 v243, 65536, v243
  ds_read_b64_tr_b16 v[192:193], v236 offset:0
  ds_read_b64_tr_b16 v[194:195], v236 offset:4096
  ds_read_b64_tr_b16 v[196:197], v237 offset:0
  ds_read_b64_tr_b16 v[198:199], v237 offset:4096
  ds_read_b64_tr_b16 v[200:201], v238 offset:0
  ds_read_b64_tr_b16 v[202:203], v238 offset:4096
  ds_read_b64_tr_b16 v[204:205], v239 offset:0
  ds_read_b64_tr_b16 v[206:207], v239 offset:4096
  ds_read_b64_tr_b16 v[208:209], v236 offset:8192
  ds_read_b64_tr_b16 v[210:211], v236 offset:12288
  ds_read_b64_tr_b16 v[212:213], v237 offset:8192
  ds_read_b64_tr_b16 v[214:215], v237 offset:12288
  s_cmp_lg_u32 s55, 0
  s_cbranch_scc1 L_x22
  v_cmp_eq_u64 vcc, v[244:245], v[254:255]
  s_nop 4
  s_and_b32 s98, vcc_lo, 0xff
  s_cmp_eq_u32 s98, s59
  s_cbranch_scc0 L_x23
  s_mov_b32 s55, 1
  buffer_load_dwordx4 v[4:7], v248, s[80:83], s89 offen offset:0 sc1
  buffer_load_dwordx4 v[12:15], v248, s[80:83], s89 offen offset:1024 sc1
  buffer_load_dwordx4 v[20:23], v248, s[80:83], s89 offen offset:2048 sc1
  buffer_load_dwordx4 v[28:31], v248, s[80:83], s89 offen offset:3072 sc1
  buffer_load_dwordx4 v[36:39], v248, s[80:83], s90 offen offset:0 sc1
  buffer_load_dwordx4 v[44:47], v248, s[80:83], s90 offen offset:1024 sc1
  buffer_load_dwordx4 v[52:55], v248, s[80:83], s90 offen offset:2048 sc1
  buffer_load_dwordx4 v[60:63], v248, s[80:83], s90 offen offset:3072 sc1
  buffer_load_dwordx4 v[68:71], v248, s[80:83], s91 offen offset:0 sc1
  buffer_load_dwordx4 v[76:79], v248, s[80:83], s91 offen offset:1024 sc1
  buffer_load_dwordx4 v[84:87], v248, s[80:83], s91 offen offset:2048 sc1
  buffer_load_dwordx4 v[92:95], v248, s[80:83], s91 offen offset:3072 sc1
  buffer_load_dwordx4 v[100:103], v248, s[80:83], s92 offen offset:0 sc1
  buffer_load_dwordx4 v[108:111], v248, s[80:83], s92 offen offset:1024 sc1
  buffer_load_dwordx4 v[116:119], v248, s[80:83], s92 offen offset:2048 sc1
  buffer_load_dwordx4 v[124:127], v248, s[80:83], s92 offen offset:3072 sc1
L_x22:
  buffer_load_dwordx4 v[0:3], v248, s[80:83], s93 offen offset:0 sc1
  buffer_load_dwordx4 v[8:11], v248, s[80:83], s93 offen offset:1024 sc1
  buffer_load_dwordx4 v[16:19], v248, s[80:83], s93 offen offset:2048 sc1
  buffer_load_dwordx4 v[24:27], v248, s[80:83], s93 offen offset:3072 sc1
  s_branch L_x24
L_x23:
  s_mov_b64 exec, 0xff
  buffer_load_dwordx2 v[244:245], v249, s[68:71], s53 offen offset:0 sc1
  s_mov_b64 exec, -1
L_x24:
  s_waitcnt lgkmcnt(10)
  v_mfma_f32_16x16x32_bf16 v[164:167], v[192:195], v[32:35], v[164:167]
  ds_read_b64_tr_b16 v[216:217], v238 offset:8192
  ds_read_b64_tr_b16 v[218:219], v238 offset:12288
  s_waitcnt lgkmcnt(10)
  v_mfma_f32_16x16x32_bf16 v[172:175], v[196:199], v[32:35], v[172:175]
  ds_read_b64_tr_b16 v[220:221], v239 offset:8192
  ds_read_b64_tr_b16 v[222:223], v239 offset:12288
  s_waitcnt lgkmcnt(10)
  v_mfma_f32_16x16x32_bf16 v[180:183], v[200:203], v[32:35], v[180:183]
  ds_read_b64_tr_b16 v[192:193], v240 offset:0
  ds_read_b64_tr_b16 v[194:195], v240 offset:4096
  s_waitcnt lgkmcnt(10)
  v_mfma_f32_16x16x32_bf16 v[188:191], v[204:207], v[32:35], v[188:191]
  ds_read_b64_tr_b16 v[196:197], v241 offset:0
  ds_read_b64_tr_b16 v[198:199], v241 offset:4096
  s_waitcnt lgkmcnt(10)
  v_mfma_f32_16x16x32_bf16 v[164:167], v[208:211], v[40:43], v[164:167]
  ds_read_b64_tr_b16 v[200:201], v242 offset:0
  ds_read_b64_tr_b16 v[202:203], v242 offset:4096
  s_waitcnt lgkmcnt(10)
  v_mfma_f32_16x16x32_bf16 v[172:175], v[212:215], v[40:43], v[172:175]
  ds_read_b64_tr_b16 v[204:205], v243 offset:0
  ds_read_b64_tr_b16 v[206:207], v243 offset:4096
  s_waitcnt lgkmcnt(10)
  v_mfma_f32_16x16x32_bf16 v[180:183], v[216:219], v[40:43], v[180:183]
  ds_read_b64_tr_b16 v[208:209], v240 offset:8192
  ds_read_b64_tr_b16 v[210:211], v240 offset:12288
  s_waitcnt lgkmcnt(10)
  v_mfma_f32_16x16x32_bf16 v[188:191], v[220:223], v[40:43], v[188:191]
  ds_read_b64_tr_b16 v[212:213], v241 offset:8192
  ds_read_b64_tr_b16 v[214:215], v241 offset:12288
  s_waitcnt lgkmcnt(10)
  v_mfma_f32_16x16x32_bf16 v[164:167], v[192:195], v[48:51], v[164:167]
  ds_read_b64_tr_b16 v[216:217], v242 offset:8192
  ds_read_b64_tr_b16 v[218:219], v242 offset:12288
  s_waitcnt lgkmcnt(10)
  v_mfma_f32_16x16x32_bf16 v[172:175], v[196:199], v[48:51], v[172:175]
  ds_read_b64_tr_b16 v[220:221], v243 offset:8192
  ds_read_b64_tr_b16 v[222:223], v243 offset:12288
  s_waitcnt lgkmcnt(10)
  v_mfma_f32_16x16x32_bf16 v[180:183], v[200:203], v[48:51], v[180:183]
  s_waitcnt lgkmcnt(8)
  v_mfma_f32_16x16x32_bf16 v[188:191], v[204:207], v[48:51], v[188:191]
  s_waitcnt lgkmcnt(6)
  v_mfma_f32_16x16x32_bf16 v[164:167], v[208:211], v[56:59], v[164:167]
  s_waitcnt lgkmcnt(4)
  v_mfma_f32_16x16x32_bf16 v[172:175], v[212:215], v[56:59], v[172:175]
  s_waitcnt lgkmcnt(2)
  v_mfma_f32_16x16x32_bf16 v[180:183], v[216:219], v[56:59], v[180:183]
  s_waitcnt lgkmcnt(0)
  v_mfma_f32_16x16x32_bf16 v[188:191], v[220:223], v[56:59], v[188:191]
  s_cmp_lg_u32 s55, 0
  s_cbranch_scc1 L_x25
  s_waitcnt vmcnt(0)
  s_branch L_x26
L_x25:
  s_waitcnt vmcnt(4)
L_x26:
  s_add_u32 s98, s52, 4096
  s_mov_b64 exec, 1
  s_cmp_lg_u32 s67, 0
  s_cbranch_scc1 L_x27
  buffer_store_dwordx2 v[254:255], off, s[68:71], s98 offset:2048 sc1
  s_branch L_x28
L_x27:
  buffer_store_dwordx2 v[254:255], off, s[68:71], s98 offset:2048
L_x28:
  s_mov_b64 exec, -1
  s_barrier
  v_subrev_u32 v236, 65536, v236
  v_subrev_u32 v237, 65536, v237
  v_subrev_u32 v238, 65536, v238
  v_subrev_u32 v239, 65536, v239
  v_subrev_u32 v240, 65536, v240
  v_subrev_u32 v241, 65536, v241
  v_subrev_u32 v242, 65536, v242
  v_subrev_u32 v243, 65536, v243
  ds_read_b64_tr_b16 v[192:193], v236 offset:0
  ds_read_b64_tr_b16 v[194:195], v236 offset:4096
  ds_read_b64_tr_b16 v[196:197], v237 offset:0
  ds_read_b64_tr_b16 v[198:199], v237 offset:4096
  ds_read_b64_tr_b16 v[200:201], v238 offset:0
  ds_read_b64_tr_b16 v[202:203], v238 offset:4096
  ds_read_b64_tr_b16 v[204:205], v239 offset:0
  ds_read_b64_tr_b16 v[206:207], v239 offset:4096
  ds_read_b64_tr_b16 v[208:209], v236 offset:8192
  ds_read_b64_tr_b16 v[210:211], v236 offset:12288
  ds_read_b64_tr_b16 v[212:213], v237 offset:8192
  ds_read_b64_tr_b16 v[214:215], v237 offset:12288
  s_cmp_lg_u32 s55, 0
  s_cbranch_scc1 L_x29
  v_cmp_eq_u64 vcc, v[244:245], v[254:255]
  s_nop 4
  s_and_b32 s98, vcc_lo, 0xff
  s_cmp_eq_u32 s98, s59
  s_cbranch_scc0 L_x30
  s_mov_b32 s55, 1
  buffer_load_dwordx4 v[4:7], v248, s[80:83], s89 offen offset:0 sc1
  buffer_load_dwordx4 v[12:15], v248, s[80:83], s89 offen offset:1024 sc1
  buffer_load_dwordx4 v[20:23], v248, s[80:83], s89 offen offset:2048 sc1
  buffer_load_dwordx4 v[28:31], v248, s[80:83], s89 offen offset:3072 sc1
  buffer_load_dwordx4 v[36:39], v248, s[80:83], s90 offen offset:0 sc1
  buffer_load_dwordx4 v[44:47], v248, s[80:83], s90 offen offset:1024 sc1
  buffer_load_dwordx4 v[52:55], v248, s[80:83], s90 offen offset:2048 sc1
  buffer_load_dwordx4 v[60:63], v248, s[80:83], s90 offen offset:3072 sc1
  buffer_load_dwordx4 v[68:71], v248, s[80:83], s91 offen offset:0 sc1
  buffer_load_dwordx4 v[76:79], v248, s[80:83], s91 offen offset:1024 sc1
  buffer_load_dwordx4 v[84:87], v248, s[80:83], s91 offen offset:2048 sc1
  buffer_load_dwordx4 v[92:95], v248, s[80:83], s91 offen offset:3072 sc1
  buffer_load_dwordx4 v[100:103], v248, s[80:83], s92 offen offset:0 sc1
  buffer_load_dwordx4 v[108:111], v248, s[80:83], s92 offen offset:1024 sc1
  buffer_load_dwordx4 v[116:119], v248, s[80:83], s92 offen offset:2048 sc1
  buffer_load_dwordx4 v[124:127], v248, s[80:83], s92 offen offset:3072 sc1
  buffer_load_dwordx4 v[0:3], v248, s[80:83], s93 offen offset:0 sc1
  buffer_load_dwordx4 v[8:11], v248, s[80:83], s93 offen offset:1024 sc1
  buffer_load_dwordx4 v[16:19], v248, s[80:83], s93 offen offset:2048 sc1
  buffer_load_dwordx4 v[24:27], v248, s[80:83], s93 offen offset:3072 sc1
L_x29:
  buffer_load_dwordx4 v[32:35], v248, s[80:83], s94 offen offset:0 sc1
  buffer_load_dwordx4 v[40:43], v248, s[80:83], s94 offen offset:1024 sc1
  buffer_load_dwordx4 v[48:51], v248, s[80:83], s94 offen offset:2048 sc1
  buffer_load_dwordx4 v[56:59], v248, s[80:83], s94 offen offset:3072 sc1
  s_branch L_x31
L_x30:
  s_mov_b64 exec, 0xff
  buffer_load_dwordx2 v[244:245], v249, s[68:71], s53 offen offset:0 sc1
  s_mov_b64 exec, -1
L_x31:
  s_waitcnt lgkmcnt(10)
  v_mfma_f32_16x16x32_bf16 v[164:167], v[192:195], v[64:67], v[164:167]
  ds_read_b64_tr_b16 v[216:217], v238 offset:8192
  ds_read_b64_tr_b16 v[218:219], v238 offset:12288
  s_waitcnt lgkmcnt(10)
  v_mfma_f32_16x16x32_bf16 v[172:175], v[196:199], v[64:67], v[172:175]
  ds_read_b64_tr_b16 v[220:221], v239 offset:8192
  ds_read_b64_tr_b16 v[222:223], v239 offset:12288
  s_waitcnt lgkmcnt(10)
  v_mfma_f32_16x16x32_bf16 v[180:183], v[200:203], v[64:67], v[180:183]
  ds_read_b64_tr_b16 v[192:193], v240 offset:0
  ds_read_b64_tr_b16 v[194:195], v240 offset:4096
  s_waitcnt lgkmcnt(10)
  v_mfma_f32_16x16x32_bf16 v[188:191], v[204:207], v[64:67], v[188:191]
  ds_read_b64_tr_b16 v[196:197], v241 offset:0
  ds_read_b64_tr_b16 v[198:199], v241 offset:4096
  s_waitcnt lgkmcnt(10)
  v_mfma_f32_16x16x32_bf16 v[164:167], v[208:211], v[72:75], v[164:167]
  ds_read_b64_tr_b16 v[200:201], v242 offset:0
  ds_read_b64_tr_b16 v[202:203], v242 offset:4096
  s_waitcnt lgkmcnt(10)
  v_mfma_f32_16x16x32_bf16 v[172:175], v[212:215], v[72:75], v[172:175]
  ds_read_b64_tr_b16 v[204:205], v243 offset:0
  ds_read_b64_tr_b16 v[206:207], v243 offset:4096
  s_waitcnt lgkmcnt(10)
  v_mfma_f32_16x16x32_bf16 v[180:183], v[216:219], v[72:75], v[180:183]
  ds_read_b64_tr_b16 v[208:209], v240 offset:8192
  ds_read_b64_tr_b16 v[210:211], v240 offset:12288
  s_waitcnt lgkmcnt(10)
  v_mfma_f32_16x16x32_bf16 v[188:191], v[220:223], v[72:75], v[188:191]
  ds_read_b64_tr_b16 v[212:213], v241 offset:8192
  ds_read_b64_tr_b16 v[214:215], v241 offset:12288
  s_waitcnt lgkmcnt(10)
  v_mfma_f32_16x16x32_bf16 v[164:167], v[192:195], v[80:83], v[164:167]
  ds_read_b64_tr_b16 v[216:217], v242 offset:8192
  ds_read_b64_tr_b16 v[218:219], v242 offset:12288
  s_waitcnt lgkmcnt(10)
  v_mfma_f32_16x16x32_bf16 v[172:175], v[196:199], v[80:83], v[172:175]
  ds_read_b64_tr_b16 v[220:221], v243 offset:8192
  ds_read_b64_tr_b16 v[222:223], v243 offset:12288
  s_waitcnt lgkmcnt(10)
  v_mfma_f32_16x16x32_bf16 v[180:183], v[200:203], v[80:83], v[180:183]
  s_waitcnt lgkmcnt(8)
  v_mfma_f32_16x16x32_bf16 v[188:191], v[204:207], v[80:83], v[188:191]
  s_waitcnt lgkmcnt(6)
  v_mfma_f32_16x16x32_bf16 v[164:167], v[208:211], v[88:91], v[164:167]
  s_waitcnt lgkmcnt(4)
  v_mfma_f32_16x16x32_bf16 v[172:175], v[212:215], v[88:91], v[172:175]
  s_waitcnt lgkmcnt(2)
  v_mfma_f32_16x16x32_bf16 v[180:183], v[216:219], v[88:91], v[180:183]
  s_waitcnt lgkmcnt(0)
  v_mfma_f32_16x16x32_bf16 v[188:191], v[220:223], v[88:91], v[188:191]
  s_barrier
  ds_read_b64_tr_b16 v[192:193], v236 offset:16384
  ds_read_b64_tr_b16 v[194:195], v236 offset:20480
  ds_read_b64_tr_b16 v[196:197], v237 offset:16384
  ds_read_b64_tr_b16 v[198:199], v237 offset:20480
  ds_read_b64_tr_b16 v[200:201], v238 offset:16384
  ds_read_b64_tr_b16 v[202:203], v238 offset:20480
  ds_read_b64_tr_b16 v[204:205], v239 offset:16384
  ds_read_b64_tr_b16 v[206:207], v239 offset:20480
  ds_read_b64_tr_b16 v[208:209], v236 offset:24576
  ds_read_b64_tr_b16 v[210:211], v236 offset:28672
  ds_read_b64_tr_b16 v[212:213], v237 offset:24576
  ds_read_b64_tr_b16 v[214:215], v237 offset:28672
  s_cmp_lg_u32 s55, 0
  s_cbranch_scc1 L_x32
  v_cmp_eq_u64 vcc, v[244:245], v[254:255]
  s_nop 4
  s_and_b32 s98, vcc_lo, 0xff
  s_cmp_eq_u32 s98, s59
  s_cbranch_scc0 L_x33
  s_mov_b32 s55, 1
  buffer_load_dwordx4 v[4:7], v248, s[80:83], s89 offen offset:0 sc1
  buffer_load_dwordx4 v[12:15], v248, s[80:83], s89 offen offset:1024 sc1
  buffer_load_dwordx4 v[20:23], v248, s[80:83], s89 offen offset:2048 sc1
  buffer_load_dwordx4 v[28:31], v248, s[80:83], s89 offen offset:3072 sc1
  buffer_load_dwordx4 v[36:39], v248, s[80:83], s90 offen offset:0 sc1
  buffer_load_dwordx4 v[44:47], v248, s[80:83], s90 offen offset:1024 sc1
  buffer_load_dwordx4 v[52:55], v248, s[80:83], s90 offen offset:2048 sc1
  buffer_load_dwordx4 v[60:63], v248, s[80:83], s90 offen offset:3072 sc1
  buffer_load_dwordx4 v[68:71], v248, s[80:83], s91 offen offset:0 sc1
  buffer_load_dwordx4 v[76:79], v248, s[80:83], s91 offen offset:1024 sc1
  buffer_load_dwordx4 v[84:87], v248, s[80:83], s91 offen offset:2048 sc1
  buffer_load_dwordx4 v[92:95], v248, s[80:83], s91 offen offset:3072 sc1
  buffer_load_dwordx4 v[100:103], v248, s[80:83], s92 offen offset:0 sc1
  buffer_load_dwordx4 v[108:111], v248, s[80:83], s92 offen offset:1024 sc1
  buffer_load_dwordx4 v[116:119], v248, s[80:83], s92 offen offset:2048 sc1
  buffer_load_dwordx4 v[124:127], v248, s[80:83], s92 offen offset:3072 sc1
  buffer_load_dwordx4 v[0:3], v248, s[80:83], s93 offen offset:0 sc1
  buffer_load_dwordx4 v[8:11], v248, s[80:83], s93 offen offset:1024 sc1
  buffer_load_dwordx4 v[16:19], v248, s[80:83], s93 offen offset:2048 sc1
  buffer_load_dwordx4 v[24:27], v248, s[80:83], s93 offen offset:3072 sc1
  buffer_load_dwordx4 v[32:35], v248, s[80:83], s94 offen offset:0 sc1
  buffer_load_dwordx4 v[40:43], v248, s[80:83], s94 offen offset:1024 sc1
  buffer_load_dwordx4 v[48:51], v248, s[80:83], s94 offen offset:2048 sc1
  buffer_load_dwordx4 v[56:59], v248, s[80:83], s94 offen offset:3072 sc1
L_x32:
  buffer_load_dwordx4 v[64:67], v248, s[80:83], s95 offen offset:0 sc1
  buffer_load_dwordx4 v[72:75], v248, s[80:83], s95 offen offset:1024 sc1
  buffer_load_dwordx4 v[80:83], v248, s[80:83], s95 offen offset:2048 sc1
  buffer_load_dwordx4 v[88:91], v248, s[80:83], s95 offen offset:3072 sc1
  s_branch L_x34
L_x33:
  s_mov_b64 exec, 0xff
  buffer_load_dwordx2 v[244:245], v249, s[68:71], s53 offen offset:0 sc1
  s_mov_b64 exec, -1
L_x34:
  s_waitcnt lgkmcnt(10)
  v_mfma_f32_16x16x32_bf16 v[164:167], v[192:195], v[96:99], v[164:167]
  ds_read_b64_tr_b16 v[216:217], v238 offset:24576
  ds_read_b64_tr_b16 v[218:219], v238 offset:28672
  s_waitcnt lgkmcnt(10)
  v_mfma_f32_16x16x32_bf16 v[172:175], v[196:199], v[96:99], v[172:175]
  ds_read_b64_tr_b16 v[220:221], v239 offset:24576
  ds_read_b64_tr_b16 v[222:223], v239 offset:28672
  s_waitcnt lgkmcnt(10)
  v_mfma_f32_16x16x32_bf16 v[180:183], v[200:203], v[96:99], v[180:183]
  ds_read_b64_tr_b16 v[192:193], v240 offset:16384
  ds_read_b64_tr_b16 v[194:195], v240 offset:20480
  s_waitcnt lgkmcnt(10)
  v_mfma_f32_16x16x32_bf16 v[188:191], v[204:207], v[96:99], v[188:191]
  ds_read_b64_tr_b16 v[196:197], v241 offset:16384
  ds_read_b64_tr_b16 v[198:199], v241 offset:20480
  s_waitcnt lgkmcnt(10)
  v_mfma_f32_16x16x32_bf16 v[164:167], v[208:211], v[104:107], v[164:167]
  ds_read_b64_tr_b16 v[200:201], v242 offset:16384
  ds_read_b64_tr_b16 v[202:203], v242 offset:20480
  s_waitcnt lgkmcnt(10)
  v_mfma_f32_16x16x32_bf16 v[172:175], v[212:215], v[104:107], v[172:175]
  ds_read_b64_tr_b16 v[204:205], v243 offset:16384
  ds_read_b64_tr_b16 v[206:207], v243 offset:20480
  s_waitcnt lgkmcnt(10)
  v_mfma_f32_16x16x32_bf16 v[180:183], v[216:219], v[104:107], v[180:183]
  ds_read_b64_tr_b16 v[208:209], v240 offset:24576
  ds_read_b64_tr_b16 v[210:211], v240 offset:28672
  s_waitcnt lgkmcnt(10)
  v_mfma_f32_16x16x32_bf16 v[188:191], v[220:223], v[104:107], v[188:191]
  ds_read_b64_tr_b16 v[212:213], v241 offset:24576
  ds_read_b64_tr_b16 v[214:215], v241 offset:28672
  s_waitcnt lgkmcnt(10)
  v_mfma_f32_16x16x32_bf16 v[164:167], v[192:195], v[112:115], v[164:167]
  ds_read_b64_tr_b16 v[216:217], v242 offset:24576
  ds_read_b64_tr_b16 v[218:219], v242 offset:28672
  s_waitcnt lgkmcnt(10)
  v_mfma_f32_16x16x32_bf16 v[172:175], v[196:199], v[112:115], v[172:175]
  ds_read_b64_tr_b16 v[220:221], v243 offset:24576
  ds_read_b64_tr_b16 v[222:223], v243 offset:28672
  s_waitcnt lgkmcnt(10)
  v_mfma_f32_16x16x32_bf16 v[180:183], v[200:203], v[112:115], v[180:183]
  s_waitcnt lgkmcnt(8)
  v_mfma_f32_16x16x32_bf16 v[188:191], v[204:207], v[112:115], v[188:191]
  s_waitcnt lgkmcnt(6)
  v_mfma_f32_16x16x32_bf16 v[164:167], v[208:211], v[120:123], v[164:167]
  s_waitcnt lgkmcnt(4)
  v_mfma_f32_16x16x32_bf16 v[172:175], v[212:215], v[120:123], v[172:175]
  s_waitcnt lgkmcnt(2)
  v_mfma_f32_16x16x32_bf16 v[180:183], v[216:219], v[120:123], v[180:183]
  s_waitcnt lgkmcnt(0)
  v_mfma_f32_16x16x32_bf16 v[188:191], v[220:223], v[120:123], v[188:191]
  s_setprio 3
  v_rcp_f32 v251, v224
  s_nop 0
  v_mul_f32 v164, v164, v251
  v_mul_f32 v165, v165, v251
  v_mul_f32 v166, v166, v251
  v_mul_f32 v167, v167, v251
  v_mul_f32 v172, v172, v251
  v_mul_f32 v173, v173, v251
  v_mul_f32 v174, v174, v251
  v_mul_f32 v175, v175, v251
  v_cvt_pk_bf16_f32 v164, v164, v165
  v_cvt_pk_bf16_f32 v165, v166, v167
  v_cvt_pk_bf16_f32 v166, v172, v173
  v_cvt_pk_bf16_f32 v167, v174, v175
  v_cndmask_b32_e64 v176, v164, v166, s[42:43]
  v_cndmask_b32_e64 v177, v165, v167, s[42:43]
  v_cndmask_b32_e64 v178, v166, v164, s[42:43]
  v_cndmask_b32_e64 v179, v167, v165, s[42:43]
  s_cmp_lg_u32 s67, 0
  s_cbranch_scc1 L_x35
  buffer_store_dwordx4 v[176:179], v253, s[32:35], s41 offen offset:2048 sc1
  s_branch L_x36
L_x35:
  buffer_store_dwordx4 v[176:179], v253, s[32:35], s41 offen offset:2048
L_x36:
  v_mul_f32 v180, v180, v251
  v_mul_f32 v181, v181, v251
  v_mul_f32 v182, v182, v251
  v_mul_f32 v183, v183, v251
  v_mul_f32 v188, v188, v251
  v_mul_f32 v189, v189, v251
  v_mul_f32 v190, v190, v251
  v_mul_f32 v191, v191, v251
  v_cvt_pk_bf16_f32 v180, v180, v181
  v_cvt_pk_bf16_f32 v181, v182, v183
  v_cvt_pk_bf16_f32 v182, v188, v189
  v_cvt_pk_bf16_f32 v183, v190, v191
  v_cndmask_b32_e64 v184, v180, v182, s[42:43]
  v_cndmask_b32_e64 v185, v181, v183, s[42:43]
  v_cndmask_b32_e64 v186, v182, v180, s[42:43]
  v_cndmask_b32_e64 v187, v183, v181, s[42:43]
  s_cmp_lg_u32 s67, 0
  s_cbranch_scc1 L_x37
  buffer_store_dwordx4 v[184:187], v253, s[32:35], s41 offen offset:3072 sc1
  s_branch L_x38
L_x37:
  buffer_store_dwordx4 v[184:187], v253, s[32:35], s41 offen offset:3072
L_x38:
  v_and_b32 v250, 0x300, v248
  v_lshlrev_b32 v250, 2, v250
  v_add_u32 v236, v250, v236
  v_add_u32 v237, v250, v237
  v_add_u32 v238, v250, v238
  v_add_u32 v239, v250, v239
  v_add_u32 v240, v250, v240
  v_add_u32 v241, v250, v241
  v_add_u32 v242, v250, v242
  v_add_u32 v243, v250, v243
  v_mov_b32 v232, 65536
  s_lshl_b32 s98, s36, 4
  s_add_u32 s98, s98, 65600
  v_mov_b32 v233, s98
  s_cmp_eq_u32 s11, 1
  s_cselect_b32 s5, 128, 0
  s_cselect_b32 s98, 3670016, 0
  s_add_u32 s16, s6, s98
  s_add_u32 s17, s7, s98
  s_add_u32 s18, s8, s98
  s_min_u32 s4, s9, s11
  s_mov_b32 s19, 64
  s_mov_b32 s50, -1
  ds_read_b64_tr_b16 v[192:193], v236 offset:32768
  ds_read_b64_tr_b16 v[194:195], v236 offset:33792
  ds_read_b64_tr_b16 v[196:197], v237 offset:32768
  ds_read_b64_tr_b16 v[198:199], v237 offset:33792
  ds_read_b64_tr_b16 v[200:201], v238 offset:32768
  ds_read_b64_tr_b16 v[202:203], v238 offset:33792
  ds_read_b64_tr_b16 v[204:205], v239 offset:32768
  ds_read_b64_tr_b16 v[206:207], v239 offset:33792
  ds_read_b64_tr_b16 v[208:209], v236 offset:40960
  ds_read_b64_tr_b16 v[210:211], v236 offset:41984
  ds_read_b64_tr_b16 v[212:213], v237 offset:40960
  ds_read_b64_tr_b16 v[214:215], v237 offset:41984
  s_cmp_lg_u32 s55, 0
  s_cbranch_scc1 L_x39
  s_mov_b32 s54, 48
L_x40:
  s_waitcnt vmcnt(0)
  v_cmp_eq_u64 vcc, v[244:245], v[254:255]
  s_nop 4
  s_and_b32 s98, vcc_lo, 0xff
  s_cmp_eq_u32 s98, s59
  s_cbranch_scc1 L_x41
  s_sub_u32 s54, s54, 1
  s_cbranch_scc1 L_x42
  s_sleep 2
  s_mov_b64 exec, 0xff
  buffer_load_dwordx2 v[244:245], v249, s[68:71], s53 offen offset:0 sc1
  s_mov_b64 exec, -1
  s_branch L_x40
L_x42:
  s_mov_b32 s57, 1
  s_mov_b32 s86, 0
  s_branch L_x43
L_x41:
  buffer_load_dwordx4 v[4:7], v248, s[80:83], s89 offen offset:0 sc1
  buffer_load_dwordx4 v[12:15], v248, s[80:83], s89 offen offset:1024 sc1
  buffer_load_dwordx4 v[20:23], v248, s[80:83], s89 offen offset:2048 sc1
  buffer_load_dwordx4 v[28:31], v248, s[80:83], s89 offen offset:3072 sc1
  buffer_load_dwordx4 v[36:39], v248, s[80:83], s90 offen offset:0 sc1
  buffer_load_dwordx4 v[44:47], v248, s[80:83], s90 offen offset:1024 sc1
  buffer_load_dwordx4 v[52:55], v248, s[80:83], s90 offen offset:2048 sc1
  buffer_load_dwordx4 v[60:63], v248, s[80:83], s90 offen offset:3072 sc1
  buffer_load_dwordx4 v[68:71], v248, s[80:83], s91 offen offset:0 sc1
  buffer_load_dwordx4 v[76:79], v248, s[80:83], s91 offen offset:1024 sc1
  buffer_load_dwordx4 v[84:87], v248, s[80:83], s91 offen offset:2048 sc1
  buffer_load_dwordx4 v[92:95], v248, s[80:83], s91 offen offset:3072 sc1
  buffer_load_dwordx4 v[100:103], v248, s[80:83], s92 offen offset:0 sc1
  buffer_load_dwordx4 v[108:111], v248, s[80:83], s92 offen offset:1024 sc1
  buffer_load_dwordx4 v[116:119], v248, s[80:83], s92 offen offset:2048 sc1
  buffer_load_dwordx4 v[124:127], v248, s[80:83], s92 offen offset:3072 sc1
  buffer_load_dwordx4 v[0:3], v248, s[80:83], s93 offen offset:0 sc1
  buffer_load_dwordx4 v[8:11], v248, s[80:83], s93 offen offset:1024 sc1
  buffer_load_dwordx4 v[16:19], v248, s[80:83], s93 offen offset:2048 sc1
  buffer_load_dwordx4 v[24:27], v248, s[80:83], s93 offen offset:3072 sc1
  buffer_load_dwordx4 v[32:35], v248, s[80:83], s94 offen offset:0 sc1
  buffer_load_dwordx4 v[40:43], v248, s[80:83], s94 offen offset:1024 sc1
  buffer_load_dwordx4 v[48:51], v248, s[80:83], s94 offen offset:2048 sc1
  buffer_load_dwordx4 v[56:59], v248, s[80:83], s94 offen offset:3072 sc1
  buffer_load_dwordx4 v[64:67], v248, s[80:83], s95 offen offset:0 sc1
  buffer_load_dwordx4 v[72:75], v248, s[80:83], s95 offen offset:1024 sc1
  buffer_load_dwordx4 v[80:83], v248, s[80:83], s95 offen offset:2048 sc1
  buffer_load_dwordx4 v[88:91], v248, s[80:83], s95 offen offset:3072 sc1
L_x39:
L_x43:
  s_waitcnt lgkmcnt(10)
  v_mfma_f32_16x16x32_bf16 v[132:135], v[192:195], v[128:131], 0
  v_mfma_f32_16x16x32_bf16 v[164:167], v[192:195], v[160:163], 0
  ds_read_b64_tr_b16 v[216:217], v238 offset:40960
  ds_read_b64_tr_b16 v[218:219], v238 offset:41984
  s_waitcnt lgkmcnt(10)
  v_mfma_f32_16x16x32_bf16 v[140:143], v[196:199], v[128:131], 0
  v_mfma_f32_16x16x32_bf16 v[172:175], v[196:199], v[160:163], 0
  ds_read_b64_tr_b16 v[220:221], v239 offset:40960
  ds_read_b64_tr_b16 v[222:223], v239 offset:41984
  s_waitcnt lgkmcnt(10)
  v_mfma_f32_16x16x32_bf16 v[148:151], v[200:203], v[128:131], 0
  v_mfma_f32_16x16x32_bf16 v[180:183], v[200:203], v[160:163], 0
  ds_read_b64_tr_b16 v[192:193], v240 offset:32768
  ds_read_b64_tr_b16 v[194:195], v240 offset:33792
  s_waitcnt lgkmcnt(10)
  v_mfma_f32_16x16x32_bf16 v[156:159], v[204:207], v[128:131], 0
  v_mfma_f32_16x16x32_bf16 v[188:191], v[204:207], v[160:163], 0
  ds_read_b64_tr_b16 v[196:197], v241 offset:32768
  ds_read_b64_tr_b16 v[198:199], v241 offset:33792
  s_waitcnt lgkmcnt(10)
  v_mfma_f32_16x16x32_bf16 v[132:135], v[208:211], v[136:139], v[132:135]
  v_mfma_f32_16x16x32_bf16 v[164:167], v[208:211], v[168:171], v[164:167]
  ds_read_b64_tr_b16 v[200:201], v242 offset:32768
  ds_read_b64_tr_b16 v[202:203], v242 offset:33792
  s_waitcnt lgkmcnt(10)
  v_mfma_f32_16x16x32_bf16 v[140:143], v[212:215], v[136:139], v[140:143]
  v_mfma_f32_16x16x32_bf16 v[172:175], v[212:215], v[168:171], v[172:175]
  ds_read_b64_tr_b16 v[204:205], v243 offset:32768
  ds_read_b64_tr_b16 v[206:207], v243 offset:33792
  s_waitcnt lgkmcnt(10)
  v_mfma_f32_16x16x32_bf16 v[148:151], v[216:219], v[136:139], v[148:151]
  v_mfma_f32_16x16x32_bf16 v[180:183], v[216:219], v[168:171], v[180:183]
  ds_read_b64_tr_b16 v[208:209], v240 offset:40960
  ds_read_b64_tr_b16 v[210:211], v240 offset:41984
  s_waitcnt lgkmcnt(10)
  v_mfma_f32_16x16x32_bf16 v[156:159], v[220:223], v[136:139], v[156:159]
  v_mfma_f32_16x16x32_bf16 v[188:191], v[220:223], v[168:171], v[188:191]
  ds_read_b64_tr_b16 v[212:213], v241 offset:40960
  ds_read_b64_tr_b16 v[214:215], v241 offset:41984
  s_waitcnt lgkmcnt(10)
  v_mfma_f32_16x16x32_bf16 v[132:135], v[192:195], v[144:147], v[132:135]
  v_mfma_f32_16x16x32_bf16 v[164:167], v[192:195], v[176:179], v[164:167]
  ds_read_b64_tr_b16 v[216:217], v242 offset:40960
  ds_read_b64_tr_b16 v[218:219], v242 offset:41984
  s_waitcnt lgkmcnt(10)
  v_mfma_f32_16x16x32_bf16 v[140:143], v[196:199], v[144:147], v[140:143]
  v_mfma_f32_16x16x32_bf16 v[172:175], v[196:199], v[176:179], v[172:175]
  ds_read_b64_tr_b16 v[220:221], v243 offset:40960
  ds_read_b64_tr_b16 v[222:223], v243 offset:41984
  s_waitcnt lgkmcnt(10)
  v_mfma_f32_16x16x32_bf16 v[148:151], v[200:203], v[144:147], v[148:151]
  v_mfma_f32_16x16x32_bf16 v[180:183], v[200:203], v[176:179], v[180:183]
  v_subrev_u32 v236, 65536, v236
  v_subrev_u32 v237, 65536, v237
  v_subrev_u32 v238, 65536, v238
  v_subrev_u32 v239, 65536, v239
  v_subrev_u32 v240, 65536, v240
  v_subrev_u32 v241, 65536, v241
  v_subrev_u32 v242, 65536, v242
  v_subrev_u32 v243, 65536, v243
  ds_read_b64_tr_b16 v[192:193], v236 offset:0
  ds_read_b64_tr_b16 v[194:195], v236 offset:1024
  s_waitcnt lgkmcnt(10)
  v_mfma_f32_16x16x32_bf16 v[156:159], v[204:207], v[144:147], v[156:159]
  v_mfma_f32_16x16x32_bf16 v[188:191], v[204:207], v[176:179], v[188:191]
  ds_read_b128 v[244:247], v233
  ds_read_b64_tr_b16 v[196:197], v237 offset:0
  ds_read_b64_tr_b16 v[198:199], v237 offset:1024
  s_waitcnt lgkmcnt(11)
  v_mfma_f32_16x16x32_bf16 v[132:135], v[208:211], v[152:155], v[132:135]
  v_mfma_f32_16x16x32_bf16 v[164:167], v[208:211], v[184:187], v[164:167]
  ds_read_b64_tr_b16 v[200:201], v238 offset:0
  ds_read_b64_tr_b16 v[202:203], v238 offset:1024
  s_waitcnt lgkmcnt(11)
  v_mfma_f32_16x16x32_bf16 v[140:143], v[212:215], v[152:155], v[140:143]
  v_mfma_f32_16x16x32_bf16 v[172:175], v[212:215], v[184:187], v[172:175]
  ds_read_b64_tr_b16 v[204:205], v239 offset:0
  ds_read_b64_tr_b16 v[206:207], v239 offset:1024
  s_waitcnt lgkmcnt(11)
  v_mfma_f32_16x16x32_bf16 v[148:151], v[216:219], v[152:155], v[148:151]
  v_mfma_f32_16x16x32_bf16 v[180:183], v[216:219], v[184:187], v[180:183]
  ds_read_b64_tr_b16 v[208:209], v236 offset:8192
  ds_read_b64_tr_b16 v[210:211], v236 offset:9216
  s_waitcnt lgkmcnt(11)
  v_mfma_f32_16x16x32_bf16 v[156:159], v[220:223], v[152:155], v[156:159]
  v_mfma_f32_16x16x32_bf16 v[188:191], v[220:223], v[184:187], v[188:191]
  ds_read_b64_tr_b16 v[212:213], v237 offset:8192
  ds_read_b64_tr_b16 v[214:215], v237 offset:9216
  s_waitcnt vmcnt(0)
  s_mov_b64 exec, 1
  s_cmp_lg_u32 s67, 0
  s_cbranch_scc1 L_x44
  buffer_store_dwordx2 v[254:255], off, s[68:71], s52 offset:2048 sc1
  s_branch L_x45
L_x44:
  buffer_store_dwordx2 v[254:255], off, s[68:71], s52 offset:2048
L_x45:
  s_mov_b64 exec, -1
  s_setprio 0
  s_waitcnt lgkmcnt(10)
  v_cmp_eq_u64 vcc, v[244:245], v[254:255]
  s_cmp_lg_u32 s37, 0
  s_cbranch_scc1 L_x46
  s_cmp_eq_u32 vcc_lo, s50
  s_cbranch_scc0 L_x47
  s_mov_b32 s37, 1
L_x46:
  s_add_u32 s38, s89, 3670016
  buffer_load_dwordx4 v[96:99], v248, s[80:83], s38 offen offset:0 sc1
  buffer_load_dwordx4 v[104:107], v248, s[80:83], s38 offen offset:1024 sc1
  s_add_u32 s38, s90, 3670016
  buffer_load_dwordx4 v[112:115], v248, s[80:83], s38 offen offset:0 sc1
  buffer_load_dwordx4 v[120:123], v248, s[80:83], s38 offen offset:1024 sc1
L_x47:
  v_mfma_f32_16x16x32_bf16 v[132:135], v[192:195], v[4:7], v[132:135]
  ds_read_b64_tr_b16 v[216:217], v238 offset:8192
  ds_read_b64_tr_b16 v[218:219], v238 offset:9216
  s_waitcnt lgkmcnt(10)
  v_mfma_f32_16x16x32_bf16 v[140:143], v[196:199], v[4:7], v[140:143]
  ds_read_b64_tr_b16 v[220:221], v239 offset:8192
  ds_read_b64_tr_b16 v[222:223], v239 offset:9216
  s_waitcnt lgkmcnt(10)
  v_mfma_f32_16x16x32_bf16 v[148:151], v[200:203], v[4:7], v[148:151]
  ds_read_b64_tr_b16 v[192:193], v240 offset:0
  ds_read_b64_tr_b16 v[194:195], v240 offset:1024
  s_waitcnt lgkmcnt(10)
  v_mfma_f32_16x16x32_bf16 v[156:159], v[204:207], v[4:7], v[156:159]
  ds_read_b64_tr_b16 v[196:197], v241 offset:0
  ds_read_b64_tr_b16 v[198:199], v241 offset:1024
  s_waitcnt lgkmcnt(10)
  v_mfma_f32_16x16x32_bf16 v[132:135], v[208:211], v[12:15], v[132:135]
  ds_read_b64_tr_b16 v[200:201], v242 offset:0
  ds_read_b64_tr_b16 v[202:203], v242 offset:1024
  s_waitcnt lgkmcnt(10)
  v_mfma_f32_16x16x32_bf16 v[140:143], v[212:215], v[12:15], v[140:143]
  ds_read_b64_tr_b16 v[204:205], v243 offset:0
  ds_read_b64_tr_b16 v[206:207], v243 offset:1024
  s_waitcnt lgkmcnt(10)
  v_mfma_f32_16x16x32_bf16 v[148:151], v[216:219], v[12:15], v[148:151]
  ds_read_b64_tr_b16 v[208:209], v240 offset:8192
  ds_read_b64_tr_b16 v[210:211], v240 offset:9216
  s_waitcnt lgkmcnt(10)
  v_mfma_f32_16x16x32_bf16 v[156:159], v[220:223], v[12:15], v[156:159]
  ds_read_b64_tr_b16 v[212:213], v241 offset:8192
  ds_read_b64_tr_b16 v[214:215], v241 offset:9216
  s_waitcnt lgkmcnt(10)
  v_mfma_f32_16x16x32_bf16 v[132:135], v[192:195], v[20:23], v[132:135]
  ds_read_b64_tr_b16 v[216:217], v242 offset:8192
  ds_read_b64_tr_b16 v[218:219], v242 offset:9216
  s_waitcnt lgkmcnt(10)
  v_mfma_f32_16x16x32_bf16 v[140:143], v[196:199], v[20:23], v[140:143]
  ds_read_b64_tr_b16 v[220:221], v243 offset:8192
  ds_read_b64_tr_b16 v[222:223], v243 offset:9216
  s_waitcnt lgkmcnt(10)
  v_mfma_f32_16x16x32_bf16 v[148:151], v[200:203], v[20:23], v[148:151]
  ds_read_b64_tr_b16 v[192:193], v236 offset:16384
  ds_read_b64_tr_b16 v[194:195], v236 offset:17408
  s_waitcnt lgkmcnt(10)
  v_mfma_f32_16x16x32_bf16 v[156:159], v[204:207], v[20:23], v[156:159]
  ds_read_b128 v[244:247], v233
  ds_read_b64_tr_b16 v[196:197], v237 offset:16384
  ds_read_b64_tr_b16 v[198:199], v237 offset:17408
  s_waitcnt lgkmcnt(11)
  v_mfma_f32_16x16x32_bf16 v[132:135], v[208:211], v[28:31], v[132:135]
  ds_read_b64_tr_b16 v[200:201], v238 offset:16384
  ds_read_b64_tr_b16 v[202:203], v238 offset:17408
  s_waitcnt lgkmcnt(11)
  v_mfma_f32_16x16x32_bf16 v[140:143], v[212:215], v[28:31], v[140:143]
  ds_read_b64_tr_b16 v[204:205], v239 offset:16384
  ds_read_b64_tr_b16 v[206:207], v239 offset:17408
  s_waitcnt lgkmcnt(11)
  v_mfma_f32_16x16x32_bf16 v[148:151], v[216:219], v[28:31], v[148:151]
  ds_read_b64_tr_b16 v[208:209], v236 offset:24576
  ds_read_b64_tr_b16 v[210:211], v236 offset:25600
  s_waitcnt lgkmcnt(11)
  v_mfma_f32_16x16x32_bf16 v[156:159], v[220:223], v[28:31], v[156:159]
  ds_read_b64_tr_b16 v[212:213], v237 offset:24576
  ds_read_b64_tr_b16 v[214:215], v237 offset:25600
  s_waitcnt lgkmcnt(10)
  v_cmp_eq_u64 vcc, v[244:245], v[254:255]
  s_cmp_lg_u32 s37, 0
  s_cbranch_scc1 L_x48
  s_cmp_eq_u32 vcc_lo, s50
  s_cbranch_scc0 L_x49
  s_mov_b32 s37, 1
  s_add_u32 s38, s89, 3670016
  buffer_load_dwordx4 v[96:99], v248, s[80:83], s38 offen offset:0 sc1
  buffer_load_dwordx4 v[104:107], v248, s[80:83], s38 offen offset:1024 sc1
  s_add_u32 s38, s90, 3670016
  buffer_load_dwordx4 v[112:115], v248, s[80:83], s38 offen offset:0 sc1
  buffer_load_dwordx4 v[120:123], v248, s[80:83], s38 offen offset:1024 sc1
L_x48:
  s_add_u32 s38, s91, 3670016
  buffer_load_dwordx4 v[4:7], v248, s[80:83], s38 offen offset:0 sc1
  buffer_load_dwordx4 v[12:15], v248, s[80:83], s38 offen offset:1024 sc1
  s_add_u32 s38, s92, 3670016
  buffer_load_dwordx4 v[20:23], v248, s[80:83], s38 offen offset:0 sc1
  buffer_load_dwordx4 v[28:31], v248, s[80:83], s38 offen offset:1024 sc1
L_x49:
  v_mfma_f32_16x16x32_bf16 v[132:135], v[192:195], v[36:39], v[132:135]
  ds_read_b64_tr_b16 v[216:217], v238 offset:24576
  ds_read_b64_tr_b16 v[218:219], v238 offset:25600
  s_waitcnt lgkmcnt(10)
  v_mfma_f32_16x16x32_bf16 v[140:143], v[196:199], v[36:39], v[140:143]
  ds_read_b64_tr_b16 v[220:221], v239 offset:24576
  ds_read_b64_tr_b16 v[222:223], v239 offset:25600
  s_waitcnt lgkmcnt(10)
  v_mfma_f32_16x16x32_bf16 v[148:151], v[200:203], v[36:39], v[148:151]
  ds_read_b64_tr_b16 v[192:193], v240 offset:16384
  ds_read_b64_tr_b16 v[194:195], v240 offset:17408
  s_waitcnt lgkmcnt(10)
  v_mfma_f32_16x16x32_bf16 v[156:159], v[204:207], v[36:39], v[156:159]
  ds_read_b64_tr_b16 v[196:197], v241 offset:16384
  ds_read_b64_tr_b16 v[198:199], v241 offset:17408
  s_waitcnt lgkmcnt(10)
  v_mfma_f32_16x16x32_bf16 v[132:135], v[208:211], v[44:47], v[132:135]
  ds_read_b64_tr_b16 v[200:201], v242 offset:16384
  ds_read_b64_tr_b16 v[202:203], v242 offset:17408
  s_waitcnt lgkmcnt(10)
  v_mfma_f32_16x16x32_bf16 v[140:143], v[212:215], v[44:47], v[140:143]
  ds_read_b64_tr_b16 v[204:205], v243 offset:16384
  ds_read_b64_tr_b16 v[206:207], v243 offset:17408
  s_waitcnt lgkmcnt(10)
  v_mfma_f32_16x16x32_bf16 v[148:151], v[216:219], v[44:47], v[148:151]
  ds_read_b64_tr_b16 v[208:209], v240 offset:24576
  ds_read_b64_tr_b16 v[210:211], v240 offset:25600
  s_waitcnt lgkmcnt(10)
  v_mfma_f32_16x16x32_bf16 v[156:159], v[220:223], v[44:47], v[156:159]
  ds_read_b64_tr_b16 v[212:213], v241 offset:24576
  ds_read_b64_tr_b16 v[214:215], v241 offset:25600
  s_waitcnt lgkmcnt(10)
  v_mfma_f32_16x16x32_bf16 v[132:135], v[192:195], v[52:55], v[132:135]
  ds_read_b64_tr_b16 v[216:217], v242 offset:24576
  ds_read_b64_tr_b16 v[218:219], v242 offset:25600
  s_waitcnt lgkmcnt(10)
  v_mfma_f32_16x16x32_bf16 v[140:143], v[196:199], v[52:55], v[140:143]
  ds_read_b64_tr_b16 v[220:221], v243 offset:24576
  ds_read_b64_tr_b16 v[222:223], v243 offset:25600
  s_waitcnt lgkmcnt(10)
  v_mfma_f32_16x16x32_bf16 v[148:151], v[200:203], v[52:55], v[148:151]
  ds_read_b64_tr_b16 v[192:193], v236 offset:32768
  ds_read_b64_tr_b16 v[194:195], v236 offset:33792
  s_waitcnt lgkmcnt(10)
  v_mfma_f32_16x16x32_bf16 v[156:159], v[204:207], v[52:55], v[156:159]
  ds_read_b128 v[244:247], v233
  ds_read_b64_tr_b16 v[196:197], v237 offset:32768
  ds_read_b64_tr_b16 v[198:199], v237 offset:33792
  s_waitcnt lgkmcnt(11)
  v_mfma_f32_16x16x32_bf16 v[132:135], v[208:211], v[60:63], v[132:135]
  ds_read_b64_tr_b16 v[200:201], v238 offset:32768
  ds_read_b64_tr_b16 v[202:203], v238 offset:33792
  s_waitcnt lgkmcnt(11)
  v_mfma_f32_16x16x32_bf16 v[140:143], v[212:215], v[60:63], v[140:143]
  ds_read_b64_tr_b16 v[204:205], v239 offset:32768
  ds_read_b64_tr_b16 v[206:207], v239 offset:33792
  s_waitcnt lgkmcnt(11)
  v_mfma_f32_16x16x32_bf16 v[148:151], v[216:219], v[60:63], v[148:151]
  ds_read_b64_tr_b16 v[208:209], v236 offset:40960
  ds_read_b64_tr_b16 v[210:211], v236 offset:41984
  s_waitcnt lgkmcnt(11)
  v_mfma_f32_16x16x32_bf16 v[156:159], v[220:223], v[60:63], v[156:159]
  ds_read_b64_tr_b16 v[212:213], v237 offset:40960
  ds_read_b64_tr_b16 v[214:215], v237 offset:41984
  s_waitcnt lgkmcnt(10)
  v_cmp_eq_u64 vcc, v[244:245], v[254:255]
  s_cmp_lg_u32 s37, 0
  s_cbranch_scc1 L_x50
  s_cmp_eq_u32 vcc_lo, s50
  s_cbranch_scc0 L_x51
  s_mov_b32 s37, 1
  s_add_u32 s38, s89, 3670016
  buffer_load_dwordx4 v[96:99], v248, s[80:83], s38 offen offset:0 sc1
  buffer_load_dwordx4 v[104:107], v248, s[80:83], s38 offen offset:1024 sc1
  s_add_u32 s38, s90, 3670016
  buffer_load_dwordx4 v[112:115], v248, s[80:83], s38 offen offset:0 sc1
  buffer_load_dwordx4 v[120:123], v248, s[80:83], s38 offen offset:1024 sc1
  s_add_u32 s38, s91, 3670016
  buffer_load_dwordx4 v[4:7], v248, s[80:83], s38 offen offset:0 sc1
  buffer_load_dwordx4 v[12:15], v248, s[80:83], s38 offen offset:1024 sc1
  s_add_u32 s38, s92, 3670016
  buffer_load_dwordx4 v[20:23], v248, s[80:83], s38 offen offset:0 sc1
  buffer_load_dwordx4 v[28:31], v248, s[80:83], s38 offen offset:1024 sc1
L_x50:
  s_add_u32 s38, s93, 3670016
  buffer_load_dwordx4 v[36:39], v248, s[80:83], s38 offen offset:0 sc1
  buffer_load_dwordx4 v[44:47], v248, s[80:83], s38 offen offset:1024 sc1
  s_add_u32 s38, s94, 3670016
  buffer_load_dwordx4 v[52:55], v248, s[80:83], s38 offen offset:0 sc1
  buffer_load_dwordx4 v[60:63], v248, s[80:83], s38 offen offset:1024 sc1
L_x51:
  v_mfma_f32_16x16x32_bf16 v[132:135], v[192:195], v[68:71], v[132:135]
  ds_read_b64_tr_b16 v[216:217], v238 offset:40960
  ds_read_b64_tr_b16 v[218:219], v238 offset:41984
  s_waitcnt lgkmcnt(10)
  v_mfma_f32_16x16x32_bf16 v[140:143], v[196:199], v[68:71], v[140:143]
  ds_read_b64_tr_b16 v[220:221], v239 offset:40960
  ds_read_b64_tr_b16 v[222:223], v239 offset:41984
  s_waitcnt lgkmcnt(10)
  v_mfma_f32_16x16x32_bf16 v[148:151], v[200:203], v[68:71], v[148:151]
  ds_read_b64_tr_b16 v[192:193], v240 offset:32768
  ds_read_b64_tr_b16 v[194:195], v240 offset:33792
  s_waitcnt lgkmcnt(10)
  v_mfma_f32_16x16x32_bf16 v[156:159], v[204:207], v[68:71], v[156:159]
  ds_read_b64_tr_b16 v[196:197], v241 offset:32768
  ds_read_b64_tr_b16 v[198:199], v241 offset:33792
  s_waitcnt lgkmcnt(10)
  v_mfma_f32_16x16x32_bf16 v[132:135], v[208:211], v[76:79], v[132:135]
  ds_read_b64_tr_b16 v[200:201], v242 offset:32768
  ds_read_b64_tr_b16 v[202:203], v242 offset:33792
  s_waitcnt lgkmcnt(10)
  v_mfma_f32_16x16x32_bf16 v[140:143], v[212:215], v[76:79], v[140:143]
  ds_read_b64_tr_b16 v[204:205], v243 offset:32768
  ds_read_b64_tr_b16 v[206:207], v243 offset:33792
  s_waitcnt lgkmcnt(10)
  v_mfma_f32_16x16x32_bf16 v[148:151], v[216:219], v[76:79], v[148:151]
  ds_read_b64_tr_b16 v[208:209], v240 offset:40960
  ds_read_b64_tr_b16 v[210:211], v240 offset:41984
  s_waitcnt lgkmcnt(10)
  v_mfma_f32_16x16x32_bf16 v[156:159], v[220:223], v[76:79], v[156:159]
  ds_read_b64_tr_b16 v[212:213], v241 offset:40960
  ds_read_b64_tr_b16 v[214:215], v241 offset:41984
  s_waitcnt lgkmcnt(10)
  v_mfma_f32_16x16x32_bf16 v[132:135], v[192:195], v[84:87], v[132:135]
  ds_read_b64_tr_b16 v[216:217], v242 offset:40960
  ds_read_b64_tr_b16 v[218:219], v242 offset:41984
  s_waitcnt lgkmcnt(10)
  v_mfma_f32_16x16x32_bf16 v[140:143], v[196:199], v[84:87], v[140:143]
  ds_read_b64_tr_b16 v[220:221], v243 offset:40960
  ds_read_b64_tr_b16 v[222:223], v243 offset:41984
  s_waitcnt lgkmcnt(10)
  v_mfma_f32_16x16x32_bf16 v[148:151], v[200:203], v[84:87], v[148:151]
  ds_read_b64_tr_b16 v[192:193], v236 offset:49152
  ds_read_b64_tr_b16 v[194:195], v236 offset:50176
  s_waitcnt lgkmcnt(10)
  v_mfma_f32_16x16x32_bf16 v[156:159], v[204:207], v[84:87], v[156:159]
  ds_read_b128 v[244:247], v233
  ds_read_b64_tr_b16 v[196:197], v237 offset:49152
  ds_read_b64_tr_b16 v[198:199], v237 offset:50176
  s_waitcnt lgkmcnt(11)
  v_mfma_f32_16x16x32_bf16 v[132:135], v[208:211], v[92:95], v[132:135]
  ds_read_b64_tr_b16 v[200:201], v238 offset:49152
  ds_read_b64_tr_b16 v[202:203], v238 offset:50176
  s_waitcnt lgkmcnt(11)
  v_mfma_f32_16x16x32_bf16 v[140:143], v[212:215], v[92:95], v[140:143]
  ds_read_b64_tr_b16 v[204:205], v239 offset:49152
  ds_read_b64_tr_b16 v[206:207], v239 offset:50176
  s_waitcnt lgkmcnt(11)
  v_mfma_f32_16x16x32_bf16 v[148:151], v[216:219], v[92:95], v[148:151]
  ds_read_b64_tr_b16 v[208:209], v236 offset:57344
  ds_read_b64_tr_b16 v[210:211], v236 offset:58368
  s_waitcnt lgkmcnt(11)
  v_mfma_f32_16x16x32_bf16 v[156:159], v[220:223], v[92:95], v[156:159]
  ds_read_b64_tr_b16 v[212:213], v237 offset:57344
  ds_read_b64_tr_b16 v[214:215], v237 offset:58368
  s_waitcnt lgkmcnt(10)
  v_cmp_eq_u64 vcc, v[244:245], v[254:255]
  s_cmp_lg_u32 s37, 0
  s_cbranch_scc1 L_x52
  s_cmp_eq_u32 vcc_lo, s50
  s_cbranch_scc0 L_x53
  s_mov_b32 s37, 1
  s_add_u32 s38, s89, 3670016
  buffer_load_dwordx4 v[96:99], v248, s[80:83], s38 offen offset:0 sc1
  buffer_load_dwordx4 v[104:107], v248, s[80:83], s38 offen offset:1024 sc1
  s_add_u32 s38, s90, 3670016
  buffer_load_dwordx4 v[112:115], v248, s[80:83], s38 offen offset:0 sc1
  buffer_load_dwordx4 v[120:123], v248, s[80:83], s38 offen offset:1024 sc1
  s_add_u32 s38, s91, 3670016
  buffer_load_dwordx4 v[4:7], v248, s[80:83], s38 offen offset:0 sc1
  buffer_load_dwordx4 v[12:15], v248, s[80:83], s38 offen offset:1024 sc1
  s_add_u32 s38, s92, 3670016
  buffer_load_dwordx4 v[20:23], v248, s[80:83], s38 offen offset:0 sc1
  buffer_load_dwordx4 v[28:31], v248, s[80:83], s38 offen offset:1024 sc1
  s_add_u32 s38, s93, 3670016
  buffer_load_dwordx4 v[36:39], v248, s[80:83], s38 offen offset:0 sc1
  buffer_load_dwordx4 v[44:47], v248, s[80:83], s38 offen offset:1024 sc1
  s_add_u32 s38, s94, 3670016
  buffer_load_dwordx4 v[52:55], v248, s[80:83], s38 offen offset:0 sc1
  buffer_load_dwordx4 v[60:63], v248, s[80:83], s38 offen offset:1024 sc1
L_x52:
  s_add_u32 s38, s95, 3670016
  buffer_load_dwordx4 v[68:71], v248, s[80:83], s38 offen offset:0 sc1
  buffer_load_dwordx4 v[76:79], v248, s[80:83], s38 offen offset:1024 sc1
L_x53:
  v_cmp_eq_u64 vcc, v[246:247], v[254:255]
  s_cmp_lg_u32 s56, 0
  s_cbranch_scc1 L_x54
  s_cmp_eq_u32 vcc_lo, s46
  s_cbranch_scc0 L_x55
  s_cmp_eq_u32 s37, 0
  s_cbranch_scc1 L_x55
  s_mov_b32 s56, 1
L_x54:
  s_add_u32 s38, s89, 3670016
  buffer_load_dwordx4 v[84:87], v248, s[80:83], s38 offen offset:2048 sc1
  buffer_load_dwordx4 v[92:95], v248, s[80:83], s38 offen offset:3072 sc1
L_x55:
  v_mfma_f32_16x16x32_bf16 v[132:135], v[192:195], v[100:103], v[132:135]
  ds_read_b64_tr_b16 v[216:217], v238 offset:57344
  ds_read_b64_tr_b16 v[218:219], v238 offset:58368
  s_waitcnt lgkmcnt(10)
  v_mfma_f32_16x16x32_bf16 v[140:143], v[196:199], v[100:103], v[140:143]
  ds_read_b64_tr_b16 v[220:221], v239 offset:57344
  ds_read_b64_tr_b16 v[222:223], v239 offset:58368
  s_waitcnt lgkmcnt(10)
  v_mfma_f32_16x16x32_bf16 v[148:151], v[200:203], v[100:103], v[148:151]
  ds_read_b64_tr_b16 v[192:193], v240 offset:49152
  ds_read_b64_tr_b16 v[194:195], v240 offset:50176
  s_waitcnt lgkmcnt(10)
  v_mfma_f32_16x16x32_bf16 v[156:159], v[204:207], v[100:103], v[156:159]
  ds_read_b64_tr_b16 v[196:197], v241 offset:49152
  ds_read_b64_tr_b16 v[198:199], v241 offset:50176
  s_waitcnt lgkmcnt(10)
  v_mfma_f32_16x16x32_bf16 v[132:135], v[208:211], v[108:111], v[132:135]
  ds_read_b64_tr_b16 v[200:201], v242 offset:49152
  ds_read_b64_tr_b16 v[202:203], v242 offset:50176
  s_waitcnt lgkmcnt(10)
  v_mfma_f32_16x16x32_bf16 v[140:143], v[212:215], v[108:111], v[140:143]
  ds_read_b64_tr_b16 v[204:205], v243 offset:49152
  ds_read_b64_tr_b16 v[206:207], v243 offset:50176
  s_waitcnt lgkmcnt(10)
  v_mfma_f32_16x16x32_bf16 v[148:151], v[216:219], v[108:111], v[148:151]
  ds_read_b64_tr_b16 v[208:209], v240 offset:57344
  ds_read_b64_tr_b16 v[210:211], v240 offset:58368
  s_waitcnt lgkmcnt(10)
  v_mfma_f32_16x16x32_bf16 v[156:159], v[220:223], v[108:111], v[156:159]
  ds_read_b64_tr_b16 v[212:213], v241 offset:57344
  ds_read_b64_tr_b16 v[214:215], v241 offset:58368
  s_waitcnt lgkmcnt(10)
  v_mfma_f32_16x16x32_bf16 v[132:135], v[192:195], v[116:119], v[132:135]
  ds_read_b64_tr_b16 v[216:217], v242 offset:57344
  ds_read_b64_tr_b16 v[218:219], v242 offset:58368
  s_waitcnt lgkmcnt(10)
  v_mfma_f32_16x16x32_bf16 v[140:143], v[196:199], v[116:119], v[140:143]
  ds_read_b64_tr_b16 v[220:221], v243 offset:57344
  ds_read_b64_tr_b16 v[222:223], v243 offset:58368
  s_waitcnt lgkmcnt(10)
  v_mfma_f32_16x16x32_bf16 v[148:151], v[200:203], v[116:119], v[148:151]
  v_add_u32 v236, 131072, v236
  v_add_u32 v237, 131072, v237
  v_add_u32 v238, 131072, v238
  v_add_u32 v239, 131072, v239
  v_add_u32 v240, 131072, v240
  v_add_u32 v241, 131072, v241
  v_add_u32 v242, 131072, v242
  v_add_u32 v243, 131072, v243
  ds_read_b64_tr_b16 v[192:193], v236 offset:16384
  ds_read_b64_tr_b16 v[194:195], v236 offset:17408
  s_waitcnt lgkmcnt(10)
  v_mfma_f32_16x16x32_bf16 v[156:159], v[204:207], v[116:119], v[156:159]
  ds_read_b128 v[244:247], v233
  ds_read_b64_tr_b16 v[196:197], v237 offset:16384
  ds_read_b64_tr_b16 v[198:199], v237 offset:17408
  s_waitcnt lgkmcnt(11)
  v_mfma_f32_16x16x32_bf16 v[132:135], v[208:211], v[124:127], v[132:135]
  ds_read_b64_tr_b16 v[200:201], v238 offset:16384
  ds_read_b64_tr_b16 v[202:203], v238 offset:17408
  s_waitcnt lgkmcnt(11)
  v_mfma_f32_16x16x32_bf16 v[140:143], v[212:215], v[124:127], v[140:143]
  ds_read_b64_tr_b16 v[204:205], v239 offset:16384
  ds_read_b64_tr_b16 v[206:207], v239 offset:17408
  s_waitcnt lgkmcnt(11)
  v_mfma_f32_16x16x32_bf16 v[148:151], v[216:219], v[124:127], v[148:151]
  ds_read_b64_tr_b16 v[208:209], v236 offset:24576
  ds_read_b64_tr_b16 v[210:211], v236 offset:25600
  s_waitcnt lgkmcnt(11)
  v_mfma_f32_16x16x32_bf16 v[156:159], v[220:223], v[124:127], v[156:159]
  ds_read_b64_tr_b16 v[212:213], v237 offset:24576
  ds_read_b64_tr_b16 v[214:215], v237 offset:25600
  s_waitcnt lgkmcnt(10)
  v_cmp_eq_u64 vcc, v[244:245], v[254:255]
  s_cmp_lg_u32 s37, 0
  s_cbranch_scc1 L_x56
  s_cmp_eq_u32 vcc_lo, s50
  s_cbranch_scc0 L_x57
  s_mov_b32 s37, 1
  s_add_u32 s38, s89, 3670016
  buffer_load_dwordx4 v[96:99], v248, s[80:83], s38 offen offset:0 sc1
  buffer_load_dwordx4 v[104:107], v248, s[80:83], s38 offen offset:1024 sc1
  s_add_u32 s38, s90, 3670016
  buffer_load_dwordx4 v[112:115], v248, s[80:83], s38 offen offset:0 sc1
  buffer_load_dwordx4 v[120:123], v248, s[80:83], s38 offen offset:1024 sc1
  s_add_u32 s38, s91, 3670016
  buffer_load_dwordx4 v[4:7], v248, s[80:83], s38 offen offset:0 sc1
  buffer_load_dwordx4 v[12:15], v248, s[80:83], s38 offen offset:1024 sc1
  s_add_u32 s38, s92, 3670016
  buffer_load_dwordx4 v[20:23], v248, s[80:83], s38 offen offset:0 sc1
  buffer_load_dwordx4 v[28:31], v248, s[80:83], s38 offen offset:1024 sc1
  s_add_u32 s38, s93, 3670016
  buffer_load_dwordx4 v[36:39], v248, s[80:83], s38 offen offset:0 sc1
  buffer_load_dwordx4 v[44:47], v248, s[80:83], s38 offen offset:1024 sc1
  s_add_u32 s38, s94, 3670016
  buffer_load_dwordx4 v[52:55], v248, s[80:83], s38 offen offset:0 sc1
  buffer_load_dwordx4 v[60:63], v248, s[80:83], s38 offen offset:1024 sc1
  s_add_u32 s38, s95, 3670016
  buffer_load_dwordx4 v[68:71], v248, s[80:83], s38 offen offset:0 sc1
  buffer_load_dwordx4 v[76:79], v248, s[80:83], s38 offen offset:1024 sc1
L_x56:
L_x57:
  v_cmp_eq_u64 vcc, v[246:247], v[254:255]
  s_cmp_lg_u32 s56, 0
  s_cbranch_scc1 L_x58
  s_cmp_eq_u32 vcc_lo, s46
  s_cbranch_scc0 L_x59
  s_cmp_eq_u32 s37, 0
  s_cbranch_scc1 L_x59
  s_mov_b32 s56, 1
  s_add_u32 s38, s89, 3670016
  buffer_load_dwordx4 v[84:87], v248, s[80:83], s38 offen offset:2048 sc1
  buffer_load_dwordx4 v[92:95], v248, s[80:83], s38 offen offset:3072 sc1
L_x58:
  s_add_u32 s38, s90, 3670016
  buffer_load_dwordx4 v[100:103], v248, s[80:83], s38 offen offset:2048 sc1
  buffer_load_dwordx4 v[108:111], v248, s[80:83], s38 offen offset:3072 sc1
  s_add_u32 s38, s91, 3670016
  buffer_load_dwordx4 v[116:119], v248, s[80:83], s38 offen offset:2048 sc1
  buffer_load_dwordx4 v[124:127], v248, s[80:83], s38 offen offset:3072 sc1
L_x59:
  v_mfma_f32_16x16x32_bf16 v[132:135], v[192:195], v[0:3], v[132:135]
  ds_read_b64_tr_b16 v[216:217], v238 offset:24576
  ds_read_b64_tr_b16 v[218:219], v238 offset:25600
  s_waitcnt lgkmcnt(10)
  v_mfma_f32_16x16x32_bf16 v[140:143], v[196:199], v[0:3], v[140:143]
  ds_read_b64_tr_b16 v[220:221], v239 offset:24576
  ds_read_b64_tr_b16 v[222:223], v239 offset:25600
  s_waitcnt lgkmcnt(10)
  v_mfma_f32_16x16x32_bf16 v[148:151], v[200:203], v[0:3], v[148:151]
  ds_read_b64_tr_b16 v[192:193], v240 offset:16384
  ds_read_b64_tr_b16 v[194:195], v240 offset:17408
  s_waitcnt lgkmcnt(10)
  v_mfma_f32_16x16x32_bf16 v[156:159], v[204:207], v[0:3], v[156:159]
  ds_read_b64_tr_b16 v[196:197], v241 offset:16384
  ds_read_b64_tr_b16 v[198:199], v241 offset:17408
  s_waitcnt lgkmcnt(10)
  v_mfma_f32_16x16x32_bf16 v[132:135], v[208:211], v[8:11], v[132:135]
  ds_read_b64_tr_b16 v[200:201], v242 offset:16384
  ds_read_b64_tr_b16 v[202:203], v242 offset:17408
  s_waitcnt lgkmcnt(10)
  v_mfma_f32_16x16x32_bf16 v[140:143], v[212:215], v[8:11], v[140:143]
  ds_read_b64_tr_b16 v[204:205], v243 offset:16384
  ds_read_b64_tr_b16 v[206:207], v243 offset:17408
  s_waitcnt lgkmcnt(10)
  v_mfma_f32_16x16x32_bf16 v[148:151], v[216:219], v[8:11], v[148:151]
  ds_read_b64_tr_b16 v[208:209], v240 offset:24576
  ds_read_b64_tr_b16 v[210:211], v240 offset:25600
  s_waitcnt lgkmcnt(10)
  v_mfma_f32_16x16x32_bf16 v[156:159], v[220:223], v[8:11], v[156:159]
  ds_read_b64_tr_b16 v[212:213], v241 offset:24576
  ds_read_b64_tr_b16 v[214:215], v241 offset:25600
  s_waitcnt lgkmcnt(10)
  v_mfma_f32_16x16x32_bf16 v[132:135], v[192:195], v[16:19], v[132:135]
  ds_read_b64_tr_b16 v[216:217], v242 offset:24576
  ds_read_b64_tr_b16 v[218:219], v242 offset:25600
  s_waitcnt lgkmcnt(10)
  v_mfma_f32_16x16x32_bf16 v[140:143], v[196:199], v[16:19], v[140:143]
  ds_read_b64_tr_b16 v[220:221], v243 offset:24576
  ds_read_b64_tr_b16 v[222:223], v243 offset:25600
  s_waitcnt lgkmcnt(10)
  v_mfma_f32_16x16x32_bf16 v[148:151], v[200:203], v[16:19], v[148:151]
  v_subrev_u32 v236, 65536, v236
  v_subrev_u32 v237, 65536, v237
  v_subrev_u32 v238, 65536, v238
  v_subrev_u32 v239, 65536, v239
  v_subrev_u32 v240, 65536, v240
  v_subrev_u32 v241, 65536, v241
  v_subrev_u32 v242, 65536, v242
  v_subrev_u32 v243, 65536, v243
  ds_read_b64_tr_b16 v[192:193], v236 offset:49152
  ds_read_b64_tr_b16 v[194:195], v236 offset:50176
  s_waitcnt lgkmcnt(10)
  v_mfma_f32_16x16x32_bf16 v[156:159], v[204:207], v[16:19], v[156:159]
  ds_read_b128 v[244:247], v233
  ds_read_b64_tr_b16 v[196:197], v237 offset:49152
  ds_read_b64_tr_b16 v[198:199], v237 offset:50176
  s_waitcnt lgkmcnt(11)
  v_mfma_f32_16x16x32_bf16 v[132:135], v[208:211], v[24:27], v[132:135]
  ds_read_b64_tr_b16 v[200:201], v238 offset:49152
  ds_read_b64_tr_b16 v[202:203], v238 offset:50176
  s_waitcnt lgkmcnt(11)
  v_mfma_f32_16x16x32_bf16 v[140:143], v[212:215], v[24:27], v[140:143]
  ds_read_b64_tr_b16 v[204:205], v239 offset:49152
  ds_read_b64_tr_b16 v[206:207], v239 offset:50176
  s_waitcnt lgkmcnt(11)
  v_mfma_f32_16x16x32_bf16 v[148:151], v[216:219], v[24:27], v[148:151]
  ds_read_b64_tr_b16 v[208:209], v236 offset:57344
  ds_read_b64_tr_b16 v[210:211], v236 offset:58368
  s_waitcnt lgkmcnt(11)
  v_mfma_f32_16x16x32_bf16 v[156:159], v[220:223], v[24:27], v[156:159]
  ds_read_b64_tr_b16 v[212:213], v237 offset:57344
  ds_read_b64_tr_b16 v[214:215], v237 offset:58368
  s_waitcnt lgkmcnt(10)
  v_cmp_eq_u64 vcc, v[244:245], v[254:255]
  s_cmp_lg_u32 s37, 0
  s_cbranch_scc1 L_x60
  s_cmp_eq_u32 vcc_lo, s50
  s_cbranch_scc0 L_x61
  s_mov_b32 s37, 1
  s_add_u32 s38, s89, 3670016
  buffer_load_dwordx4 v[96:99], v248, s[80:83], s38 offen offset:0 sc1
  buffer_load_dwordx4 v[104:107], v248, s[80:83], s38 offen offset:1024 sc1
  s_add_u32 s38, s90, 3670016
  buffer_load_dwordx4 v[112:115], v248, s[80:83], s38 offen offset:0 sc1
  buffer_load_dwordx4 v[120:123], v248, s[80:83], s38 offen offset:1024 sc1
  s_add_u32 s38, s91, 3670016
  buffer_load_dwordx4 v[4:7], v248, s[80:83], s38 offen offset:0 sc1
  buffer_load_dwordx4 v[12:15], v248, s[80:83], s38 offen offset:1024 sc1
  s_add_u32 s38, s92, 3670016
  buffer_load_dwordx4 v[20:23], v248, s[80:83], s38 offen offset:0 sc1
  buffer_load_dwordx4 v[28:31], v248, s[80:83], s38 offen offset:1024 sc1
  s_add_u32 s38, s93, 3670016
  buffer_load_dwordx4 v[36:39], v248, s[80:83], s38 offen offset:0 sc1
  buffer_load_dwordx4 v[44:47], v248, s[80:83], s38 offen offset:1024 sc1
  s_add_u32 s38, s94, 3670016
  buffer_load_dwordx4 v[52:55], v248, s[80:83], s38 offen offset:0 sc1
  buffer_load_dwordx4 v[60:63], v248, s[80:83], s38 offen offset:1024 sc1
  s_add_u32 s38, s95, 3670016
  buffer_load_dwordx4 v[68:71], v248, s[80:83], s38 offen offset:0 sc1
  buffer_load_dwordx4 v[76:79], v248, s[80:83], s38 offen offset:1024 sc1
L_x60:
L_x61:
  v_cmp_eq_u64 vcc, v[246:247], v[254:255]
  s_cmp_lg_u32 s56, 0
  s_cbranch_scc1 L_x62
  s_cmp_eq_u32 vcc_lo, s46
  s_cbranch_scc0 L_x63
  s_cmp_eq_u32 s37, 0
  s_cbranch_scc1 L_x63
  s_mov_b32 s56, 1
  s_add_u32 s38, s89, 3670016
  buffer_load_dwordx4 v[84:87], v248, s[80:83], s38 offen offset:2048 sc1
  buffer_load_dwordx4 v[92:95], v248, s[80:83], s38 offen offset:3072 sc1
  s_add_u32 s38, s90, 3670016
  buffer_load_dwordx4 v[100:103], v248, s[80:83], s38 offen offset:2048 sc1
  buffer_load_dwordx4 v[108:111], v248, s[80:83], s38 offen offset:3072 sc1
  s_add_u32 s38, s91, 3670016
  buffer_load_dwordx4 v[116:119], v248, s[80:83], s38 offen offset:2048 sc1
  buffer_load_dwordx4 v[124:127], v248, s[80:83], s38 offen offset:3072 sc1
L_x62:
  s_add_u32 s38, s92, 3670016
  buffer_load_dwordx4 v[0:3], v248, s[80:83], s38 offen offset:2048 sc1
  buffer_load_dwordx4 v[8:11], v248, s[80:83], s38 offen offset:3072 sc1
  s_add_u32 s38, s93, 3670016
  buffer_load_dwordx4 v[16:19], v248, s[80:83], s38 offen offset:2048 sc1
  buffer_load_dwordx4 v[24:27], v248, s[80:83], s38 offen offset:3072 sc1
L_x63:
  v_mfma_f32_16x16x32_bf16 v[132:135], v[192:195], v[32:35], v[132:135]
  ds_read_b64_tr_b16 v[216:217], v238 offset:57344
  ds_read_b64_tr_b16 v[218:219], v238 offset:58368
  s_waitcnt lgkmcnt(10)
  v_mfma_f32_16x16x32_bf16 v[140:143], v[196:199], v[32:35], v[140:143]
  ds_read_b64_tr_b16 v[220:221], v239 offset:57344
  ds_read_b64_tr_b16 v[222:223], v239 offset:58368
  s_waitcnt lgkmcnt(10)
  v_mfma_f32_16x16x32_bf16 v[148:151], v[200:203], v[32:35], v[148:151]
  ds_read_b64_tr_b16 v[192:193], v240 offset:49152
  ds_read_b64_tr_b16 v[194:195], v240 offset:50176
  s_waitcnt lgkmcnt(10)
  v_mfma_f32_16x16x32_bf16 v[156:159], v[204:207], v[32:35], v[156:159]
  ds_read_b64_tr_b16 v[196:197], v241 offset:49152
  ds_read_b64_tr_b16 v[198:199], v241 offset:50176
  s_waitcnt lgkmcnt(10)
  v_mfma_f32_16x16x32_bf16 v[132:135], v[208:211], v[40:43], v[132:135]
  ds_read_b64_tr_b16 v[200:201], v242 offset:49152
  ds_read_b64_tr_b16 v[202:203], v242 offset:50176
  s_waitcnt lgkmcnt(10)
  v_mfma_f32_16x16x32_bf16 v[140:143], v[212:215], v[40:43], v[140:143]
  ds_read_b64_tr_b16 v[204:205], v243 offset:49152
  ds_read_b64_tr_b16 v[206:207], v243 offset:50176
  s_waitcnt lgkmcnt(10)
  v_mfma_f32_16x16x32_bf16 v[148:151], v[216:219], v[40:43], v[148:151]
  ds_read_b64_tr_b16 v[208:209], v240 offset:57344
  ds_read_b64_tr_b16 v[210:211], v240 offset:58368
  s_waitcnt lgkmcnt(10)
  v_mfma_f32_16x16x32_bf16 v[156:159], v[220:223], v[40:43], v[156:159]
  ds_read_b64_tr_b16 v[212:213], v241 offset:57344
  ds_read_b64_tr_b16 v[214:215], v241 offset:58368
  s_waitcnt lgkmcnt(10)
  v_mfma_f32_16x16x32_bf16 v[132:135], v[192:195], v[48:51], v[132:135]
  ds_read_b64_tr_b16 v[216:217], v242 offset:57344
  ds_read_b64_tr_b16 v[218:219], v242 offset:58368
  s_waitcnt lgkmcnt(10)
  v_mfma_f32_16x16x32_bf16 v[140:143], v[196:199], v[48:51], v[140:143]
  ds_read_b64_tr_b16 v[220:221], v243 offset:57344
  ds_read_b64_tr_b16 v[222:223], v243 offset:58368
  s_waitcnt lgkmcnt(10)
  v_mfma_f32_16x16x32_bf16 v[148:151], v[200:203], v[48:51], v[148:151]
  v_add_u32 v236, 65536, v236
  v_add_u32 v237, 65536, v237
  v_add_u32 v238, 65536, v238
  v_add_u32 v239, 65536, v239
  v_add_u32 v240, 65536, v240
  v_add_u32 v241, 65536, v241
  v_add_u32 v242, 65536, v242
  v_add_u32 v243, 65536, v243
  ds_read_b64_tr_b16 v[192:193], v236 offset:0
  ds_read_b64_tr_b16 v[194:195], v236 offset:1024
  s_waitcnt lgkmcnt(10)
  v_mfma_f32_16x16x32_bf16 v[156:159], v[204:207], v[48:51], v[156:159]
  ds_read_b128 v[244:247], v233
  ds_read_b64_tr_b16 v[196:197], v237 offset:0
  ds_read_b64_tr_b16 v[198:199], v237 offset:1024
  s_waitcnt lgkmcnt(11)
  v_mfma_f32_16x16x32_bf16 v[132:135], v[208:211], v[56:59], v[132:135]
  ds_read_b64_tr_b16 v[200:201], v238 offset:0
  ds_read_b64_tr_b16 v[202:203], v238 offset:1024
  s_waitcnt lgkmcnt(11)
  v_mfma_f32_16x16x32_bf16 v[140:143], v[212:215], v[56:59], v[140:143]
  ds_read_b64_tr_b16 v[204:205], v239 offset:0
  ds_read_b64_tr_b16 v[206:207], v239 offset:1024
  s_waitcnt lgkmcnt(11)
  v_mfma_f32_16x16x32_bf16 v[148:151], v[216:219], v[56:59], v[148:151]
  ds_read_b64_tr_b16 v[208:209], v236 offset:8192
  ds_read_b64_tr_b16 v[210:211], v236 offset:9216
  s_waitcnt lgkmcnt(11)
  v_mfma_f32_16x16x32_bf16 v[156:159], v[220:223], v[56:59], v[156:159]
  ds_read_b64_tr_b16 v[212:213], v237 offset:8192
  ds_read_b64_tr_b16 v[214:215], v237 offset:9216
  s_waitcnt lgkmcnt(10)
  v_cmp_eq_u64 vcc, v[244:245], v[254:255]
  s_cmp_lg_u32 s37, 0
  s_cbranch_scc1 L_x64
  s_cmp_eq_u32 vcc_lo, s50
  s_cbranch_scc0 L_x65
  s_mov_b32 s37, 1
  s_add_u32 s38, s89, 3670016
  buffer_load_dwordx4 v[96:99], v248, s[80:83], s38 offen offset:0 sc1
  buffer_load_dwordx4 v[104:107], v248, s[80:83], s38 offen offset:1024 sc1
  s_add_u32 s38, s90, 3670016
  buffer_load_dwordx4 v[112:115], v248, s[80:83], s38 offen offset:0 sc1
  buffer_load_dwordx4 v[120:123], v248, s[80:83], s38 offen offset:1024 sc1
  s_add_u32 s38, s91, 3670016
  buffer_load_dwordx4 v[4:7], v248, s[80:83], s38 offen offset:0 sc1
  buffer_load_dwordx4 v[12:15], v248, s[80:83], s38 offen offset:1024 sc1
  s_add_u32 s38, s92, 3670016
  buffer_load_dwordx4 v[20:23], v248, s[80:83], s38 offen offset:0 sc1
  buffer_load_dwordx4 v[28:31], v248, s[80:83], s38 offen offset:1024 sc1
  s_add_u32 s38, s93, 3670016
  buffer_load_dwordx4 v[36:39], v248, s[80:83], s38 offen offset:0 sc1
  buffer_load_dwordx4 v[44:47], v248, s[80:83], s38 offen offset:1024 sc1
  s_add_u32 s38, s94, 3670016
  buffer_load_dwordx4 v[52:55], v248, s[80:83], s38 offen offset:0 sc1
  buffer_load_dwordx4 v[60:63], v248, s[80:83], s38 offen offset:1024 sc1
  s_add_u32 s38, s95, 3670016
  buffer_load_dwordx4 v[68:71], v248, s[80:83], s38 offen offset:0 sc1
  buffer_load_dwordx4 v[76:79], v248, s[80:83], s38 offen offset:1024 sc1
L_x64:
L_x65:
  v_cmp_eq_u64 vcc, v[246:247], v[254:255]
  s_cmp_lg_u32 s56, 0
  s_cbranch_scc1 L_x66
  s_cmp_eq_u32 vcc_lo, s46
  s_cbranch_scc0 L_x67
  s_cmp_eq_u32 s37, 0
  s_cbranch_scc1 L_x67
  s_mov_b32 s56, 1
  s_add_u32 s38, s89, 3670016
  buffer_load_dwordx4 v[84:87], v248, s[80:83], s38 offen offset:2048 sc1
  buffer_load_dwordx4 v[92:95], v248, s[80:83], s38 offen offset:3072 sc1
  s_add_u32 s38, s90, 3670016
  buffer_load_dwordx4 v[100:103], v248, s[80:83], s38 offen offset:2048 sc1
  buffer_load_dwordx4 v[108:111], v248, s[80:83], s38 offen offset:3072 sc1
  s_add_u32 s38, s91, 3670016
  buffer_load_dwordx4 v[116:119], v248, s[80:83], s38 offen offset:2048 sc1
  buffer_load_dwordx4 v[124:127], v248, s[80:83], s38 offen offset:3072 sc1
  s_add_u32 s38, s92, 3670016
  buffer_load_dwordx4 v[0:3], v248, s[80:83], s38 offen offset:2048 sc1
  buffer_load_dwordx4 v[8:11], v248, s[80:83], s38 offen offset:3072 sc1
  s_add_u32 s38, s93, 3670016
  buffer_load_dwordx4 v[16:19], v248, s[80:83], s38 offen offset:2048 sc1
  buffer_load_dwordx4 v[24:27], v248, s[80:83], s38 offen offset:3072 sc1
L_x66:
  s_add_u32 s38, s94, 3670016
  buffer_load_dwordx4 v[32:35], v248, s[80:83], s38 offen offset:2048 sc1
  buffer_load_dwordx4 v[40:43], v248, s[80:83], s38 offen offset:3072 sc1
  s_add_u32 s38, s95, 3670016
  buffer_load_dwordx4 v[48:51], v248, s[80:83], s38 offen offset:2048 sc1
  buffer_load_dwordx4 v[56:59], v248, s[80:83], s38 offen offset:3072 sc1
L_x67:
  v_mfma_f32_16x16x32_bf16 v[132:135], v[192:195], v[64:67], v[132:135]
  ds_read_b64_tr_b16 v[216:217], v238 offset:8192
  ds_read_b64_tr_b16 v[218:219], v238 offset:9216
  s_waitcnt lgkmcnt(10)
  v_mfma_f32_16x16x32_bf16 v[140:143], v[196:199], v[64:67], v[140:143]
  ds_read_b64_tr_b16 v[220:221], v239 offset:8192
  ds_read_b64_tr_b16 v[222:223], v239 offset:9216
  s_waitcnt lgkmcnt(10)
  v_mfma_f32_16x16x32_bf16 v[148:151], v[200:203], v[64:67], v[148:151]
  ds_read_b64_tr_b16 v[192:193], v240 offset:0
  ds_read_b64_tr_b16 v[194:195], v240 offset:1024
  s_waitcnt lgkmcnt(10)
  v_mfma_f32_16x16x32_bf16 v[156:159], v[204:207], v[64:67], v[156:159]
  ds_read_b64_tr_b16 v[196:197], v241 offset:0
  ds_read_b64_tr_b16 v[198:199], v241 offset:1024
  s_waitcnt lgkmcnt(10)
  v_mfma_f32_16x16x32_bf16 v[132:135], v[208:211], v[72:75], v[132:135]
  ds_read_b64_tr_b16 v[200:201], v242 offset:0
  ds_read_b64_tr_b16 v[202:203], v242 offset:1024
  s_waitcnt lgkmcnt(10)
  v_mfma_f32_16x16x32_bf16 v[140:143], v[212:215], v[72:75], v[140:143]
  ds_read_b64_tr_b16 v[204:205], v243 offset:0
  ds_read_b64_tr_b16 v[206:207], v243 offset:1024
  s_waitcnt lgkmcnt(10)
  v_mfma_f32_16x16x32_bf16 v[148:151], v[216:219], v[72:75], v[148:151]
  ds_read_b64_tr_b16 v[208:209], v240 offset:8192
  ds_read_b64_tr_b16 v[210:211], v240 offset:9216
  s_waitcnt lgkmcnt(10)
  v_mfma_f32_16x16x32_bf16 v[156:159], v[220:223], v[72:75], v[156:159]
  ds_read_b64_tr_b16 v[212:213], v241 offset:8192
  ds_read_b64_tr_b16 v[214:215], v241 offset:9216
  s_waitcnt lgkmcnt(10)
  v_mfma_f32_16x16x32_bf16 v[132:135], v[192:195], v[80:83], v[132:135]
  ds_read_b64_tr_b16 v[216:217], v242 offset:8192
  ds_read_b64_tr_b16 v[218:219], v242 offset:9216
  s_waitcnt lgkmcnt(10)
  v_mfma_f32_16x16x32_bf16 v[140:143], v[196:199], v[80:83], v[140:143]
  ds_read_b64_tr_b16 v[220:221], v243 offset:8192
  ds_read_b64_tr_b16 v[222:223], v243 offset:9216
  s_waitcnt lgkmcnt(10)
  v_mfma_f32_16x16x32_bf16 v[148:151], v[200:203], v[80:83], v[148:151]
  v_subrev_u32 v236, 131072, v236
  v_subrev_u32 v237, 131072, v237
  v_subrev_u32 v238, 131072, v238
  v_subrev_u32 v239, 131072, v239
  v_subrev_u32 v240, 131072, v240
  v_subrev_u32 v241, 131072, v241
  v_subrev_u32 v242, 131072, v242
  v_subrev_u32 v243, 131072, v243
  ds_read_b64_tr_b16 v[192:193], v236 offset:0
  ds_read_b64_tr_b16 v[194:195], v236 offset:1024
  s_waitcnt lgkmcnt(10)
  v_mfma_f32_16x16x32_bf16 v[156:159], v[204:207], v[80:83], v[156:159]
  ds_read_b128 v[244:247], v233
  ds_read_b64_tr_b16 v[196:197], v237 offset:0
  ds_read_b64_tr_b16 v[198:199], v237 offset:1024
  s_waitcnt lgkmcnt(11)
  v_mfma_f32_16x16x32_bf16 v[132:135], v[208:211], v[88:91], v[132:135]
  ds_read_b64_tr_b16 v[200:201], v238 offset:0
  ds_read_b64_tr_b16 v[202:203], v238 offset:1024
  s_waitcnt lgkmcnt(11)
  v_mfma_f32_16x16x32_bf16 v[140:143], v[212:215], v[88:91], v[140:143]
  ds_read_b64_tr_b16 v[204:205], v239 offset:0
  ds_read_b64_tr_b16 v[206:207], v239 offset:1024
  s_waitcnt lgkmcnt(11)
  v_mfma_f32_16x16x32_bf16 v[148:151], v[216:219], v[88:91], v[148:151]
  ds_read_b64_tr_b16 v[208:209], v236 offset:8192
  ds_read_b64_tr_b16 v[210:211], v236 offset:9216
  s_waitcnt lgkmcnt(11)
  v_mfma_f32_16x16x32_bf16 v[156:159], v[220:223], v[88:91], v[156:159]
  ds_read_b64_tr_b16 v[212:213], v237 offset:8192
  ds_read_b64_tr_b16 v[214:215], v237 offset:9216
  s_waitcnt lgkmcnt(10)
  v_cmp_eq_u64 vcc, v[244:245], v[254:255]
  s_cmp_lg_u32 s37, 0
  s_cbranch_scc1 L_x68
  s_cmp_eq_u32 vcc_lo, s50
  s_cbranch_scc0 L_x69
  s_mov_b32 s37, 1
  s_add_u32 s38, s89, 3670016
  buffer_load_dwordx4 v[96:99], v248, s[80:83], s38 offen offset:0 sc1
  buffer_load_dwordx4 v[104:107], v248, s[80:83], s38 offen offset:1024 sc1
  s_add_u32 s38, s90, 3670016
  buffer_load_dwordx4 v[112:115], v248, s[80:83], s38 offen offset:0 sc1
  buffer_load_dwordx4 v[120:123], v248, s[80:83], s38 offen offset:1024 sc1
  s_add_u32 s38, s91, 3670016
  buffer_load_dwordx4 v[4:7], v248, s[80:83], s38 offen offset:0 sc1
  buffer_load_dwordx4 v[12:15], v248, s[80:83], s38 offen offset:1024 sc1
  s_add_u32 s38, s92, 3670016
  buffer_load_dwordx4 v[20:23], v248, s[80:83], s38 offen offset:0 sc1
  buffer_load_dwordx4 v[28:31], v248, s[80:83], s38 offen offset:1024 sc1
  s_add_u32 s38, s93, 3670016
  buffer_load_dwordx4 v[36:39], v248, s[80:83], s38 offen offset:0 sc1
  buffer_load_dwordx4 v[44:47], v248, s[80:83], s38 offen offset:1024 sc1
  s_add_u32 s38, s94, 3670016
  buffer_load_dwordx4 v[52:55], v248, s[80:83], s38 offen offset:0 sc1
  buffer_load_dwordx4 v[60:63], v248, s[80:83], s38 offen offset:1024 sc1
  s_add_u32 s38, s95, 3670016
  buffer_load_dwordx4 v[68:71], v248, s[80:83], s38 offen offset:0 sc1
  buffer_load_dwordx4 v[76:79], v248, s[80:83], s38 offen offset:1024 sc1
L_x68:
L_x69:
  v_cmp_eq_u64 vcc, v[246:247], v[254:255]
  s_cmp_lg_u32 s56, 0
  s_cbranch_scc1 L_x70
  s_cmp_eq_u32 vcc_lo, s46
  s_cbranch_scc0 L_x71
  s_cmp_eq_u32 s37, 0
  s_cbranch_scc1 L_x71
  s_mov_b32 s56, 1
  s_add_u32 s38, s89, 3670016
  buffer_load_dwordx4 v[84:87], v248, s[80:83], s38 offen offset:2048 sc1
  buffer_load_dwordx4 v[92:95], v248, s[80:83], s38 offen offset:3072 sc1
  s_add_u32 s38, s90, 3670016
  buffer_load_dwordx4 v[100:103], v248, s[80:83], s38 offen offset:2048 sc1
  buffer_load_dwordx4 v[108:111], v248, s[80:83], s38 offen offset:3072 sc1
  s_add_u32 s38, s91, 3670016
  buffer_load_dwordx4 v[116:119], v248, s[80:83], s38 offen offset:2048 sc1
  buffer_load_dwordx4 v[124:127], v248, s[80:83], s38 offen offset:3072 sc1
  s_add_u32 s38, s92, 3670016
  buffer_load_dwordx4 v[0:3], v248, s[80:83], s38 offen offset:2048 sc1
  buffer_load_dwordx4 v[8:11], v248, s[80:83], s38 offen offset:3072 sc1
  s_add_u32 s38, s93, 3670016
  buffer_load_dwordx4 v[16:19], v248, s[80:83], s38 offen offset:2048 sc1
  buffer_load_dwordx4 v[24:27], v248, s[80:83], s38 offen offset:3072 sc1
  s_add_u32 s38, s94, 3670016
  buffer_load_dwordx4 v[32:35], v248, s[80:83], s38 offen offset:2048 sc1
  buffer_load_dwordx4 v[40:43], v248, s[80:83], s38 offen offset:3072 sc1
  s_add_u32 s38, s95, 3670016
  buffer_load_dwordx4 v[48:51], v248, s[80:83], s38 offen offset:2048 sc1
  buffer_load_dwordx4 v[56:59], v248, s[80:83], s38 offen offset:3072 sc1
L_x70:
L_x71:
  s_cmp_lg_u32 s37, 0
  s_cbranch_scc1 L_x75
  s_cmp_lg_u32 s57, 0
  s_cbranch_scc1 L_x75
  s_mov_b32 s54, 2048
L_x72:
  ds_read_b64 v[246:247], v233 offset:0
  ds_read_b64 v[234:235], v232 offset:32
  s_waitcnt lgkmcnt(0)
  v_cmp_eq_u64 vcc, v[246:247], v[254:255]
  v_cmp_eq_u64_e64 s[98:99], v[234:235], v[254:255]
  s_nop 1
  s_cmp_eq_u32 vcc_lo, s50
  s_cbranch_scc1 L_x73
  s_cmp_lg_u32 s98, 0
  s_cbranch_scc1 L_x74
  s_sub_u32 s54, s54, 1
  s_cbranch_scc1 L_x74
  s_sleep 1
  s_branch L_x72
L_x74:
  s_mov_b32 s57, 1
  s_mov_b32 s86, 0
  s_branch L_x75
L_x73:
  s_mov_b32 s37, 1
  s_add_u32 s38, s89, 3670016
  buffer_load_dwordx4 v[96:99], v248, s[80:83], s38 offen offset:0 sc1
  buffer_load_dwordx4 v[104:107], v248, s[80:83], s38 offen offset:1024 sc1
  s_add_u32 s38, s90, 3670016
  buffer_load_dwordx4 v[112:115], v248, s[80:83], s38 offen offset:0 sc1
  buffer_load_dwordx4 v[120:123], v248, s[80:83], s38 offen offset:1024 sc1
  s_add_u32 s38, s91, 3670016
  buffer_load_dwordx4 v[4:7], v248, s[80:83], s38 offen offset:0 sc1
  buffer_load_dwordx4 v[12:15], v248, s[80:83], s38 offen offset:1024 sc1
  s_add_u32 s38, s92, 3670016
  buffer_load_dwordx4 v[20:23], v248, s[80:83], s38 offen offset:0 sc1
  buffer_load_dwordx4 v[28:31], v248, s[80:83], s38 offen offset:1024 sc1
  s_add_u32 s38, s93, 3670016
  buffer_load_dwordx4 v[36:39], v248, s[80:83], s38 offen offset:0 sc1
  buffer_load_dwordx4 v[44:47], v248, s[80:83], s38 offen offset:1024 sc1
  s_add_u32 s38, s94, 3670016
  buffer_load_dwordx4 v[52:55], v248, s[80:83], s38 offen offset:0 sc1
  buffer_load_dwordx4 v[60:63], v248, s[80:83], s38 offen offset:1024 sc1
  s_add_u32 s38, s95, 3670016
  buffer_load_dwordx4 v[68:71], v248, s[80:83], s38 offen offset:0 sc1
  buffer_load_dwordx4 v[76:79], v248, s[80:83], s38 offen offset:1024 sc1
L_x75:
  s_cmp_lg_u32 s56, 0
  s_cbranch_scc1 L_x76
  s_waitcnt vmcnt(0)
  s_branch L_x77
L_x76:
  s_waitcnt vmcnt(14)
L_x77:
  s_cmp_lg_u32 s9, 2
  s_cbranch_scc1 L_x78
  s_nop 7
  s_mov_b32 s38, 0
  buffer_store_dwordx4 v[132:135], v248, s[84:87], s38 offen offset:0 sc1
  buffer_store_dwordx4 v[140:143], v248, s[84:87], s38 offen offset:1024 sc1
  s_mov_b32 s38, 57344
  buffer_store_dwordx4 v[148:151], v248, s[84:87], s38 offen offset:0 sc1
  buffer_store_dwordx4 v[156:159], v248, s[84:87], s38 offen offset:1024 sc1
L_x78:
  v_mfma_f32_16x16x32_bf16 v[164:167], v[192:195], v[96:99], v[164:167]
  ds_read_b64_tr_b16 v[216:217], v238 offset:8192
  ds_read_b64_tr_b16 v[218:219], v238 offset:9216
  s_waitcnt lgkmcnt(10)
  v_mfma_f32_16x16x32_bf16 v[172:175], v[196:199], v[96:99], v[172:175]
  ds_read_b64_tr_b16 v[220:221], v239 offset:8192
  ds_read_b64_tr_b16 v[222:223], v239 offset:9216
  s_waitcnt lgkmcnt(10)
  v_mfma_f32_16x16x32_bf16 v[180:183], v[200:203], v[96:99], v[180:183]
  ds_read_b64_tr_b16 v[192:193], v236 offset:16384
  ds_read_b64_tr_b16 v[194:195], v236 offset:17408
  s_waitcnt lgkmcnt(10)
  v_mfma_f32_16x16x32_bf16 v[188:191], v[204:207], v[96:99], v[188:191]
  ds_read_b64 v[246:247], v233 offset:8
  ds_read_b64_tr_b16 v[196:197], v237 offset:16384
  ds_read_b64_tr_b16 v[198:199], v237 offset:17408
  s_waitcnt lgkmcnt(11)
  v_mfma_f32_16x16x32_bf16 v[164:167], v[208:211], v[104:107], v[164:167]
  ds_read_b64_tr_b16 v[200:201], v238 offset:16384
  ds_read_b64_tr_b16 v[202:203], v238 offset:17408
  s_waitcnt lgkmcnt(11)
  v_mfma_f32_16x16x32_bf16 v[172:175], v[212:215], v[104:107], v[172:175]
  ds_read_b64_tr_b16 v[204:205], v239 offset:16384
  ds_read_b64_tr_b16 v[206:207], v239 offset:17408
  s_waitcnt lgkmcnt(11)
  v_mfma_f32_16x16x32_bf16 v[180:183], v[216:219], v[104:107], v[180:183]
  ds_read_b64_tr_b16 v[208:209], v236 offset:24576
  ds_read_b64_tr_b16 v[210:211], v236 offset:25600
  s_waitcnt lgkmcnt(11)
  v_mfma_f32_16x16x32_bf16 v[188:191], v[220:223], v[104:107], v[188:191]
  ds_read_b64_tr_b16 v[212:213], v237 offset:24576
  ds_read_b64_tr_b16 v[214:215], v237 offset:25600
  s_waitcnt lgkmcnt(10)
  v_cmp_eq_u64 vcc, v[246:247], v[254:255]
  s_cmp_lg_u32 s56, 0
  s_cbranch_scc1 L_x79
  s_cmp_eq_u32 vcc_lo, s46
  s_cbranch_scc0 L_x80
  s_cmp_eq_u32 s37, 0
  s_cbranch_scc1 L_x80
  s_mov_b32 s56, 1
  s_mov_b32 s39, 1
  s_add_u32 s38, s89, 3670016
  buffer_load_dwordx4 v[84:87], v248, s[80:83], s38 offen offset:2048 sc1
  buffer_load_dwordx4 v[92:95], v248, s[80:83], s38 offen offset:3072 sc1
  s_add_u32 s38, s90, 3670016
  buffer_load_dwordx4 v[100:103], v248, s[80:83], s38 offen offset:2048 sc1
  buffer_load_dwordx4 v[108:111], v248, s[80:83], s38 offen offset:3072 sc1
  s_add_u32 s38, s91, 3670016
  buffer_load_dwordx4 v[116:119], v248, s[80:83], s38 offen offset:2048 sc1
  buffer_load_dwordx4 v[124:127], v248, s[80:83], s38 offen offset:3072 sc1
  s_add_u32 s38, s92, 3670016
  buffer_load_dwordx4 v[0:3], v248, s[80:83], s38 offen offset:2048 sc1
  buffer_load_dwordx4 v[8:11], v248, s[80:83], s38 offen offset:3072 sc1
  s_add_u32 s38, s93, 3670016
  buffer_load_dwordx4 v[16:19], v248, s[80:83], s38 offen offset:2048 sc1
  buffer_load_dwordx4 v[24:27], v248, s[80:83], s38 offen offset:3072 sc1
  s_add_u32 s38, s94, 3670016
  buffer_load_dwordx4 v[32:35], v248, s[80:83], s38 offen offset:2048 sc1
  buffer_load_dwordx4 v[40:43], v248, s[80:83], s38 offen offset:3072 sc1
  s_add_u32 s38, s95, 3670016
  buffer_load_dwordx4 v[48:51], v248, s[80:83], s38 offen offset:2048 sc1
  buffer_load_dwordx4 v[56:59], v248, s[80:83], s38 offen offset:3072 sc1
L_x79:
L_x80:
  v_mfma_f32_16x16x32_bf16 v[164:167], v[192:195], v[112:115], v[164:167]
  ds_read_b64_tr_b16 v[216:217], v238 offset:24576
  ds_read_b64_tr_b16 v[218:219], v238 offset:25600
  s_waitcnt lgkmcnt(10)
  v_mfma_f32_16x16x32_bf16 v[172:175], v[196:199], v[112:115], v[172:175]
  ds_read_b64_tr_b16 v[220:221], v239 offset:24576
  ds_read_b64_tr_b16 v[222:223], v239 offset:25600
  s_waitcnt lgkmcnt(10)
  v_mfma_f32_16x16x32_bf16 v[180:183], v[200:203], v[112:115], v[180:183]
  ds_read_b64_tr_b16 v[192:193], v236 offset:32768
  ds_read_b64_tr_b16 v[194:195], v236 offset:33792
  s_waitcnt lgkmcnt(10)
  v_mfma_f32_16x16x32_bf16 v[188:191], v[204:207], v[112:115], v[188:191]
  ds_read_b64 v[246:247], v233 offset:8
  ds_read_b64_tr_b16 v[196:197], v237 offset:32768
  ds_read_b64_tr_b16 v[198:199], v237 offset:33792
  s_waitcnt lgkmcnt(11)
  v_mfma_f32_16x16x32_bf16 v[164:167], v[208:211], v[120:123], v[164:167]
  ds_read_b64_tr_b16 v[200:201], v238 offset:32768
  ds_read_b64_tr_b16 v[202:203], v238 offset:33792
  s_waitcnt lgkmcnt(11)
  v_mfma_f32_16x16x32_bf16 v[172:175], v[212:215], v[120:123], v[172:175]
  ds_read_b64_tr_b16 v[204:205], v239 offset:32768
  ds_read_b64_tr_b16 v[206:207], v239 offset:33792
  s_waitcnt lgkmcnt(11)
  v_mfma_f32_16x16x32_bf16 v[180:183], v[216:219], v[120:123], v[180:183]
  ds_read_b64_tr_b16 v[208:209], v236 offset:40960
  ds_read_b64_tr_b16 v[210:211], v236 offset:41984
  s_waitcnt lgkmcnt(11)
  v_mfma_f32_16x16x32_bf16 v[188:191], v[220:223], v[120:123], v[188:191]
  ds_read_b64_tr_b16 v[212:213], v237 offset:40960
  ds_read_b64_tr_b16 v[214:215], v237 offset:41984
  s_waitcnt lgkmcnt(10)
  v_cmp_eq_u64 vcc, v[246:247], v[254:255]
  s_cmp_lg_u32 s56, 0
  s_cbranch_scc1 L_x81
  s_cmp_eq_u32 vcc_lo, s46
  s_cbranch_scc0 L_x82
  s_cmp_eq_u32 s37, 0
  s_cbranch_scc1 L_x82
  s_mov_b32 s56, 1
  s_mov_b32 s39, 1
  s_add_u32 s38, s89, 3670016
  buffer_load_dwordx4 v[84:87], v248, s[80:83], s38 offen offset:2048 sc1
  buffer_load_dwordx4 v[92:95], v248, s[80:83], s38 offen offset:3072 sc1
  s_add_u32 s38, s90, 3670016
  buffer_load_dwordx4 v[100:103], v248, s[80:83], s38 offen offset:2048 sc1
  buffer_load_dwordx4 v[108:111], v248, s[80:83], s38 offen offset:3072 sc1
  s_add_u32 s38, s91, 3670016
  buffer_load_dwordx4 v[116:119], v248, s[80:83], s38 offen offset:2048 sc1
  buffer_load_dwordx4 v[124:127], v248, s[80:83], s38 offen offset:3072 sc1
  s_add_u32 s38, s92, 3670016
  buffer_load_dwordx4 v[0:3], v248, s[80:83], s38 offen offset:2048 sc1
  buffer_load_dwordx4 v[8:11], v248, s[80:83], s38 offen offset:3072 sc1
  s_add_u32 s38, s93, 3670016
  buffer_load_dwordx4 v[16:19], v248, s[80:83], s38 offen offset:2048 sc1
  buffer_load_dwordx4 v[24:27], v248, s[80:83], s38 offen offset:3072 sc1
  s_add_u32 s38, s94, 3670016
  buffer_load_dwordx4 v[32:35], v248, s[80:83], s38 offen offset:2048 sc1
  buffer_load_dwordx4 v[40:43], v248, s[80:83], s38 offen offset:3072 sc1
  s_add_u32 s38, s95, 3670016
  buffer_load_dwordx4 v[48:51], v248, s[80:83], s38 offen offset:2048 sc1
  buffer_load_dwordx4 v[56:59], v248, s[80:83], s38 offen offset:3072 sc1
L_x81:
L_x82:
  v_mfma_f32_16x16x32_bf16 v[164:167], v[192:195], v[4:7], v[164:167]
  ds_read_b64_tr_b16 v[216:217], v238 offset:40960
  ds_read_b64_tr_b16 v[218:219], v238 offset:41984
  s_waitcnt lgkmcnt(10)
  v_mfma_f32_16x16x32_bf16 v[172:175], v[196:199], v[4:7], v[172:175]
  ds_read_b64_tr_b16 v[220:221], v239 offset:40960
  ds_read_b64_tr_b16 v[222:223], v239 offset:41984
  s_waitcnt lgkmcnt(10)
  v_mfma_f32_16x16x32_bf16 v[180:183], v[200:203], v[4:7], v[180:183]
  ds_read_b64_tr_b16 v[192:193], v236 offset:49152
  ds_read_b64_tr_b16 v[194:195], v236 offset:50176
  s_waitcnt lgkmcnt(10)
  v_mfma_f32_16x16x32_bf16 v[188:191], v[204:207], v[4:7], v[188:191]
  ds_read_b64 v[246:247], v233 offset:8
  ds_read_b64_tr_b16 v[196:197], v237 offset:49152
  ds_read_b64_tr_b16 v[198:199], v237 offset:50176
  s_waitcnt lgkmcnt(11)
  v_mfma_f32_16x16x32_bf16 v[164:167], v[208:211], v[12:15], v[164:167]
  ds_read_b64_tr_b16 v[200:201], v238 offset:49152
  ds_read_b64_tr_b16 v[202:203], v238 offset:50176
  s_waitcnt lgkmcnt(11)
  v_mfma_f32_16x16x32_bf16 v[172:175], v[212:215], v[12:15], v[172:175]
  ds_read_b64_tr_b16 v[204:205], v239 offset:49152
  ds_read_b64_tr_b16 v[206:207], v239 offset:50176
  s_waitcnt lgkmcnt(11)
  v_mfma_f32_16x16x32_bf16 v[180:183], v[216:219], v[12:15], v[180:183]
  ds_read_b64_tr_b16 v[208:209], v236 offset:57344
  ds_read_b64_tr_b16 v[210:211], v236 offset:58368
  s_waitcnt lgkmcnt(11)
  v_mfma_f32_16x16x32_bf16 v[188:191], v[220:223], v[12:15], v[188:191]
  ds_read_b64_tr_b16 v[212:213], v237 offset:57344
  ds_read_b64_tr_b16 v[214:215], v237 offset:58368
  s_waitcnt lgkmcnt(10)
  v_cmp_eq_u64 vcc, v[246:247], v[254:255]
  s_cmp_lg_u32 s56, 0
  s_cbranch_scc1 L_x83
  s_cmp_eq_u32 vcc_lo, s46
  s_cbranch_scc0 L_x84
  s_cmp_eq_u32 s37, 0
  s_cbranch_scc1 L_x84
  s_mov_b32 s56, 1
  s_mov_b32 s39, 1
  s_add_u32 s38, s89, 3670016
  buffer_load_dwordx4 v[84:87], v248, s[80:83], s38 offen offset:2048 sc1
  buffer_load_dwordx4 v[92:95], v248, s[80:83], s38 offen offset:3072 sc1
  s_add_u32 s38, s90, 3670016
  buffer_load_dwordx4 v[100:103], v248, s[80:83], s38 offen offset:2048 sc1
  buffer_load_dwordx4 v[108:111], v248, s[80:83], s38 offen offset:3072 sc1
  s_add_u32 s38, s91, 3670016
  buffer_load_dwordx4 v[116:119], v248, s[80:83], s38 offen offset:2048 sc1
  buffer_load_dwordx4 v[124:127], v248, s[80:83], s38 offen offset:3072 sc1
  s_add_u32 s38, s92, 3670016
  buffer_load_dwordx4 v[0:3], v248, s[80:83], s38 offen offset:2048 sc1
  buffer_load_dwordx4 v[8:11], v248, s[80:83], s38 offen offset:3072 sc1
  s_add_u32 s38, s93, 3670016
  buffer_load_dwordx4 v[16:19], v248, s[80:83], s38 offen offset:2048 sc1
  buffer_load_dwordx4 v[24:27], v248, s[80:83], s38 offen offset:3072 sc1
  s_add_u32 s38, s94, 3670016
  buffer_load_dwordx4 v[32:35], v248, s[80:83], s38 offen offset:2048 sc1
  buffer_load_dwordx4 v[40:43], v248, s[80:83], s38 offen offset:3072 sc1
  s_add_u32 s38, s95, 3670016
  buffer_load_dwordx4 v[48:51], v248, s[80:83], s38 offen offset:2048 sc1
  buffer_load_dwordx4 v[56:59], v248, s[80:83], s38 offen offset:3072 sc1
L_x83:
L_x84:
  v_mfma_f32_16x16x32_bf16 v[164:167], v[192:195], v[20:23], v[164:167]
  ds_read_b64_tr_b16 v[216:217], v238 offset:57344
  ds_read_b64_tr_b16 v[218:219], v238 offset:58368
  s_waitcnt lgkmcnt(10)
  v_mfma_f32_16x16x32_bf16 v[172:175], v[196:199], v[20:23], v[172:175]
  ds_read_b64_tr_b16 v[220:221], v239 offset:57344
  ds_read_b64_tr_b16 v[222:223], v239 offset:58368
  s_waitcnt lgkmcnt(10)
  v_mfma_f32_16x16x32_bf16 v[180:183], v[200:203], v[20:23], v[180:183]
  v_add_u32 v236, 131072, v236
  v_add_u32 v237, 131072, v237
  v_add_u32 v238, 131072, v238
  v_add_u32 v239, 131072, v239
  v_add_u32 v240, 131072, v240
  v_add_u32 v241, 131072, v241
  v_add_u32 v242, 131072, v242
  v_add_u32 v243, 131072, v243
  ds_read_b64_tr_b16 v[192:193], v236 offset:16384
  ds_read_b64_tr_b16 v[194:195], v236 offset:17408
  s_waitcnt lgkmcnt(10)
  v_mfma_f32_16x16x32_bf16 v[188:191], v[204:207], v[20:23], v[188:191]
  ds_read_b64 v[246:247], v233 offset:8
  ds_read_b64_tr_b16 v[196:197], v237 offset:16384
  ds_read_b64_tr_b16 v[198:199], v237 offset:17408
  s_waitcnt lgkmcnt(11)
  v_mfma_f32_16x16x32_bf16 v[164:167], v[208:211], v[28:31], v[164:167]
  ds_read_b64_tr_b16 v[200:201], v238 offset:16384
  ds_read_b64_tr_b16 v[202:203], v238 offset:17408
  s_waitcnt lgkmcnt(11)
  v_mfma_f32_16x16x32_bf16 v[172:175], v[212:215], v[28:31], v[172:175]
  ds_read_b64_tr_b16 v[204:205], v239 offset:16384
  ds_read_b64_tr_b16 v[206:207], v239 offset:17408
  s_waitcnt lgkmcnt(11)
  v_mfma_f32_16x16x32_bf16 v[180:183], v[216:219], v[28:31], v[180:183]
  ds_read_b64_tr_b16 v[208:209], v236 offset:24576
  ds_read_b64_tr_b16 v[210:211], v236 offset:25600
  s_waitcnt lgkmcnt(11)
  v_mfma_f32_16x16x32_bf16 v[188:191], v[220:223], v[28:31], v[188:191]
  ds_read_b64_tr_b16 v[212:213], v237 offset:24576
  ds_read_b64_tr_b16 v[214:215], v237 offset:25600
  s_waitcnt lgkmcnt(10)
  v_cmp_eq_u64 vcc, v[246:247], v[254:255]
  s_cmp_lg_u32 s56, 0
  s_cbranch_scc1 L_x85
  s_cmp_eq_u32 vcc_lo, s46
  s_cbranch_scc0 L_x86
  s_cmp_eq_u32 s37, 0
  s_cbranch_scc1 L_x86
  s_mov_b32 s56, 1
  s_mov_b32 s39, 1
  s_add_u32 s38, s89, 3670016
  buffer_load_dwordx4 v[84:87], v248, s[80:83], s38 offen offset:2048 sc1
  buffer_load_dwordx4 v[92:95], v248, s[80:83], s38 offen offset:3072 sc1
  s_add_u32 s38, s90, 3670016
  buffer_load_dwordx4 v[100:103], v248, s[80:83], s38 offen offset:2048 sc1
  buffer_load_dwordx4 v[108:111], v248, s[80:83], s38 offen offset:3072 sc1
  s_add_u32 s38, s91, 3670016
  buffer_load_dwordx4 v[116:119], v248, s[80:83], s38 offen offset:2048 sc1
  buffer_load_dwordx4 v[124:127], v248, s[80:83], s38 offen offset:3072 sc1
  s_add_u32 s38, s92, 3670016
  buffer_load_dwordx4 v[0:3], v248, s[80:83], s38 offen offset:2048 sc1
  buffer_load_dwordx4 v[8:11], v248, s[80:83], s38 offen offset:3072 sc1
  s_add_u32 s38, s93, 3670016
  buffer_load_dwordx4 v[16:19], v248, s[80:83], s38 offen offset:2048 sc1
  buffer_load_dwordx4 v[24:27], v248, s[80:83], s38 offen offset:3072 sc1
  s_add_u32 s38, s94, 3670016
  buffer_load_dwordx4 v[32:35], v248, s[80:83], s38 offen offset:2048 sc1
  buffer_load_dwordx4 v[40:43], v248, s[80:83], s38 offen offset:3072 sc1
  s_add_u32 s38, s95, 3670016
  buffer_load_dwordx4 v[48:51], v248, s[80:83], s38 offen offset:2048 sc1
  buffer_load_dwordx4 v[56:59], v248, s[80:83], s38 offen offset:3072 sc1
L_x85:
L_x86:
  v_mfma_f32_16x16x32_bf16 v[164:167], v[192:195], v[36:39], v[164:167]
  ds_read_b64_tr_b16 v[216:217], v238 offset:24576
  ds_read_b64_tr_b16 v[218:219], v238 offset:25600
  s_waitcnt lgkmcnt(10)
  v_mfma_f32_16x16x32_bf16 v[172:175], v[196:199], v[36:39], v[172:175]
  ds_read_b64_tr_b16 v[220:221], v239 offset:24576
  ds_read_b64_tr_b16 v[222:223], v239 offset:25600
  s_waitcnt lgkmcnt(10)
  v_mfma_f32_16x16x32_bf16 v[180:183], v[200:203], v[36:39], v[180:183]
  v_subrev_u32 v236, 65536, v236
  v_subrev_u32 v237, 65536, v237
  v_subrev_u32 v238, 65536, v238
  v_subrev_u32 v239, 65536, v239
  v_subrev_u32 v240, 65536, v240
  v_subrev_u32 v241, 65536, v241
  v_subrev_u32 v242, 65536, v242
  v_subrev_u32 v243, 65536, v243
  ds_read_b64_tr_b16 v[192:193], v236 offset:49152
  ds_read_b64_tr_b16 v[194:195], v236 offset:50176
  s_waitcnt lgkmcnt(10)
  v_mfma_f32_16x16x32_bf16 v[188:191], v[204:207], v[36:39], v[188:191]
  ds_read_b64 v[246:247], v233 offset:8
  ds_read_b64_tr_b16 v[196:197], v237 offset:49152
  ds_read_b64_tr_b16 v[198:199], v237 offset:50176
  s_waitcnt lgkmcnt(11)
  v_mfma_f32_16x16x32_bf16 v[164:167], v[208:211], v[44:47], v[164:167]
  ds_read_b64_tr_b16 v[200:201], v238 offset:49152
  ds_read_b64_tr_b16 v[202:203], v238 offset:50176
  s_waitcnt lgkmcnt(11)
  v_mfma_f32_16x16x32_bf16 v[172:175], v[212:215], v[44:47], v[172:175]
  ds_read_b64_tr_b16 v[204:205], v239 offset:49152
  ds_read_b64_tr_b16 v[206:207], v239 offset:50176
  s_waitcnt lgkmcnt(11)
  v_mfma_f32_16x16x32_bf16 v[180:183], v[216:219], v[44:47], v[180:183]
  ds_read_b64_tr_b16 v[208:209], v236 offset:57344
  ds_read_b64_tr_b16 v[210:211], v236 offset:58368
  s_waitcnt lgkmcnt(11)
  v_mfma_f32_16x16x32_bf16 v[188:191], v[220:223], v[44:47], v[188:191]
  ds_read_b64_tr_b16 v[212:213], v237 offset:57344
  ds_read_b64_tr_b16 v[214:215], v237 offset:58368
  s_cmp_lg_u32 s57, 0
  s_cbranch_scc1 L_x89
  s_cmp_lg_u32 s9, 2
  s_cbranch_scc1 L_x89
  s_cmp_lg_u32 s39, 0
  s_cbranch_scc1 L_x87
  s_waitcnt vmcnt(0)
  s_branch L_x88
L_x87:
  s_waitcnt vmcnt(14)
L_x88:
  v_mov_b32 v244, s10
  s_mov_b64 exec, 1
  buffer_atomic_or v244, off, s[20:23], 0 offset:0 sc0 sc1
  s_mov_b64 exec, -1
L_x89:
  s_waitcnt lgkmcnt(10)
  v_cmp_eq_u64 vcc, v[246:247], v[254:255]
  s_cmp_lg_u32 s56, 0
  s_cbranch_scc1 L_x90
  s_cmp_eq_u32 vcc_lo, s46
  s_cbranch_scc0 L_x91
  s_cmp_eq_u32 s37, 0
  s_cbranch_scc1 L_x91
  s_mov_b32 s56, 1
  s_mov_b32 s39, 1
  s_add_u32 s38, s89, 3670016
  buffer_load_dwordx4 v[84:87], v248, s[80:83], s38 offen offset:2048 sc1
  buffer_load_dwordx4 v[92:95], v248, s[80:83], s38 offen offset:3072 sc1
  s_add_u32 s38, s90, 3670016
  buffer_load_dwordx4 v[100:103], v248, s[80:83], s38 offen offset:2048 sc1
  buffer_load_dwordx4 v[108:111], v248, s[80:83], s38 offen offset:3072 sc1
  s_add_u32 s38, s91, 3670016
  buffer_load_dwordx4 v[116:119], v248, s[80:83], s38 offen offset:2048 sc1
  buffer_load_dwordx4 v[124:127], v248, s[80:83], s38 offen offset:3072 sc1
  s_add_u32 s38, s92, 3670016
  buffer_load_dwordx4 v[0:3], v248, s[80:83], s38 offen offset:2048 sc1
  buffer_load_dwordx4 v[8:11], v248, s[80:83], s38 offen offset:3072 sc1
  s_add_u32 s38, s93, 3670016
  buffer_load_dwordx4 v[16:19], v248, s[80:83], s38 offen offset:2048 sc1
  buffer_load_dwordx4 v[24:27], v248, s[80:83], s38 offen offset:3072 sc1
  s_add_u32 s38, s94, 3670016
  buffer_load_dwordx4 v[32:35], v248, s[80:83], s38 offen offset:2048 sc1
  buffer_load_dwordx4 v[40:43], v248, s[80:83], s38 offen offset:3072 sc1
  s_add_u32 s38, s95, 3670016
  buffer_load_dwordx4 v[48:51], v248, s[80:83], s38 offen offset:2048 sc1
  buffer_load_dwordx4 v[56:59], v248, s[80:83], s38 offen offset:3072 sc1
L_x90:
L_x91:
  v_mfma_f32_16x16x32_bf16 v[164:167], v[192:195], v[52:55], v[164:167]
  ds_read_b64_tr_b16 v[216:217], v238 offset:57344
  ds_read_b64_tr_b16 v[218:219], v238 offset:58368
  s_waitcnt lgkmcnt(10)
  v_mfma_f32_16x16x32_bf16 v[172:175], v[196:199], v[52:55], v[172:175]
  ds_read_b64_tr_b16 v[220:221], v239 offset:57344
  ds_read_b64_tr_b16 v[222:223], v239 offset:58368
  s_waitcnt lgkmcnt(10)
  v_mfma_f32_16x16x32_bf16 v[180:183], v[200:203], v[52:55], v[180:183]
  v_add_u32 v236, 65536, v236
  v_add_u32 v237, 65536, v237
  v_add_u32 v238, 65536, v238
  v_add_u32 v239, 65536, v239
  v_add_u32 v240, 65536, v240
  v_add_u32 v241, 65536, v241
  v_add_u32 v242, 65536, v242
  v_add_u32 v243, 65536, v243
  ds_read_b64_tr_b16 v[192:193], v236 offset:0
  ds_read_b64_tr_b16 v[194:195], v236 offset:1024
  s_waitcnt lgkmcnt(10)
  v_mfma_f32_16x16x32_bf16 v[188:191], v[204:207], v[52:55], v[188:191]
  ds_read_b64 v[246:247], v233 offset:8
  ds_read_b64_tr_b16 v[196:197], v237 offset:0
  ds_read_b64_tr_b16 v[198:199], v237 offset:1024
  s_waitcnt lgkmcnt(11)
  v_mfma_f32_16x16x32_bf16 v[164:167], v[208:211], v[60:63], v[164:167]
  ds_read_b64_tr_b16 v[200:201], v238 offset:0
  ds_read_b64_tr_b16 v[202:203], v238 offset:1024
  s_waitcnt lgkmcnt(11)
  v_mfma_f32_16x16x32_bf16 v[172:175], v[212:215], v[60:63], v[172:175]
  ds_read_b64_tr_b16 v[204:205], v239 offset:0
  ds_read_b64_tr_b16 v[206:207], v239 offset:1024
  s_waitcnt lgkmcnt(11)
  v_mfma_f32_16x16x32_bf16 v[180:183], v[216:219], v[60:63], v[180:183]
  ds_read_b64_tr_b16 v[208:209], v236 offset:8192
  ds_read_b64_tr_b16 v[210:211], v236 offset:9216
  s_waitcnt lgkmcnt(11)
  v_mfma_f32_16x16x32_bf16 v[188:191], v[220:223], v[60:63], v[188:191]
  ds_read_b64_tr_b16 v[212:213], v237 offset:8192
  ds_read_b64_tr_b16 v[214:215], v237 offset:9216
  s_waitcnt lgkmcnt(10)
  v_cmp_eq_u64 vcc, v[246:247], v[254:255]
  s_cmp_lg_u32 s56, 0
  s_cbranch_scc1 L_x92
  s_cmp_eq_u32 vcc_lo, s46
  s_cbranch_scc0 L_x93
  s_cmp_eq_u32 s37, 0
  s_cbranch_scc1 L_x93
  s_mov_b32 s56, 1
  s_mov_b32 s39, 1
  s_add_u32 s38, s89, 3670016
  buffer_load_dwordx4 v[84:87], v248, s[80:83], s38 offen offset:2048 sc1
  buffer_load_dwordx4 v[92:95], v248, s[80:83], s38 offen offset:3072 sc1
  s_add_u32 s38, s90, 3670016
  buffer_load_dwordx4 v[100:103], v248, s[80:83], s38 offen offset:2048 sc1
  buffer_load_dwordx4 v[108:111], v248, s[80:83], s38 offen offset:3072 sc1
  s_add_u32 s38, s91, 3670016
  buffer_load_dwordx4 v[116:119], v248, s[80:83], s38 offen offset:2048 sc1
  buffer_load_dwordx4 v[124:127], v248, s[80:83], s38 offen offset:3072 sc1
  s_add_u32 s38, s92, 3670016
  buffer_load_dwordx4 v[0:3], v248, s[80:83], s38 offen offset:2048 sc1
  buffer_load_dwordx4 v[8:11], v248, s[80:83], s38 offen offset:3072 sc1
  s_add_u32 s38, s93, 3670016
  buffer_load_dwordx4 v[16:19], v248, s[80:83], s38 offen offset:2048 sc1
  buffer_load_dwordx4 v[24:27], v248, s[80:83], s38 offen offset:3072 sc1
  s_add_u32 s38, s94, 3670016
  buffer_load_dwordx4 v[32:35], v248, s[80:83], s38 offen offset:2048 sc1
  buffer_load_dwordx4 v[40:43], v248, s[80:83], s38 offen offset:3072 sc1
  s_add_u32 s38, s95, 3670016
  buffer_load_dwordx4 v[48:51], v248, s[80:83], s38 offen offset:2048 sc1
  buffer_load_dwordx4 v[56:59], v248, s[80:83], s38 offen offset:3072 sc1
L_x92:
L_x93:
  v_mfma_f32_16x16x32_bf16 v[164:167], v[192:195], v[68:71], v[164:167]
  ds_read_b64_tr_b16 v[216:217], v238 offset:8192
  ds_read_b64_tr_b16 v[218:219], v238 offset:9216
  s_waitcnt lgkmcnt(10)
  v_mfma_f32_16x16x32_bf16 v[172:175], v[196:199], v[68:71], v[172:175]
  ds_read_b64_tr_b16 v[220:221], v239 offset:8192
  ds_read_b64_tr_b16 v[222:223], v239 offset:9216
  s_waitcnt lgkmcnt(10)
  v_mfma_f32_16x16x32_bf16 v[180:183], v[200:203], v[68:71], v[180:183]
  v_subrev_u32 v236, 131072, v236
  v_subrev_u32 v237, 131072, v237
  v_subrev_u32 v238, 131072, v238
  v_subrev_u32 v239, 131072, v239
  v_subrev_u32 v240, 131072, v240
  v_subrev_u32 v241, 131072, v241
  v_subrev_u32 v242, 131072, v242
  v_subrev_u32 v243, 131072, v243
  ds_read_b64_tr_b16 v[192:193], v240 offset:0
  ds_read_b64_tr_b16 v[194:195], v240 offset:1024
  s_waitcnt lgkmcnt(10)
  v_mfma_f32_16x16x32_bf16 v[188:191], v[204:207], v[68:71], v[188:191]
  ds_read_b64 v[246:247], v233 offset:8
  ds_read_b64_tr_b16 v[196:197], v241 offset:0
  ds_read_b64_tr_b16 v[198:199], v241 offset:1024
  s_waitcnt lgkmcnt(11)
  v_mfma_f32_16x16x32_bf16 v[164:167], v[208:211], v[76:79], v[164:167]
  ds_read_b64_tr_b16 v[200:201], v242 offset:0
  ds_read_b64_tr_b16 v[202:203], v242 offset:1024
  s_waitcnt lgkmcnt(11)
  v_mfma_f32_16x16x32_bf16 v[172:175], v[212:215], v[76:79], v[172:175]
  ds_read_b64_tr_b16 v[204:205], v243 offset:0
  ds_read_b64_tr_b16 v[206:207], v243 offset:1024
  s_waitcnt lgkmcnt(11)
  v_mfma_f32_16x16x32_bf16 v[180:183], v[216:219], v[76:79], v[180:183]
  ds_read_b64_tr_b16 v[208:209], v240 offset:8192
  ds_read_b64_tr_b16 v[210:211], v240 offset:9216
  s_waitcnt lgkmcnt(11)
  v_mfma_f32_16x16x32_bf16 v[188:191], v[220:223], v[76:79], v[188:191]
  ds_read_b64_tr_b16 v[212:213], v241 offset:8192
  ds_read_b64_tr_b16 v[214:215], v241 offset:9216
  s_waitcnt lgkmcnt(10)
  v_cmp_eq_u64 vcc, v[246:247], v[254:255]
  s_cmp_lg_u32 s56, 0
  s_cbranch_scc1 L_x94
  s_cmp_eq_u32 vcc_lo, s46
  s_cbranch_scc0 L_x95
  s_cmp_eq_u32 s37, 0
  s_cbranch_scc1 L_x95
  s_mov_b32 s56, 1
  s_mov_b32 s39, 1
  s_add_u32 s38, s89, 3670016
  buffer_load_dwordx4 v[84:87], v248, s[80:83], s38 offen offset:2048 sc1
  buffer_load_dwordx4 v[92:95], v248, s[80:83], s38 offen offset:3072 sc1
  s_add_u32 s38, s90, 3670016
  buffer_load_dwordx4 v[100:103], v248, s[80:83], s38 offen offset:2048 sc1
  buffer_load_dwordx4 v[108:111], v248, s[80:83], s38 offen offset:3072 sc1
  s_add_u32 s38, s91, 3670016
  buffer_load_dwordx4 v[116:119], v248, s[80:83], s38 offen offset:2048 sc1
  buffer_load_dwordx4 v[124:127], v248, s[80:83], s38 offen offset:3072 sc1
  s_add_u32 s38, s92, 3670016
  buffer_load_dwordx4 v[0:3], v248, s[80:83], s38 offen offset:2048 sc1
  buffer_load_dwordx4 v[8:11], v248, s[80:83], s38 offen offset:3072 sc1
  s_add_u32 s38, s93, 3670016
  buffer_load_dwordx4 v[16:19], v248, s[80:83], s38 offen offset:2048 sc1
  buffer_load_dwordx4 v[24:27], v248, s[80:83], s38 offen offset:3072 sc1
  s_add_u32 s38, s94, 3670016
  buffer_load_dwordx4 v[32:35], v248, s[80:83], s38 offen offset:2048 sc1
  buffer_load_dwordx4 v[40:43], v248, s[80:83], s38 offen offset:3072 sc1
  s_add_u32 s38, s95, 3670016
  buffer_load_dwordx4 v[48:51], v248, s[80:83], s38 offen offset:2048 sc1
  buffer_load_dwordx4 v[56:59], v248, s[80:83], s38 offen offset:3072 sc1
L_x94:
L_x95:
  s_cmp_lg_u32 s56, 0
  s_cbranch_scc1 L_x99
  s_cmp_lg_u32 s57, 0
  s_cbranch_scc1 L_x99
  s_mov_b32 s54, 2048
L_x96:
  ds_read_b64 v[246:247], v233 offset:8
  ds_read_b64 v[234:235], v232 offset:32
  s_waitcnt lgkmcnt(0)
  v_cmp_eq_u64 vcc, v[246:247], v[254:255]
  v_cmp_eq_u64_e64 s[98:99], v[234:235], v[254:255]
  s_nop 1
  s_cmp_eq_u32 vcc_lo, s46
  s_cbranch_scc1 L_x97
  s_cmp_lg_u32 s98, 0
  s_cbranch_scc1 L_x98
  s_sub_u32 s54, s54, 1
  s_cbranch_scc1 L_x98
  s_sleep 1
  s_branch L_x96
L_x98:
  s_mov_b32 s57, 1
  s_mov_b32 s86, 0
  s_branch L_x99
L_x97:
  s_mov_b32 s56, 1
  s_add_u32 s38, s89, 3670016
  buffer_load_dwordx4 v[84:87], v248, s[80:83], s38 offen offset:2048 sc1
  buffer_load_dwordx4 v[92:95], v248, s[80:83], s38 offen offset:3072 sc1
  s_add_u32 s38, s90, 3670016
  buffer_load_dwordx4 v[100:103], v248, s[80:83], s38 offen offset:2048 sc1
  buffer_load_dwordx4 v[108:111], v248, s[80:83], s38 offen offset:3072 sc1
  s_add_u32 s38, s91, 3670016
  buffer_load_dwordx4 v[116:119], v248, s[80:83], s38 offen offset:2048 sc1
  buffer_load_dwordx4 v[124:127], v248, s[80:83], s38 offen offset:3072 sc1
  s_add_u32 s38, s92, 3670016
  buffer_load_dwordx4 v[0:3], v248, s[80:83], s38 offen offset:2048 sc1
  buffer_load_dwordx4 v[8:11], v248, s[80:83], s38 offen offset:3072 sc1
  s_add_u32 s38, s93, 3670016
  buffer_load_dwordx4 v[16:19], v248, s[80:83], s38 offen offset:2048 sc1
  buffer_load_dwordx4 v[24:27], v248, s[80:83], s38 offen offset:3072 sc1
  s_add_u32 s38, s94, 3670016
  buffer_load_dwordx4 v[32:35], v248, s[80:83], s38 offen offset:2048 sc1
  buffer_load_dwordx4 v[40:43], v248, s[80:83], s38 offen offset:3072 sc1
  s_add_u32 s38, s95, 3670016
  buffer_load_dwordx4 v[48:51], v248, s[80:83], s38 offen offset:2048 sc1
  buffer_load_dwordx4 v[56:59], v248, s[80:83], s38 offen offset:3072 sc1
L_x99:
  s_cmp_eq_u32 s57, 0
  s_cbranch_scc1 L_x100
  s_mov_b32 s9, 0
  s_mov_b32 s11, 0
  s_mov_b32 s4, 0
L_x100:
  s_cmp_lg_u32 s4, 1
  s_cbranch_scc1 L_x101
  buffer_load_dword v246, off, s[20:23], s5 sc1
L_x101:
  s_waitcnt vmcnt(12)
  v_mfma_f32_16x16x32_bf16 v[164:167], v[192:195], v[84:87], v[164:167]
  ds_read_b64_tr_b16 v[216:217], v242 offset:8192
  ds_read_b64_tr_b16 v[218:219], v242 offset:9216
  s_waitcnt lgkmcnt(10)
  v_mfma_f32_16x16x32_bf16 v[172:175], v[196:199], v[84:87], v[172:175]
  ds_read_b64_tr_b16 v[220:221], v243 offset:8192
  ds_read_b64_tr_b16 v[222:223], v243 offset:9216
  s_waitcnt lgkmcnt(10)
  v_mfma_f32_16x16x32_bf16 v[180:183], v[200:203], v[84:87], v[180:183]
  ds_read_b64_tr_b16 v[192:193], v240 offset:16384
  ds_read_b64_tr_b16 v[194:195], v240 offset:17408
  s_waitcnt lgkmcnt(10)
  v_mfma_f32_16x16x32_bf16 v[188:191], v[204:207], v[84:87], v[188:191]
  ds_read_b64_tr_b16 v[196:197], v241 offset:16384
  ds_read_b64_tr_b16 v[198:199], v241 offset:17408
  s_waitcnt lgkmcnt(10)
  v_mfma_f32_16x16x32_bf16 v[164:167], v[208:211], v[92:95], v[164:167]
  ds_read_b64_tr_b16 v[200:201], v242 offset:16384
  ds_read_b64_tr_b16 v[202:203], v242 offset:17408
  s_waitcnt lgkmcnt(10)
  v_mfma_f32_16x16x32_bf16 v[172:175], v[212:215], v[92:95], v[172:175]
  ds_read_b64_tr_b16 v[204:205], v243 offset:16384
  ds_read_b64_tr_b16 v[206:207], v243 offset:17408
  s_waitcnt lgkmcnt(10)
  v_mfma_f32_16x16x32_bf16 v[180:183], v[216:219], v[92:95], v[180:183]
  ds_read_b64_tr_b16 v[208:209], v240 offset:24576
  ds_read_b64_tr_b16 v[210:211], v240 offset:25600
  s_waitcnt lgkmcnt(10)
  v_mfma_f32_16x16x32_bf16 v[188:191], v[220:223], v[92:95], v[188:191]
  ds_read_b64_tr_b16 v[212:213], v241 offset:24576
  ds_read_b64_tr_b16 v[214:215], v241 offset:25600
  s_waitcnt vmcnt(10)
  s_waitcnt lgkmcnt(10)
  v_mfma_f32_16x16x32_bf16 v[164:167], v[192:195], v[100:103], v[164:167]
  ds_read_b64_tr_b16 v[216:217], v242 offset:24576
  ds_read_b64_tr_b16 v[218:219], v242 offset:25600
  s_waitcnt lgkmcnt(10)
  v_mfma_f32_16x16x32_bf16 v[172:175], v[196:199], v[100:103], v[172:175]
  ds_read_b64_tr_b16 v[220:221], v243 offset:24576
  ds_read_b64_tr_b16 v[222:223], v243 offset:25600
  s_waitcnt lgkmcnt(10)
  v_mfma_f32_16x16x32_bf16 v[180:183], v[200:203], v[100:103], v[180:183]
  ds_read_b64_tr_b16 v[192:193], v240 offset:32768
  ds_read_b64_tr_b16 v[194:195], v240 offset:33792
  s_waitcnt lgkmcnt(10)
  v_mfma_f32_16x16x32_bf16 v[188:191], v[204:207], v[100:103], v[188:191]
  ds_read_b64_tr_b16 v[196:197], v241 offset:32768
  ds_read_b64_tr_b16 v[198:199], v241 offset:33792
  s_waitcnt lgkmcnt(10)
  v_mfma_f32_16x16x32_bf16 v[164:167], v[208:211], v[108:111], v[164:167]
  ds_read_b64_tr_b16 v[200:201], v242 offset:32768
  ds_read_b64_tr_b16 v[202:203], v242 offset:33792
  s_waitcnt lgkmcnt(10)
  v_mfma_f32_16x16x32_bf16 v[172:175], v[212:215], v[108:111], v[172:175]
  ds_read_b64_tr_b16 v[204:205], v243 offset:32768
  ds_read_b64_tr_b16 v[206:207], v243 offset:33792
  s_waitcnt lgkmcnt(10)
  v_mfma_f32_16x16x32_bf16 v[180:183], v[216:219], v[108:111], v[180:183]
  ds_read_b64_tr_b16 v[208:209], v240 offset:40960
  ds_read_b64_tr_b16 v[210:211], v240 offset:41984
  s_waitcnt lgkmcnt(10)
  v_mfma_f32_16x16x32_bf16 v[188:191], v[220:223], v[108:111], v[188:191]
  ds_read_b64_tr_b16 v[212:213], v241 offset:40960
  ds_read_b64_tr_b16 v[214:215], v241 offset:41984
  s_waitcnt vmcnt(8)
  s_waitcnt lgkmcnt(10)
  v_mfma_f32_16x16x32_bf16 v[164:167], v[192:195], v[116:119], v[164:167]
  ds_read_b64_tr_b16 v[216:217], v242 offset:40960
  ds_read_b64_tr_b16 v[218:219], v242 offset:41984
  s_waitcnt lgkmcnt(10)
  v_mfma_f32_16x16x32_bf16 v[172:175], v[196:199], v[116:119], v[172:175]
  ds_read_b64_tr_b16 v[220:221], v243 offset:40960
  ds_read_b64_tr_b16 v[222:223], v243 offset:41984
  s_waitcnt lgkmcnt(10)
  v_mfma_f32_16x16x32_bf16 v[180:183], v[200:203], v[116:119], v[180:183]
  ds_read_b64_tr_b16 v[192:193], v240 offset:49152
  ds_read_b64_tr_b16 v[194:195], v240 offset:50176
  s_waitcnt lgkmcnt(10)
  v_mfma_f32_16x16x32_bf16 v[188:191], v[204:207], v[116:119], v[188:191]
  ds_read_b64_tr_b16 v[196:197], v241 offset:49152
  ds_read_b64_tr_b16 v[198:199], v241 offset:50176
  s_waitcnt lgkmcnt(10)
  v_mfma_f32_16x16x32_bf16 v[164:167], v[208:211], v[124:127], v[164:167]
  ds_read_b64_tr_b16 v[200:201], v242 offset:49152
  ds_read_b64_tr_b16 v[202:203], v242 offset:50176
  s_waitcnt lgkmcnt(10)
  v_mfma_f32_16x16x32_bf16 v[172:175], v[212:215], v[124:127], v[172:175]
  ds_read_b64_tr_b16 v[204:205], v243 offset:49152
  ds_read_b64_tr_b16 v[206:207], v243 offset:50176
  s_waitcnt lgkmcnt(10)
  v_mfma_f32_16x16x32_bf16 v[180:183], v[216:219], v[124:127], v[180:183]
  ds_read_b64_tr_b16 v[208:209], v240 offset:57344
  ds_read_b64_tr_b16 v[210:211], v240 offset:58368
  s_waitcnt lgkmcnt(10)
  v_mfma_f32_16x16x32_bf16 v[188:191], v[220:223], v[124:127], v[188:191]
  ds_read_b64_tr_b16 v[212:213], v241 offset:57344
  ds_read_b64_tr_b16 v[214:215], v241 offset:58368
  s_waitcnt vmcnt(0)
  s_cmp_lg_u32 s4, 1
  s_cbranch_scc1 L_x103
  s_waitcnt vmcnt(0)
  v_readfirstlane_b32 s98, v246
  s_nop 0
  s_or_b32 s98, s98, s10
  s_and_b32 s98, s98, 15
  s_cmp_eq_u32 s98, 15
  s_cbranch_scc0 L_x102
  s_mov_b32 s4, 3
  s_add_u32 s38, s16, 0
  buffer_load_dwordx4 v[64:67], v248, s[28:31], s38 offen offset:0 sc1
  buffer_load_dwordx4 v[72:75], v248, s[28:31], s38 offen offset:1024 sc1
  s_add_u32 s38, s16, 57344
  buffer_load_dwordx4 v[80:83], v248, s[28:31], s38 offen offset:0 sc1
  buffer_load_dwordx4 v[88:91], v248, s[28:31], s38 offen offset:1024 sc1
  s_add_u32 s38, s17, 0
  buffer_load_dwordx4 v[96:99], v248, s[28:31], s38 offen offset:0 sc1
  buffer_load_dwordx4 v[104:107], v248, s[28:31], s38 offen offset:1024 sc1
  s_add_u32 s38, s17, 57344
  buffer_load_dwordx4 v[112:115], v248, s[28:31], s38 offen offset:0 sc1
  buffer_load_dwordx4 v[120:123], v248, s[28:31], s38 offen offset:1024 sc1
  s_add_u32 s38, s18, 0
  buffer_load_dwordx4 v[4:7], v248, s[28:31], s38 offen offset:0 sc1
  buffer_load_dwordx4 v[12:15], v248, s[28:31], s38 offen offset:1024 sc1
  s_add_u32 s38, s18, 57344
  buffer_load_dwordx4 v[20:23], v248, s[28:31], s38 offen offset:0 sc1
  buffer_load_dwordx4 v[28:31], v248, s[28:31], s38 offen offset:1024 sc1
  s_branch L_x103
L_x102:
  buffer_load_dword v246, off, s[20:23], s5 sc1
L_x103:
  s_waitcnt lgkmcnt(10)
  v_mfma_f32_16x16x32_bf16 v[164:167], v[192:195], v[0:3], v[164:167]
  ds_read_b64_tr_b16 v[216:217], v242 offset:57344
  ds_read_b64_tr_b16 v[218:219], v242 offset:58368
  s_waitcnt lgkmcnt(10)
  v_mfma_f32_16x16x32_bf16 v[172:175], v[196:199], v[0:3], v[172:175]
  ds_read_b64_tr_b16 v[220:221], v243 offset:57344
  ds_read_b64_tr_b16 v[222:223], v243 offset:58368
  s_waitcnt lgkmcnt(10)
  v_mfma_f32_16x16x32_bf16 v[180:183], v[200:203], v[0:3], v[180:183]
  v_add_u32 v236, 131072, v236
  v_add_u32 v237, 131072, v237
  v_add_u32 v238, 131072, v238
  v_add_u32 v239, 131072, v239
  v_add_u32 v240, 131072, v240
  v_add_u32 v241, 131072, v241
  v_add_u32 v242, 131072, v242
  v_add_u32 v243, 131072, v243
  ds_read_b64_tr_b16 v[192:193], v240 offset:16384
  ds_read_b64_tr_b16 v[194:195], v240 offset:17408
  s_waitcnt lgkmcnt(10)
  v_mfma_f32_16x16x32_bf16 v[188:191], v[204:207], v[0:3], v[188:191]
  ds_read_b64_tr_b16 v[196:197], v241 offset:16384
  ds_read_b64_tr_b16 v[198:199], v241 offset:17408
  s_waitcnt lgkmcnt(10)
  v_mfma_f32_16x16x32_bf16 v[164:167], v[208:211], v[8:11], v[164:167]
  ds_read_b64_tr_b16 v[200:201], v242 offset:16384
  ds_read_b64_tr_b16 v[202:203], v242 offset:17408
  s_waitcnt lgkmcnt(10)
  v_mfma_f32_16x16x32_bf16 v[172:175], v[212:215], v[8:11], v[172:175]
  ds_read_b64_tr_b16 v[204:205], v243 offset:16384
  ds_read_b64_tr_b16 v[206:207], v243 offset:17408
  s_waitcnt lgkmcnt(10)
  v_mfma_f32_16x16x32_bf16 v[180:183], v[216:219], v[8:11], v[180:183]
  ds_read_b64_tr_b16 v[208:209], v240 offset:24576
  ds_read_b64_tr_b16 v[210:211], v240 offset:25600
  s_waitcnt lgkmcnt(10)
  v_mfma_f32_16x16x32_bf16 v[188:191], v[220:223], v[8:11], v[188:191]
  ds_read_b64_tr_b16 v[212:213], v241 offset:24576
  ds_read_b64_tr_b16 v[214:215], v241 offset:25600
  s_waitcnt lgkmcnt(10)
  v_mfma_f32_16x16x32_bf16 v[164:167], v[192:195], v[16:19], v[164:167]
  ds_read_b64_tr_b16 v[216:217], v242 offset:24576
  ds_read_b64_tr_b16 v[218:219], v242 offset:25600
  s_waitcnt lgkmcnt(10)
  v_mfma_f32_16x16x32_bf16 v[172:175], v[196:199], v[16:19], v[172:175]
  ds_read_b64_tr_b16 v[220:221], v243 offset:24576
  ds_read_b64_tr_b16 v[222:223], v243 offset:25600
  s_waitcnt lgkmcnt(10)
  v_mfma_f32_16x16x32_bf16 v[180:183], v[200:203], v[16:19], v[180:183]
  v_subrev_u32 v236, 65536, v236
  v_subrev_u32 v237, 65536, v237
  v_subrev_u32 v238, 65536, v238
  v_subrev_u32 v239, 65536, v239
  v_subrev_u32 v240, 65536, v240
  v_subrev_u32 v241, 65536, v241
  v_subrev_u32 v242, 65536, v242
  v_subrev_u32 v243, 65536, v243
  ds_read_b64_tr_b16 v[192:193], v240 offset:49152
  ds_read_b64_tr_b16 v[194:195], v240 offset:50176
  s_waitcnt lgkmcnt(10)
  v_mfma_f32_16x16x32_bf16 v[188:191], v[204:207], v[16:19], v[188:191]
  ds_read_b64_tr_b16 v[196:197], v241 offset:49152
  ds_read_b64_tr_b16 v[198:199], v241 offset:50176
  s_waitcnt lgkmcnt(10)
  v_mfma_f32_16x16x32_bf16 v[164:167], v[208:211], v[24:27], v[164:167]
  ds_read_b64_tr_b16 v[200:201], v242 offset:49152
  ds_read_b64_tr_b16 v[202:203], v242 offset:50176
  s_waitcnt lgkmcnt(10)
  v_mfma_f32_16x16x32_bf16 v[172:175], v[212:215], v[24:27], v[172:175]
  ds_read_b64_tr_b16 v[204:205], v243 offset:49152
  ds_read_b64_tr_b16 v[206:207], v243 offset:50176
  s_waitcnt lgkmcnt(10)
  v_mfma_f32_16x16x32_bf16 v[180:183], v[216:219], v[24:27], v[180:183]
  ds_read_b64_tr_b16 v[208:209], v240 offset:57344
  ds_read_b64_tr_b16 v[210:211], v240 offset:58368
  s_waitcnt lgkmcnt(10)
  v_mfma_f32_16x16x32_bf16 v[188:191], v[220:223], v[24:27], v[188:191]
  ds_read_b64_tr_b16 v[212:213], v241 offset:57344
  ds_read_b64_tr_b16 v[214:215], v241 offset:58368
  s_cmp_lg_u32 s4, 1
  s_cbranch_scc1 L_x105
  s_waitcnt vmcnt(0)
  v_readfirstlane_b32 s98, v246
  s_nop 0
  s_or_b32 s98, s98, s10
  s_and_b32 s98, s98, 15
  s_cmp_eq_u32 s98, 15
  s_cbranch_scc0 L_x104
  s_mov_b32 s4, 3
  s_add_u32 s38, s16, 0
  buffer_load_dwordx4 v[64:67], v248, s[28:31], s38 offen offset:0 sc1
  buffer_load_dwordx4 v[72:75], v248, s[28:31], s38 offen offset:1024 sc1
  s_add_u32 s38, s16, 57344
  buffer_load_dwordx4 v[80:83], v248, s[28:31], s38 offen offset:0 sc1
  buffer_load_dwordx4 v[88:91], v248, s[28:31], s38 offen offset:1024 sc1
  s_add_u32 s38, s17, 0
  buffer_load_dwordx4 v[96:99], v248, s[28:31], s38 offen offset:0 sc1
  buffer_load_dwordx4 v[104:107], v248, s[28:31], s38 offen offset:1024 sc1
  s_add_u32 s38, s17, 57344
  buffer_load_dwordx4 v[112:115], v248, s[28:31], s38 offen offset:0 sc1
  buffer_load_dwordx4 v[120:123], v248, s[28:31], s38 offen offset:1024 sc1
  s_add_u32 s38, s18, 0
  buffer_load_dwordx4 v[4:7], v248, s[28:31], s38 offen offset:0 sc1
  buffer_load_dwordx4 v[12:15], v248, s[28:31], s38 offen offset:1024 sc1
  s_add_u32 s38, s18, 57344
  buffer_load_dwordx4 v[20:23], v248, s[28:31], s38 offen offset:0 sc1
  buffer_load_dwordx4 v[28:31], v248, s[28:31], s38 offen offset:1024 sc1
  s_branch L_x105
L_x104:
  buffer_load_dword v246, off, s[20:23], s5 sc1
L_x105:
  s_waitcnt lgkmcnt(10)
  v_mfma_f32_16x16x32_bf16 v[164:167], v[192:195], v[32:35], v[164:167]
  ds_read_b64_tr_b16 v[216:217], v242 offset:57344
  ds_read_b64_tr_b16 v[218:219], v242 offset:58368
  s_waitcnt lgkmcnt(10)
  v_mfma_f32_16x16x32_bf16 v[172:175], v[196:199], v[32:35], v[172:175]
  ds_read_b64_tr_b16 v[220:221], v243 offset:57344
  ds_read_b64_tr_b16 v[222:223], v243 offset:58368
  s_waitcnt lgkmcnt(10)
  v_mfma_f32_16x16x32_bf16 v[180:183], v[200:203], v[32:35], v[180:183]
  v_add_u32 v236, 65536, v236
  v_add_u32 v237, 65536, v237
  v_add_u32 v238, 65536, v238
  v_add_u32 v239, 65536, v239
  v_add_u32 v240, 65536, v240
  v_add_u32 v241, 65536, v241
  v_add_u32 v242, 65536, v242
  v_add_u32 v243, 65536, v243
  ds_read_b64_tr_b16 v[192:193], v240 offset:0
  ds_read_b64_tr_b16 v[194:195], v240 offset:1024
  s_waitcnt lgkmcnt(10)
  v_mfma_f32_16x16x32_bf16 v[188:191], v[204:207], v[32:35], v[188:191]
  ds_read_b64_tr_b16 v[196:197], v241 offset:0
  ds_read_b64_tr_b16 v[198:199], v241 offset:1024
  s_waitcnt lgkmcnt(10)
  v_mfma_f32_16x16x32_bf16 v[164:167], v[208:211], v[40:43], v[164:167]
  ds_read_b64_tr_b16 v[200:201], v242 offset:0
  ds_read_b64_tr_b16 v[202:203], v242 offset:1024
  s_waitcnt lgkmcnt(10)
  v_mfma_f32_16x16x32_bf16 v[172:175], v[212:215], v[40:43], v[172:175]
  ds_read_b64_tr_b16 v[204:205], v243 offset:0
  ds_read_b64_tr_b16 v[206:207], v243 offset:1024
  s_waitcnt lgkmcnt(10)
  v_mfma_f32_16x16x32_bf16 v[180:183], v[216:219], v[40:43], v[180:183]
  ds_read_b64_tr_b16 v[208:209], v240 offset:8192
  ds_read_b64_tr_b16 v[210:211], v240 offset:9216
  s_waitcnt lgkmcnt(10)
  v_mfma_f32_16x16x32_bf16 v[188:191], v[220:223], v[40:43], v[188:191]
  ds_read_b64_tr_b16 v[212:213], v241 offset:8192
  ds_read_b64_tr_b16 v[214:215], v241 offset:9216
  s_waitcnt lgkmcnt(10)
  v_mfma_f32_16x16x32_bf16 v[164:167], v[192:195], v[48:51], v[164:167]
  ds_read_b64_tr_b16 v[216:217], v242 offset:8192
  ds_read_b64_tr_b16 v[218:219], v242 offset:9216
  s_waitcnt lgkmcnt(10)
  v_mfma_f32_16x16x32_bf16 v[172:175], v[196:199], v[48:51], v[172:175]
  ds_read_b64_tr_b16 v[220:221], v243 offset:8192
  ds_read_b64_tr_b16 v[222:223], v243 offset:9216
  s_waitcnt lgkmcnt(10)
  v_mfma_f32_16x16x32_bf16 v[180:183], v[200:203], v[48:51], v[180:183]
  s_waitcnt lgkmcnt(8)
  v_mfma_f32_16x16x32_bf16 v[188:191], v[204:207], v[48:51], v[188:191]
  s_waitcnt lgkmcnt(6)
  v_mfma_f32_16x16x32_bf16 v[164:167], v[208:211], v[56:59], v[164:167]
  s_waitcnt lgkmcnt(4)
  v_mfma_f32_16x16x32_bf16 v[172:175], v[212:215], v[56:59], v[172:175]
  s_waitcnt lgkmcnt(2)
  v_mfma_f32_16x16x32_bf16 v[180:183], v[216:219], v[56:59], v[180:183]
  s_waitcnt lgkmcnt(0)
  v_mfma_f32_16x16x32_bf16 v[188:191], v[220:223], v[56:59], v[188:191]
  s_cmp_lg_u32 s11, 5
  s_cbranch_scc1 L_x107
  s_waitcnt vmcnt(0)
L_x107:
  s_cmp_lg_u32 s11, 2
  s_cbranch_scc1 L_x106
  s_nop 15
  s_mov_b32 s38, 3670016
  buffer_store_dwordx4 v[164:167], v248, s[84:87], s38 offen offset:0 sc1
  buffer_store_dwordx4 v[172:175], v248, s[84:87], s38 offen offset:1024 sc1
  s_mov_b32 s38, 3727360
  buffer_store_dwordx4 v[180:183], v248, s[84:87], s38 offen offset:0 sc1
  buffer_store_dwordx4 v[188:191], v248, s[84:87], s38 offen offset:1024 sc1
  s_waitcnt vmcnt(0)
  v_mov_b32 v245, s10
  s_mov_b64 exec, 1
  buffer_atomic_or v245, off, s[20:23], 0 offset:128 sc0 sc1
  s_mov_b64 exec, -1
L_x106:
  s_cmp_eq_u32 s9, 1
  s_cselect_b32 s9, s4, s9
  s_cmp_eq_u32 s11, 1
  s_cselect_b32 s11, s4, s11
  s_mov_b32 s54, s19
  s_nop 7
  v_and_b32 v251, 0xf0, v248
  v_lshlrev_b32 v251, 7, v251
  v_bfe_u32 v250, v248, 8, 2
  v_lshl_or_b32 v251, v250, 4, v251
  s_cmp_eq_u32 s9, 3
  s_cbranch_scc1 L_x111
  s_cmp_eq_u32 s9, 2
  s_cbranch_scc1 L_x112
  s_cmp_eq_u32 s9, 0
  s_cbranch_scc1 L_x108
L_x113:
  s_waitcnt vmcnt(0)
  v_readfirstlane_b32 s98, v246
  s_nop 0
  s_or_b32 s98, s98, s10
  s_and_b32 s98, s98, 15
  s_cmp_eq_u32 s98, 15
  s_cbranch_scc1 L_x109
  s_sub_u32 s54, s54, 1
  s_cbranch_scc1 L_x114
  buffer_load_dword v246, off, s[20:23], s5 sc1
  s_branch L_x113
L_x114:
  s_mov_b32 s38, 0
  buffer_store_dwordx4 v[132:135], v248, s[84:87], s38 offen offset:0 sc1
  buffer_store_dwordx4 v[140:143], v248, s[84:87], s38 offen offset:1024 sc1
  s_mov_b32 s38, 57344
  buffer_store_dwordx4 v[148:151], v248, s[84:87], s38 offen offset:0 sc1
  buffer_store_dwordx4 v[156:159], v248, s[84:87], s38 offen offset:1024 sc1
  s_waitcnt vmcnt(0)
  v_mov_b32 v244, s10
  s_mov_b64 exec, 1
  buffer_atomic_or v244, off, s[20:23], 0 offset:0 sc0 sc1
  s_mov_b64 exec, -1
L_x112:
  s_waitcnt vmcnt(0)
  v_readfirstlane_b32 s98, v244
  s_nop 0
  s_or_b32 s98, s98, s10
  s_and_b32 s98, s98, 15
  s_cmp_eq_u32 s98, 15
  s_cbranch_scc0 L_x108
  s_cmp_eq_u32 s11, 3
  s_cselect_b32 s11, 1, s11
L_x109:
  s_add_u32 s38, s6, 0
  buffer_load_dwordx4 v[64:67], v248, s[28:31], s38 offen offset:0 sc1
  buffer_load_dwordx4 v[72:75], v248, s[28:31], s38 offen offset:1024 sc1
  s_add_u32 s38, s6, 57344
  buffer_load_dwordx4 v[80:83], v248, s[28:31], s38 offen offset:0 sc1
  buffer_load_dwordx4 v[88:91], v248, s[28:31], s38 offen offset:1024 sc1
  s_add_u32 s38, s7, 0
  buffer_load_dwordx4 v[96:99], v248, s[28:31], s38 offen offset:0 sc1
  buffer_load_dwordx4 v[104:107], v248, s[28:31], s38 offen offset:1024 sc1
  s_add_u32 s38, s7, 57344
  buffer_load_dwordx4 v[112:115], v248, s[28:31], s38 offen offset:0 sc1
  buffer_load_dwordx4 v[120:123], v248, s[28:31], s38 offen offset:1024 sc1
  s_add_u32 s38, s8, 0
  buffer_load_dwordx4 v[4:7], v248, s[28:31], s38 offen offset:0 sc1
  buffer_load_dwordx4 v[12:15], v248, s[28:31], s38 offen offset:1024 sc1
  s_add_u32 s38, s8, 57344
  buffer_load_dwordx4 v[20:23], v248, s[28:31], s38 offen offset:0 sc1
  buffer_load_dwordx4 v[28:31], v248, s[28:31], s38 offen offset:1024 sc1
L_x110:
  s_waitcnt vmcnt(0)
L_x111:
  v_pk_add_f32 v[132:133], v[132:133], v[64:65]
  v_pk_add_f32 v[134:135], v[134:135], v[66:67]
  v_pk_add_f32 v[140:141], v[140:141], v[72:73]
  v_pk_add_f32 v[142:143], v[142:143], v[74:75]
  v_pk_add_f32 v[148:149], v[148:149], v[80:81]
  v_pk_add_f32 v[150:151], v[150:151], v[82:83]
  v_pk_add_f32 v[156:157], v[156:157], v[88:89]
  v_pk_add_f32 v[158:159], v[158:159], v[90:91]
  v_pk_add_f32 v[132:133], v[132:133], v[96:97]
  v_pk_add_f32 v[134:135], v[134:135], v[98:99]
  v_pk_add_f32 v[140:141], v[140:141], v[104:105]
  v_pk_add_f32 v[142:143], v[142:143], v[106:107]
  v_pk_add_f32 v[148:149], v[148:149], v[112:113]
  v_pk_add_f32 v[150:151], v[150:151], v[114:115]
  v_pk_add_f32 v[156:157], v[156:157], v[120:121]
  v_pk_add_f32 v[158:159], v[158:159], v[122:123]
  v_pk_add_f32 v[132:133], v[132:133], v[4:5]
  v_pk_add_f32 v[134:135], v[134:135], v[6:7]
  v_pk_add_f32 v[140:141], v[140:141], v[12:13]
  v_pk_add_f32 v[142:143], v[142:143], v[14:15]
  v_pk_add_f32 v[148:149], v[148:149], v[20:21]
  v_pk_add_f32 v[150:151], v[150:151], v[22:23]
  v_pk_add_f32 v[156:157], v[156:157], v[28:29]
  v_pk_add_f32 v[158:159], v[158:159], v[30:31]
  v_cvt_pk_bf16_f32 v132, v132, v133
  v_cvt_pk_bf16_f32 v133, v134, v135
  v_cvt_pk_bf16_f32 v134, v140, v141
  v_cvt_pk_bf16_f32 v135, v142, v143
  v_cndmask_b32_e64 v192, v132, v134, s[42:43]
  v_cndmask_b32_e64 v193, v133, v135, s[42:43]
  v_cndmask_b32_e64 v194, v134, v132, s[42:43]
  v_cndmask_b32_e64 v195, v135, v133, s[42:43]
  buffer_store_dwordx4 v[192:195], v251, s[24:27], 0 offen offset:0
  v_cvt_pk_bf16_f32 v148, v148, v149
  v_cvt_pk_bf16_f32 v149, v150, v151
  v_cvt_pk_bf16_f32 v150, v156, v157
  v_cvt_pk_bf16_f32 v151, v158, v159
  v_cndmask_b32_e64 v196, v148, v150, s[42:43]
  v_cndmask_b32_e64 v197, v149, v151, s[42:43]
  v_cndmask_b32_e64 v198, v150, v148, s[42:43]
  v_cndmask_b32_e64 v199, v151, v149, s[42:43]
  buffer_store_dwordx4 v[196:199], v251, s[24:27], 0 offen offset:64
L_x108:
  s_cmp_eq_u32 s11, 3
  s_cbranch_scc1 L_x117
  s_cmp_eq_u32 s11, 2
  s_cbranch_scc1 L_x119
  s_cmp_eq_u32 s11, 0
  s_cbranch_scc1 L_x115
L_x120:
  s_waitcnt vmcnt(0)
  v_readfirstlane_b32 s98, v246
  s_nop 0
  s_or_b32 s98, s98, s10
  s_and_b32 s98, s98, 15
  s_cmp_eq_u32 s98, 15
  s_cbranch_scc1 L_x116
  s_sub_u32 s54, s54, 1
  s_cbranch_scc1 L_x121
  buffer_load_dword v246, off, s[20:23], s5 sc1
  s_branch L_x120
L_x121:
  s_mov_b32 s38, 3670016
  buffer_store_dwordx4 v[164:167], v248, s[84:87], s38 offen offset:0 sc1
  buffer_store_dwordx4 v[172:175], v248, s[84:87], s38 offen offset:1024 sc1
  s_mov_b32 s38, 3727360
  buffer_store_dwordx4 v[180:183], v248, s[84:87], s38 offen offset:0 sc1
  buffer_store_dwordx4 v[188:191], v248, s[84:87], s38 offen offset:1024 sc1
  s_waitcnt vmcnt(0)
  v_mov_b32 v245, s10
  s_mov_b64 exec, 1
  buffer_atomic_or v245, off, s[20:23], 0 offset:128 sc0 sc1
  s_mov_b64 exec, -1
L_x119:
  s_waitcnt vmcnt(0)
  v_readfirstlane_b32 s98, v245
  s_nop 0
  s_or_b32 s98, s98, s10
  s_and_b32 s98, s98, 15
  s_cmp_eq_u32 s98, 15
  s_cbranch_scc0 L_x115
L_x116:
  s_add_u32 s38, s6, 3670016
  buffer_load_dwordx4 v[64:67], v248, s[28:31], s38 offen offset:0 sc1
  buffer_load_dwordx4 v[72:75], v248, s[28:31], s38 offen offset:1024 sc1
  s_add_u32 s38, s6, 3727360
  buffer_load_dwordx4 v[80:83], v248, s[28:31], s38 offen offset:0 sc1
  buffer_load_dwordx4 v[88:91], v248, s[28:31], s38 offen offset:1024 sc1
  s_add_u32 s38, s7, 3670016
  buffer_load_dwordx4 v[96:99], v248, s[28:31], s38 offen offset:0 sc1
  buffer_load_dwordx4 v[104:107], v248, s[28:31], s38 offen offset:1024 sc1
  s_add_u32 s38, s7, 3727360
  buffer_load_dwordx4 v[112:115], v248, s[28:31], s38 offen offset:0 sc1
  buffer_load_dwordx4 v[120:123], v248, s[28:31], s38 offen offset:1024 sc1
  s_add_u32 s38, s8, 3670016
  buffer_load_dwordx4 v[4:7], v248, s[28:31], s38 offen offset:0 sc1
  buffer_load_dwordx4 v[12:15], v248, s[28:31], s38 offen offset:1024 sc1
  s_add_u32 s38, s8, 3727360
  buffer_load_dwordx4 v[20:23], v248, s[28:31], s38 offen offset:0 sc1
  buffer_load_dwordx4 v[28:31], v248, s[28:31], s38 offen offset:1024 sc1
L_x117:
  s_waitcnt vmcnt(0)
L_x118:
  v_pk_add_f32 v[164:165], v[164:165], v[64:65]
  v_pk_add_f32 v[166:167], v[166:167], v[66:67]
  v_pk_add_f32 v[172:173], v[172:173], v[72:73]
  v_pk_add_f32 v[174:175], v[174:175], v[74:75]
  v_pk_add_f32 v[180:181], v[180:181], v[80:81]
  v_pk_add_f32 v[182:183], v[182:183], v[82:83]
  v_pk_add_f32 v[188:189], v[188:189], v[88:89]
  v_pk_add_f32 v[190:191], v[190:191], v[90:91]
  v_pk_add_f32 v[164:165], v[164:165], v[96:97]
  v_pk_add_f32 v[166:167], v[166:167], v[98:99]
  v_pk_add_f32 v[172:173], v[172:173], v[104:105]
  v_pk_add_f32 v[174:175], v[174:175], v[106:107]
  v_pk_add_f32 v[180:181], v[180:181], v[112:113]
  v_pk_add_f32 v[182:183], v[182:183], v[114:115]
  v_pk_add_f32 v[188:189], v[188:189], v[120:121]
  v_pk_add_f32 v[190:191], v[190:191], v[122:123]
  v_pk_add_f32 v[164:165], v[164:165], v[4:5]
  v_pk_add_f32 v[166:167], v[166:167], v[6:7]
  v_pk_add_f32 v[172:173], v[172:173], v[12:13]
  v_pk_add_f32 v[174:175], v[174:175], v[14:15]
  v_pk_add_f32 v[180:181], v[180:181], v[20:21]
  v_pk_add_f32 v[182:183], v[182:183], v[22:23]
  v_pk_add_f32 v[188:189], v[188:189], v[28:29]
  v_pk_add_f32 v[190:191], v[190:191], v[30:31]
  s_mov_b32 s38, 917504
  v_cvt_pk_bf16_f32 v164, v164, v165
  v_cvt_pk_bf16_f32 v165, v166, v167
  v_cvt_pk_bf16_f32 v166, v172, v173
  v_cvt_pk_bf16_f32 v167, v174, v175
  v_cndmask_b32_e64 v200, v164, v166, s[42:43]
  v_cndmask_b32_e64 v201, v165, v167, s[42:43]
  v_cndmask_b32_e64 v202, v166, v164, s[42:43]
  v_cndmask_b32_e64 v203, v167, v165, s[42:43]
  buffer_store_dwordx4 v[200:203], v251, s[24:27], s38 offen offset:0
  v_cvt_pk_bf16_f32 v180, v180, v181
  v_cvt_pk_bf16_f32 v181, v182, v183
  v_cvt_pk_bf16_f32 v182, v188, v189
  v_cvt_pk_bf16_f32 v183, v190, v191
  v_cndmask_b32_e64 v204, v180, v182, s[42:43]
  v_cndmask_b32_e64 v205, v181, v183, s[42:43]
  v_cndmask_b32_e64 v206, v182, v180, s[42:43]
  v_cndmask_b32_e64 v207, v183, v181, s[42:43]
  buffer_store_dwordx4 v[204:207], v251, s[24:27], s38 offen offset:64
L_x115:
  s_cmp_eq_u32 s57, 0
  s_cbranch_scc1 L_x122
  ds_write_b64 v232, v[254:255] offset:32
L_x122:
  s_waitcnt lgkmcnt(0)
L_fin:
  s_barrier
  ds_read_b64 v[234:235], v232 offset:32
  ds_read_b32 v233, v232
  s_waitcnt lgkmcnt(1)
  v_cmp_eq_u64 vcc, v[234:235], v[254:255]
  s_waitcnt lgkmcnt(0)
  v_readfirstlane_b32 s58, v233
  s_nop 1
  s_mov_b32 s57, vcc_lo
  s_nop 1
  s_or_b32 s98, s57, s58
  s_cbranch_scc0 L_k1_done
L_disp:
  s_waitcnt vmcnt(0) lgkmcnt(0)
  s_barrier
  s_cmp_lg_u32 s36, 3
  s_cbranch_scc1 L_x124
  s_cmp_eq_u32 s57, 0
  s_cbranch_scc1 L_x123
  s_lshl_b32 s98, s44, 3
  s_add_u32 s98, s98, 4096
  s_mov_b64 exec, 1
  buffer_store_dwordx2 v[254:255], off, s[68:71], s98 sc1
  s_mov_b64 exec, -1
  s_waitcnt vmcnt(0)
L_x123:
  s_mov_b32 s98, 4096
  buffer_load_dwordx2 v[0:1], v249, s[68:71], s98 offen sc1
  buffer_load_dwordx2 v[2:3], v249, s[68:71], 0 offen offset:0 sc1
  buffer_load_dwordx2 v[4:5], v249, s[68:71], 0 offen offset:512 sc1
  buffer_load_dwordx2 v[6:7], v249, s[68:71], 0 offen offset:1024 sc1
  buffer_load_dwordx2 v[8:9], v249, s[68:71], 0 offen offset:1536 sc1
  buffer_load_dwordx2 v[10:11], v249, s[68:71], 0 offen offset:2048 sc1
  buffer_load_dwordx2 v[12:13], v249, s[68:71], 0 offen offset:2560 sc1
  buffer_load_dwordx2 v[14:15], v249, s[68:71], 0 offen offset:3072 sc1
  buffer_load_dwordx2 v[16:17], v249, s[68:71], 0 offen offset:3584 sc1
  s_waitcnt vmcnt(0)
  v_cmp_eq_u64_e64 s[26:27], v[0:1], v[254:255]
  s_mov_b32 s59, 0
  v_cmp_eq_u64 vcc, v[2:3], v[254:255]
  v_cmp_eq_u64_e64 s[22:23], v[10:11], v[254:255]
  s_nop 4
  s_and_b64 vcc, vcc, s[22:23]
  s_or_b32 s98, vcc_hi, 0xff000000
  s_and_b32 s98, s98, vcc_lo
  s_cmp_eq_u32 s98, -1
  s_cselect_b32 s98, 0x11111111, 0
  s_or_b32 s59, s59, s98
  v_cmp_eq_u64 vcc, v[4:5], v[254:255]
  v_cmp_eq_u64_e64 s[22:23], v[12:13], v[254:255]
  s_nop 4
  s_and_b64 vcc, vcc, s[22:23]
  s_or_b32 s98, vcc_hi, 0xff000000
  s_and_b32 s98, s98, vcc_lo
  s_cmp_eq_u32 s98, -1
  s_cselect_b32 s98, 0x22222222, 0
  s_or_b32 s59, s59, s98
  v_cmp_eq_u64 vcc, v[6:7], v[254:255]
  v_cmp_eq_u64_e64 s[22:23], v[14:15], v[254:255]
  s_nop 4
  s_and_b64 vcc, vcc, s[22:23]
  s_or_b32 s98, vcc_hi, 0xff000000
  s_and_b32 s98, s98, vcc_lo
  s_cmp_eq_u32 s98, -1
  s_cselect_b32 s98, 0x44444444, 0
  s_or_b32 s59, s59, s98
  v_cmp_eq_u64 vcc, v[8:9], v[254:255]
  v_cmp_eq_u64_e64 s[22:23], v[16:17], v[254:255]
  s_nop 4
  s_and_b64 vcc, vcc, s[22:23]
  s_or_b32 s98, vcc_hi, 0xff000000
  s_and_b32 s98, s98, vcc_lo
  s_cmp_eq_u32 s98, -1
  s_cselect_b32 s98, 0x88888888, 0
  s_or_b32 s59, s59, s98
  s_and_b32 s59, s59, s26
  v_mov_b32 v234, s59
  ds_write_b32 v232, v234 offset:8
  s_waitcnt lgkmcnt(0)
L_x124:
  s_barrier
  ds_read_b32 v234, v232 offset:8
  s_waitcnt lgkmcnt(0)
  v_readfirstlane_b32 s59, v234
  s_nop 4
L_gen_loop:
  s_cmp_eq_u32 s59, 0
  s_cbranch_scc1 L_k1_done
  s_ff1_i32_b32 s63, s59
  s_bitset0_b32 s59, s63
  s_lshr_b32 s98, s63, 2
  s_and_b32 s99, s63, 3
  s_lshl_b32 s100, s66, 20
  s_lshl_b32 s101, s98, 7
  s_add_u32 s100, s100, s101
  s_add_u32 s76, s14, s100
  s_addc_u32 s77, s15, 0
  s_sub_u32 s78, 0x100000, s101
  s_mov_b32 s79, 0x20000
  s_lshl_b32 s100, s45, 3
  s_add_u32 s99, s99, s100
  s_mul_i32 s100, s99, 7
  s_add_u32 s100, s100, s36
  s_lshl_b32 s100, s100, 17
  s_lshl_b32 s101, s66, 15
  s_add_u32 s100, s100, s101
  s_add_u32 s80, s12, s100
  s_addc_u32 s81, s13, 0
  s_mov_b32 s82, 3702784
  s_mov_b32 s83, 0x20000
  s_lshl_b32 s99, s99, 4
  s_lshl_b32 s100, s98, 1
  s_add_u32 s99, s99, s100
  s_lshl_b32 s99, s99, 2
  s_add_u32 s99, s99, s66
  s_mul_i32 s99, s99, 14336
  s_lshl_b32 s100, s36, 11
  s_add_u32 s99, s99, s100
  s_add_u32 s99, s99, 0x2000000
  s_add_u32 s84, s12, s99
  s_addc_u32 s85, s13, 0
  s_mov_b32 s86, 3729408
  s_mov_b32 s87, 0x20000
  s_mov_b32 s88, 0
  s_mov_b32 s89, 4096
  s_mov_b32 s90, 8192
  s_mov_b32 s91, 12288
  s_mov_b32 s92, 16384
  s_mov_b32 s93, 20480
  s_mov_b32 s94, 24576
  s_mov_b32 s95, 28672
  s_cmp_eq_u32 s36, 7
  s_cbranch_scc1 L_gen_ld
  s_lshr_b32 s98, s63, 2
  s_and_b32 s99, s63, 3
  s_lshl_b32 s100, s45, 2
  s_add_u32 s100, s100, s99
  s_lshl_b32 s100, s100, 3
  s_add_u32 s100, s100, s98
  s_lshl_b32 s100, s100, 3
  s_add_u32 s100, s100, s36
  s_lshl_b32 s100, s100, 8
  s_add_u32 s100, s100, 0x3400000
  s_add_u32 s20, s12, s100
  s_addc_u32 s21, s13, 0
  s_mov_b32 s22, 256
  s_add_u32 s101, s98, s99
  s_add_u32 s101, s101, s36
  s_sub_u32 s101, s101, s66
  s_and_b32 s101, s101, 3
  s_mov_b32 s23, 0x20000
  s_mul_i32 s99, s99, 7
  s_add_u32 s99, s99, s36
  s_lshl_b32 s99, s99, 15
  s_lshl_b32 s100, s45, 10
  s_add_u32 s99, s99, s100
  s_lshl_b32 s100, s98, 7
  s_add_u32 s99, s99, s100
  s_add_u32 s24, s96, s99
  s_addc_u32 s25, s97, 0
  s_sub_u32 s26, 1835008, s99
  s_mov_b32 s27, 0x20000
  s_mul_i32 s100, s66, 14336
  s_sub_u32 s28, s84, s100
  s_subb_u32 s29, s85, 0
  s_mov_b32 s30, 3772416
  s_mov_b32 s31, 0x20000
  s_add_u32 s100, s66, 1
  s_and_b32 s100, s100, 3
  s_mul_i32 s6, s100, 14336
  s_add_u32 s100, s66, 2
  s_and_b32 s100, s100, 3
  s_mul_i32 s7, s100, 14336
  s_add_u32 s100, s66, 3
  s_and_b32 s100, s100, 3
  s_mul_i32 s8, s100, 14336
  s_lshl_b32 s10, 1, s66
  s_cmp_eq_u32 s101, 0
  s_cselect_b32 s9, 1, 2
  s_cmp_eq_u32 s101, 2
  s_cselect_b32 s11, 1, 2
  s_barrier
  s_mov_b32 s54, 0
  s_mov_b32 s55, 0
L_gen_item:
  s_add_u32 s38, s54, 0
  buffer_load_dwordx4 v[0:3], v248, s[80:83], s38 offen offset:0 sc1
  buffer_load_dwordx4 v[4:7], v248, s[80:83], s38 offen offset:1024 sc1
  buffer_load_dwordx4 v[8:11], v248, s[80:83], s38 offen offset:2048 sc1
  buffer_load_dwordx4 v[12:15], v248, s[80:83], s38 offen offset:3072 sc1
  s_add_u32 s38, s54, 4096
  buffer_load_dwordx4 v[16:19], v248, s[80:83], s38 offen offset:0 sc1
  buffer_load_dwordx4 v[20:23], v248, s[80:83], s38 offen offset:1024 sc1
  buffer_load_dwordx4 v[24:27], v248, s[80:83], s38 offen offset:2048 sc1
  buffer_load_dwordx4 v[28:31], v248, s[80:83], s38 offen offset:3072 sc1
  s_add_u32 s38, s54, 8192
  buffer_load_dwordx4 v[32:35], v248, s[80:83], s38 offen offset:0 sc1
  buffer_load_dwordx4 v[36:39], v248, s[80:83], s38 offen offset:1024 sc1
  buffer_load_dwordx4 v[40:43], v248, s[80:83], s38 offen offset:2048 sc1
  buffer_load_dwordx4 v[44:47], v248, s[80:83], s38 offen offset:3072 sc1
  s_add_u32 s38, s54, 12288
  buffer_load_dwordx4 v[48:51], v248, s[80:83], s38 offen offset:0 sc1
  buffer_load_dwordx4 v[52:55], v248, s[80:83], s38 offen offset:1024 sc1
  buffer_load_dwordx4 v[56:59], v248, s[80:83], s38 offen offset:2048 sc1
  buffer_load_dwordx4 v[60:63], v248, s[80:83], s38 offen offset:3072 sc1
  s_add_u32 s38, s54, 16384
  buffer_load_dwordx4 v[64:67], v248, s[80:83], s38 offen offset:0 sc1
  buffer_load_dwordx4 v[68:71], v248, s[80:83], s38 offen offset:1024 sc1
  buffer_load_dwordx4 v[72:75], v248, s[80:83], s38 offen offset:2048 sc1
  buffer_load_dwordx4 v[76:79], v248, s[80:83], s38 offen offset:3072 sc1
  s_add_u32 s38, s54, 20480
  buffer_load_dwordx4 v[80:83], v248, s[80:83], s38 offen offset:0 sc1
  buffer_load_dwordx4 v[84:87], v248, s[80:83], s38 offen offset:1024 sc1
  buffer_load_dwordx4 v[88:91], v248, s[80:83], s38 offen offset:2048 sc1
  buffer_load_dwordx4 v[92:95], v248, s[80:83], s38 offen offset:3072 sc1
  s_add_u32 s38, s54, 24576
  buffer_load_dwordx4 v[96:99], v248, s[80:83], s38 offen offset:0 sc1
  buffer_load_dwordx4 v[100:103], v248, s[80:83], s38 offen offset:1024 sc1
  buffer_load_dwordx4 v[104:107], v248, s[80:83], s38 offen offset:2048 sc1
  buffer_load_dwordx4 v[108:111], v248, s[80:83], s38 offen offset:3072 sc1
  s_add_u32 s38, s54, 28672
  buffer_load_dwordx4 v[112:115], v248, s[80:83], s38 offen offset:0 sc1
  buffer_load_dwordx4 v[116:119], v248, s[80:83], s38 offen offset:1024 sc1
  buffer_load_dwordx4 v[120:123], v248, s[80:83], s38 offen offset:2048 sc1
  buffer_load_dwordx4 v[124:127], v248, s[80:83], s38 offen offset:3072 sc1
  v_subrev_u32 v236, 65536, v236
  v_subrev_u32 v237, 65536, v237
  v_subrev_u32 v238, 65536, v238
  v_subrev_u32 v239, 65536, v239
  v_subrev_u32 v240, 65536, v240
  v_subrev_u32 v241, 65536, v241
  v_subrev_u32 v242, 65536, v242
  v_subrev_u32 v243, 65536, v243
  ds_read_b64_tr_b16 v[192:193], v236 offset:32768
  ds_read_b64_tr_b16 v[194:195], v236 offset:33792
  ds_read_b64_tr_b16 v[196:197], v237 offset:32768
  ds_read_b64_tr_b16 v[198:199], v237 offset:33792
  ds_read_b64_tr_b16 v[200:201], v238 offset:32768
  ds_read_b64_tr_b16 v[202:203], v238 offset:33792
  ds_read_b64_tr_b16 v[204:205], v239 offset:32768
  ds_read_b64_tr_b16 v[206:207], v239 offset:33792
  ds_read_b64_tr_b16 v[208:209], v236 offset:40960
  ds_read_b64_tr_b16 v[210:211], v236 offset:41984
  ds_read_b64_tr_b16 v[212:213], v237 offset:40960
  ds_read_b64_tr_b16 v[214:215], v237 offset:41984
  s_waitcnt lgkmcnt(10)
  s_waitcnt vmcnt(31)
  v_mfma_f32_16x16x32_bf16 v[132:135], v[192:195], v[0:3], 0
  ds_read_b64_tr_b16 v[216:217], v238 offset:40960
  ds_read_b64_tr_b16 v[218:219], v238 offset:41984
  s_waitcnt lgkmcnt(10)
  v_mfma_f32_16x16x32_bf16 v[140:143], v[196:199], v[0:3], 0
  ds_read_b64_tr_b16 v[220:221], v239 offset:40960
  ds_read_b64_tr_b16 v[222:223], v239 offset:41984
  s_waitcnt lgkmcnt(10)
  v_mfma_f32_16x16x32_bf16 v[148:151], v[200:203], v[0:3], 0
  ds_read_b64_tr_b16 v[192:193], v240 offset:32768
  ds_read_b64_tr_b16 v[194:195], v240 offset:33792
  s_waitcnt lgkmcnt(10)
  v_mfma_f32_16x16x32_bf16 v[156:159], v[204:207], v[0:3], 0
  ds_read_b64_tr_b16 v[196:197], v241 offset:32768
  ds_read_b64_tr_b16 v[198:199], v241 offset:33792
  s_waitcnt lgkmcnt(10)
  s_waitcnt vmcnt(30)
  v_mfma_f32_16x16x32_bf16 v[132:135], v[208:211], v[4:7], v[132:135]
  ds_read_b64_tr_b16 v[200:201], v242 offset:32768
  ds_read_b64_tr_b16 v[202:203], v242 offset:33792
  s_waitcnt lgkmcnt(10)
  v_mfma_f32_16x16x32_bf16 v[140:143], v[212:215], v[4:7], v[140:143]
  ds_read_b64_tr_b16 v[204:205], v243 offset:32768
  ds_read_b64_tr_b16 v[206:207], v243 offset:33792
  s_waitcnt lgkmcnt(10)
  v_mfma_f32_16x16x32_bf16 v[148:151], v[216:219], v[4:7], v[148:151]
  ds_read_b64_tr_b16 v[208:209], v240 offset:40960
  ds_read_b64_tr_b16 v[210:211], v240 offset:41984
  s_waitcnt lgkmcnt(10)
  v_mfma_f32_16x16x32_bf16 v[156:159], v[220:223], v[4:7], v[156:159]
  ds_read_b64_tr_b16 v[212:213], v241 offset:40960
  ds_read_b64_tr_b16 v[214:215], v241 offset:41984
  s_waitcnt lgkmcnt(10)
  s_waitcnt vmcnt(29)
  v_mfma_f32_16x16x32_bf16 v[132:135], v[192:195], v[8:11], v[132:135]
  ds_read_b64_tr_b16 v[216:217], v242 offset:40960
  ds_read_b64_tr_b16 v[218:219], v242 offset:41984
  s_waitcnt lgkmcnt(10)
  v_mfma_f32_16x16x32_bf16 v[140:143], v[196:199], v[8:11], v[140:143]
  ds_read_b64_tr_b16 v[220:221], v243 offset:40960
  ds_read_b64_tr_b16 v[222:223], v243 offset:41984
  s_waitcnt lgkmcnt(10)
  v_mfma_f32_16x16x32_bf16 v[148:151], v[200:203], v[8:11], v[148:151]
  v_subrev_u32 v236, 65536, v236
  v_subrev_u32 v237, 65536, v237
  v_subrev_u32 v238, 65536, v238
  v_subrev_u32 v239, 65536, v239
  v_subrev_u32 v240, 65536, v240
  v_subrev_u32 v241, 65536, v241
  v_subrev_u32 v242, 65536, v242
  v_subrev_u32 v243, 65536, v243
  ds_read_b64_tr_b16 v[192:193], v236 offset:0
  ds_read_b64_tr_b16 v[194:195], v236 offset:1024
  s_waitcnt lgkmcnt(10)
  v_mfma_f32_16x16x32_bf16 v[156:159], v[204:207], v[8:11], v[156:159]
  ds_read_b64_tr_b16 v[196:197], v237 offset:0
  ds_read_b64_tr_b16 v[198:199], v237 offset:1024
  s_waitcnt lgkmcnt(10)
  s_waitcnt vmcnt(28)
  v_mfma_f32_16x16x32_bf16 v[132:135], v[208:211], v[12:15], v[132:135]
  ds_read_b64_tr_b16 v[200:201], v238 offset:0
  ds_read_b64_tr_b16 v[202:203], v238 offset:1024
  s_waitcnt lgkmcnt(10)
  v_mfma_f32_16x16x32_bf16 v[140:143], v[212:215], v[12:15], v[140:143]
  ds_read_b64_tr_b16 v[204:205], v239 offset:0
  ds_read_b64_tr_b16 v[206:207], v239 offset:1024
  s_waitcnt lgkmcnt(10)
  v_mfma_f32_16x16x32_bf16 v[148:151], v[216:219], v[12:15], v[148:151]
  ds_read_b64_tr_b16 v[208:209], v236 offset:8192
  ds_read_b64_tr_b16 v[210:211], v236 offset:9216
  s_waitcnt lgkmcnt(10)
  v_mfma_f32_16x16x32_bf16 v[156:159], v[220:223], v[12:15], v[156:159]
  ds_read_b64_tr_b16 v[212:213], v237 offset:8192
  ds_read_b64_tr_b16 v[214:215], v237 offset:9216
  s_waitcnt lgkmcnt(10)
  s_waitcnt vmcnt(27)
  v_mfma_f32_16x16x32_bf16 v[132:135], v[192:195], v[16:19], v[132:135]
  ds_read_b64_tr_b16 v[216:217], v238 offset:8192
  ds_read_b64_tr_b16 v[218:219], v238 offset:9216
  s_waitcnt lgkmcnt(10)
  v_mfma_f32_16x16x32_bf16 v[140:143], v[196:199], v[16:19], v[140:143]
  ds_read_b64_tr_b16 v[220:221], v239 offset:8192
  ds_read_b64_tr_b16 v[222:223], v239 offset:9216
  s_waitcnt lgkmcnt(10)
  v_mfma_f32_16x16x32_bf16 v[148:151], v[200:203], v[16:19], v[148:151]
  ds_read_b64_tr_b16 v[192:193], v240 offset:0
  ds_read_b64_tr_b16 v[194:195], v240 offset:1024
  s_waitcnt lgkmcnt(10)
  v_mfma_f32_16x16x32_bf16 v[156:159], v[204:207], v[16:19], v[156:159]
  ds_read_b64_tr_b16 v[196:197], v241 offset:0
  ds_read_b64_tr_b16 v[198:199], v241 offset:1024
  s_waitcnt lgkmcnt(10)
  s_waitcnt vmcnt(26)
  v_mfma_f32_16x16x32_bf16 v[132:135], v[208:211], v[20:23], v[132:135]
  ds_read_b64_tr_b16 v[200:201], v242 offset:0
  ds_read_b64_tr_b16 v[202:203], v242 offset:1024
  s_waitcnt lgkmcnt(10)
  v_mfma_f32_16x16x32_bf16 v[140:143], v[212:215], v[20:23], v[140:143]
  ds_read_b64_tr_b16 v[204:205], v243 offset:0
  ds_read_b64_tr_b16 v[206:207], v243 offset:1024
  s_waitcnt lgkmcnt(10)
  v_mfma_f32_16x16x32_bf16 v[148:151], v[216:219], v[20:23], v[148:151]
  ds_read_b64_tr_b16 v[208:209], v240 offset:8192
  ds_read_b64_tr_b16 v[210:211], v240 offset:9216
  s_waitcnt lgkmcnt(10)
  v_mfma_f32_16x16x32_bf16 v[156:159], v[220:223], v[20:23], v[156:159]
  ds_read_b64_tr_b16 v[212:213], v241 offset:8192
  ds_read_b64_tr_b16 v[214:215], v241 offset:9216
  s_waitcnt lgkmcnt(10)
  s_waitcnt vmcnt(25)
  v_mfma_f32_16x16x32_bf16 v[132:135], v[192:195], v[24:27], v[132:135]
  ds_read_b64_tr_b16 v[216:217], v242 offset:8192
  ds_read_b64_tr_b16 v[218:219], v242 offset:9216
  s_waitcnt lgkmcnt(10)
  v_mfma_f32_16x16x32_bf16 v[140:143], v[196:199], v[24:27], v[140:143]
  ds_read_b64_tr_b16 v[220:221], v243 offset:8192
  ds_read_b64_tr_b16 v[222:223], v243 offset:9216
  s_waitcnt lgkmcnt(10)
  v_mfma_f32_16x16x32_bf16 v[148:151], v[200:203], v[24:27], v[148:151]
  ds_read_b64_tr_b16 v[192:193], v236 offset:16384
  ds_read_b64_tr_b16 v[194:195], v236 offset:17408
  s_waitcnt lgkmcnt(10)
  v_mfma_f32_16x16x32_bf16 v[156:159], v[204:207], v[24:27], v[156:159]
  ds_read_b64_tr_b16 v[196:197], v237 offset:16384
  ds_read_b64_tr_b16 v[198:199], v237 offset:17408
  s_waitcnt lgkmcnt(10)
  s_waitcnt vmcnt(24)
  v_mfma_f32_16x16x32_bf16 v[132:135], v[208:211], v[28:31], v[132:135]
  ds_read_b64_tr_b16 v[200:201], v238 offset:16384
  ds_read_b64_tr_b16 v[202:203], v238 offset:17408
  s_waitcnt lgkmcnt(10)
  v_mfma_f32_16x16x32_bf16 v[140:143], v[212:215], v[28:31], v[140:143]
  ds_read_b64_tr_b16 v[204:205], v239 offset:16384
  ds_read_b64_tr_b16 v[206:207], v239 offset:17408
  s_waitcnt lgkmcnt(10)
  v_mfma_f32_16x16x32_bf16 v[148:151], v[216:219], v[28:31], v[148:151]
  ds_read_b64_tr_b16 v[208:209], v236 offset:24576
  ds_read_b64_tr_b16 v[210:211], v236 offset:25600
  s_waitcnt lgkmcnt(10)
  v_mfma_f32_16x16x32_bf16 v[156:159], v[220:223], v[28:31], v[156:159]
  ds_read_b64_tr_b16 v[212:213], v237 offset:24576
  ds_read_b64_tr_b16 v[214:215], v237 offset:25600
  s_waitcnt lgkmcnt(10)
  s_waitcnt vmcnt(23)
  v_mfma_f32_16x16x32_bf16 v[132:135], v[192:195], v[32:35], v[132:135]
  ds_read_b64_tr_b16 v[216:217], v238 offset:24576
  ds_read_b64_tr_b16 v[218:219], v238 offset:25600
  s_waitcnt lgkmcnt(10)
  v_mfma_f32_16x16x32_bf16 v[140:143], v[196:199], v[32:35], v[140:143]
  ds_read_b64_tr_b16 v[220:221], v239 offset:24576
  ds_read_b64_tr_b16 v[222:223], v239 offset:25600
  s_waitcnt lgkmcnt(10)
  v_mfma_f32_16x16x32_bf16 v[148:151], v[200:203], v[32:35], v[148:151]
  ds_read_b64_tr_b16 v[192:193], v240 offset:16384
  ds_read_b64_tr_b16 v[194:195], v240 offset:17408
  s_waitcnt lgkmcnt(10)
  v_mfma_f32_16x16x32_bf16 v[156:159], v[204:207], v[32:35], v[156:159]
  ds_read_b64_tr_b16 v[196:197], v241 offset:16384
  ds_read_b64_tr_b16 v[198:199], v241 offset:17408
  s_waitcnt lgkmcnt(10)
  s_waitcnt vmcnt(22)
  v_mfma_f32_16x16x32_bf16 v[132:135], v[208:211], v[36:39], v[132:135]
  ds_read_b64_tr_b16 v[200:201], v242 offset:16384
  ds_read_b64_tr_b16 v[202:203], v242 offset:17408
  s_waitcnt lgkmcnt(10)
  v_mfma_f32_16x16x32_bf16 v[140:143], v[212:215], v[36:39], v[140:143]
  ds_read_b64_tr_b16 v[204:205], v243 offset:16384
  ds_read_b64_tr_b16 v[206:207], v243 offset:17408
  s_waitcnt lgkmcnt(10)
  v_mfma_f32_16x16x32_bf16 v[148:151], v[216:219], v[36:39], v[148:151]
  ds_read_b64_tr_b16 v[208:209], v240 offset:24576
  ds_read_b64_tr_b16 v[210:211], v240 offset:25600
  s_waitcnt lgkmcnt(10)
  v_mfma_f32_16x16x32_bf16 v[156:159], v[220:223], v[36:39], v[156:159]
  ds_read_b64_tr_b16 v[212:213], v241 offset:24576
  ds_read_b64_tr_b16 v[214:215], v241 offset:25600
  s_waitcnt lgkmcnt(10)
  s_waitcnt vmcnt(21)
  v_mfma_f32_16x16x32_bf16 v[132:135], v[192:195], v[40:43], v[132:135]
  ds_read_b64_tr_b16 v[216:217], v242 offset:24576
  ds_read_b64_tr_b16 v[218:219], v242 offset:25600
  s_waitcnt lgkmcnt(10)
  v_mfma_f32_16x16x32_bf16 v[140:143], v[196:199], v[40:43], v[140:143]
  ds_read_b64_tr_b16 v[220:221], v243 offset:24576
  ds_read_b64_tr_b16 v[222:223], v243 offset:25600
  s_waitcnt lgkmcnt(10)
  v_mfma_f32_16x16x32_bf16 v[148:151], v[200:203], v[40:43], v[148:151]
  ds_read_b64_tr_b16 v[192:193], v236 offset:32768
  ds_read_b64_tr_b16 v[194:195], v236 offset:33792
  s_waitcnt lgkmcnt(10)
  v_mfma_f32_16x16x32_bf16 v[156:159], v[204:207], v[40:43], v[156:159]
  ds_read_b64_tr_b16 v[196:197], v237 offset:32768
  ds_read_b64_tr_b16 v[198:199], v237 offset:33792
  s_waitcnt lgkmcnt(10)
  s_waitcnt vmcnt(20)
  v_mfma_f32_16x16x32_bf16 v[132:135], v[208:211], v[44:47], v[132:135]
  ds_read_b64_tr_b16 v[200:201], v238 offset:32768
  ds_read_b64_tr_b16 v[202:203], v238 offset:33792
  s_waitcnt lgkmcnt(10)
  v_mfma_f32_16x16x32_bf16 v[140:143], v[212:215], v[44:47], v[140:143]
  ds_read_b64_tr_b16 v[204:205], v239 offset:32768
  ds_read_b64_tr_b16 v[206:207], v239 offset:33792
  s_waitcnt lgkmcnt(10)
  v_mfma_f32_16x16x32_bf16 v[148:151], v[216:219], v[44:47], v[148:151]
  ds_read_b64_tr_b16 v[208:209], v236 offset:40960
  ds_read_b64_tr_b16 v[210:211], v236 offset:41984
  s_waitcnt lgkmcnt(10)
  v_mfma_f32_16x16x32_bf16 v[156:159], v[220:223], v[44:47], v[156:159]
  ds_read_b64_tr_b16 v[212:213], v237 offset:40960
  ds_read_b64_tr_b16 v[214:215], v237 offset:41984
  s_waitcnt lgkmcnt(10)
  s_waitcnt vmcnt(19)
  v_mfma_f32_16x16x32_bf16 v[132:135], v[192:195], v[48:51], v[132:135]
  ds_read_b64_tr_b16 v[216:217], v238 offset:40960
  ds_read_b64_tr_b16 v[218:219], v238 offset:41984
  s_waitcnt lgkmcnt(10)
  v_mfma_f32_16x16x32_bf16 v[140:143], v[196:199], v[48:51], v[140:143]
  ds_read_b64_tr_b16 v[220:221], v239 offset:40960
  ds_read_b64_tr_b16 v[222:223], v239 offset:41984
  s_waitcnt lgkmcnt(10)
  v_mfma_f32_16x16x32_bf16 v[148:151], v[200:203], v[48:51], v[148:151]
  ds_read_b64_tr_b16 v[192:193], v240 offset:32768
  ds_read_b64_tr_b16 v[194:195], v240 offset:33792
  s_waitcnt lgkmcnt(10)
  v_mfma_f32_16x16x32_bf16 v[156:159], v[204:207], v[48:51], v[156:159]
  ds_read_b64_tr_b16 v[196:197], v241 offset:32768
  ds_read_b64_tr_b16 v[198:199], v241 offset:33792
  s_waitcnt lgkmcnt(10)
  s_waitcnt vmcnt(18)
  v_mfma_f32_16x16x32_bf16 v[132:135], v[208:211], v[52:55], v[132:135]
  ds_read_b64_tr_b16 v[200:201], v242 offset:32768
  ds_read_b64_tr_b16 v[202:203], v242 offset:33792
  s_waitcnt lgkmcnt(10)
  v_mfma_f32_16x16x32_bf16 v[140:143], v[212:215], v[52:55], v[140:143]
  ds_read_b64_tr_b16 v[204:205], v243 offset:32768
  ds_read_b64_tr_b16 v[206:207], v243 offset:33792
  s_waitcnt lgkmcnt(10)
  v_mfma_f32_16x16x32_bf16 v[148:151], v[216:219], v[52:55], v[148:151]
  ds_read_b64_tr_b16 v[208:209], v240 offset:40960
  ds_read_b64_tr_b16 v[210:211], v240 offset:41984
  s_waitcnt lgkmcnt(10)
  v_mfma_f32_16x16x32_bf16 v[156:159], v[220:223], v[52:55], v[156:159]
  ds_read_b64_tr_b16 v[212:213], v241 offset:40960
  ds_read_b64_tr_b16 v[214:215], v241 offset:41984
  s_waitcnt lgkmcnt(10)
  s_waitcnt vmcnt(17)
  v_mfma_f32_16x16x32_bf16 v[132:135], v[192:195], v[56:59], v[132:135]
  ds_read_b64_tr_b16 v[216:217], v242 offset:40960
  ds_read_b64_tr_b16 v[218:219], v242 offset:41984
  s_waitcnt lgkmcnt(10)
  v_mfma_f32_16x16x32_bf16 v[140:143], v[196:199], v[56:59], v[140:143]
  ds_read_b64_tr_b16 v[220:221], v243 offset:40960
  ds_read_b64_tr_b16 v[222:223], v243 offset:41984
  s_waitcnt lgkmcnt(10)
  v_mfma_f32_16x16x32_bf16 v[148:151], v[200:203], v[56:59], v[148:151]
  ds_read_b64_tr_b16 v[192:193], v236 offset:49152
  ds_read_b64_tr_b16 v[194:195], v236 offset:50176
  s_waitcnt lgkmcnt(10)
  v_mfma_f32_16x16x32_bf16 v[156:159], v[204:207], v[56:59], v[156:159]
  ds_read_b64_tr_b16 v[196:197], v237 offset:49152
  ds_read_b64_tr_b16 v[198:199], v237 offset:50176
  s_waitcnt lgkmcnt(10)
  s_waitcnt vmcnt(16)
  v_mfma_f32_16x16x32_bf16 v[132:135], v[208:211], v[60:63], v[132:135]
  ds_read_b64_tr_b16 v[200:201], v238 offset:49152
  ds_read_b64_tr_b16 v[202:203], v238 offset:50176
  s_waitcnt lgkmcnt(10)
  v_mfma_f32_16x16x32_bf16 v[140:143], v[212:215], v[60:63], v[140:143]
  ds_read_b64_tr_b16 v[204:205], v239 offset:49152
  ds_read_b64_tr_b16 v[206:207], v239 offset:50176
  s_waitcnt lgkmcnt(10)
  v_mfma_f32_16x16x32_bf16 v[148:151], v[216:219], v[60:63], v[148:151]
  ds_read_b64_tr_b16 v[208:209], v236 offset:57344
  ds_read_b64_tr_b16 v[210:211], v236 offset:58368
  s_waitcnt lgkmcnt(10)
  v_mfma_f32_16x16x32_bf16 v[156:159], v[220:223], v[60:63], v[156:159]
  ds_read_b64_tr_b16 v[212:213], v237 offset:57344
  ds_read_b64_tr_b16 v[214:215], v237 offset:58368
  s_waitcnt lgkmcnt(10)
  s_waitcnt vmcnt(15)
  v_mfma_f32_16x16x32_bf16 v[132:135], v[192:195], v[64:67], v[132:135]
  ds_read_b64_tr_b16 v[216:217], v238 offset:57344
  ds_read_b64_tr_b16 v[218:219], v238 offset:58368
  s_waitcnt lgkmcnt(10)
  v_mfma_f32_16x16x32_bf16 v[140:143], v[196:199], v[64:67], v[140:143]
  ds_read_b64_tr_b16 v[220:221], v239 offset:57344
  ds_read_b64_tr_b16 v[222:223], v239 offset:58368
  s_waitcnt lgkmcnt(10)
  v_mfma_f32_16x16x32_bf16 v[148:151], v[200:203], v[64:67], v[148:151]
  ds_read_b64_tr_b16 v[192:193], v240 offset:49152
  ds_read_b64_tr_b16 v[194:195], v240 offset:50176
  s_waitcnt lgkmcnt(10)
  v_mfma_f32_16x16x32_bf16 v[156:159], v[204:207], v[64:67], v[156:159]
  ds_read_b64_tr_b16 v[196:197], v241 offset:49152
  ds_read_b64_tr_b16 v[198:199], v241 offset:50176
  s_waitcnt lgkmcnt(10)
  s_waitcnt vmcnt(14)
  v_mfma_f32_16x16x32_bf16 v[132:135], v[208:211], v[68:71], v[132:135]
  ds_read_b64_tr_b16 v[200:201], v242 offset:49152
  ds_read_b64_tr_b16 v[202:203], v242 offset:50176
  s_waitcnt lgkmcnt(10)
  v_mfma_f32_16x16x32_bf16 v[140:143], v[212:215], v[68:71], v[140:143]
  ds_read_b64_tr_b16 v[204:205], v243 offset:49152
  ds_read_b64_tr_b16 v[206:207], v243 offset:50176
  s_waitcnt lgkmcnt(10)
  v_mfma_f32_16x16x32_bf16 v[148:151], v[216:219], v[68:71], v[148:151]
  ds_read_b64_tr_b16 v[208:209], v240 offset:57344
  ds_read_b64_tr_b16 v[210:211], v240 offset:58368
  s_waitcnt lgkmcnt(10)
  v_mfma_f32_16x16x32_bf16 v[156:159], v[220:223], v[68:71], v[156:159]
  ds_read_b64_tr_b16 v[212:213], v241 offset:57344
  ds_read_b64_tr_b16 v[214:215], v241 offset:58368
  s_waitcnt lgkmcnt(10)
  s_waitcnt vmcnt(13)
  v_mfma_f32_16x16x32_bf16 v[132:135], v[192:195], v[72:75], v[132:135]
  ds_read_b64_tr_b16 v[216:217], v242 offset:57344
  ds_read_b64_tr_b16 v[218:219], v242 offset:58368
  s_waitcnt lgkmcnt(10)
  v_mfma_f32_16x16x32_bf16 v[140:143], v[196:199], v[72:75], v[140:143]
  ds_read_b64_tr_b16 v[220:221], v243 offset:57344
  ds_read_b64_tr_b16 v[222:223], v243 offset:58368
  s_waitcnt lgkmcnt(10)
  v_mfma_f32_16x16x32_bf16 v[148:151], v[200:203], v[72:75], v[148:151]
  v_add_u32 v236, 131072, v236
  v_add_u32 v237, 131072, v237
  v_add_u32 v238, 131072, v238
  v_add_u32 v239, 131072, v239
  v_add_u32 v240, 131072, v240
  v_add_u32 v241, 131072, v241
  v_add_u32 v242, 131072, v242
  v_add_u32 v243, 131072, v243
  ds_read_b64_tr_b16 v[192:193], v236 offset:16384
  ds_read_b64_tr_b16 v[194:195], v236 offset:17408
  s_waitcnt lgkmcnt(10)
  v_mfma_f32_16x16x32_bf16 v[156:159], v[204:207], v[72:75], v[156:159]
  ds_read_b64_tr_b16 v[196:197], v237 offset:16384
  ds_read_b64_tr_b16 v[198:199], v237 offset:17408
  s_waitcnt lgkmcnt(10)
  s_waitcnt vmcnt(12)
  v_mfma_f32_16x16x32_bf16 v[132:135], v[208:211], v[76:79], v[132:135]
  ds_read_b64_tr_b16 v[200:201], v238 offset:16384
  ds_read_b64_tr_b16 v[202:203], v238 offset:17408
  s_waitcnt lgkmcnt(10)
  v_mfma_f32_16x16x32_bf16 v[140:143], v[212:215], v[76:79], v[140:143]
  ds_read_b64_tr_b16 v[204:205], v239 offset:16384
  ds_read_b64_tr_b16 v[206:207], v239 offset:17408
  s_waitcnt lgkmcnt(10)
  v_mfma_f32_16x16x32_bf16 v[148:151], v[216:219], v[76:79], v[148:151]
  ds_read_b64_tr_b16 v[208:209], v236 offset:24576
  ds_read_b64_tr_b16 v[210:211], v236 offset:25600
  s_waitcnt lgkmcnt(10)
  v_mfma_f32_16x16x32_bf16 v[156:159], v[220:223], v[76:79], v[156:159]
  ds_read_b64_tr_b16 v[212:213], v237 offset:24576
  ds_read_b64_tr_b16 v[214:215], v237 offset:25600
  s_waitcnt lgkmcnt(10)
  s_waitcnt vmcnt(11)
  v_mfma_f32_16x16x32_bf16 v[132:135], v[192:195], v[80:83], v[132:135]
  ds_read_b64_tr_b16 v[216:217], v238 offset:24576
  ds_read_b64_tr_b16 v[218:219], v238 offset:25600
  s_waitcnt lgkmcnt(10)
  v_mfma_f32_16x16x32_bf16 v[140:143], v[196:199], v[80:83], v[140:143]
  ds_read_b64_tr_b16 v[220:221], v239 offset:24576
  ds_read_b64_tr_b16 v[222:223], v239 offset:25600
  s_waitcnt lgkmcnt(10)
  v_mfma_f32_16x16x32_bf16 v[148:151], v[200:203], v[80:83], v[148:151]
  ds_read_b64_tr_b16 v[192:193], v240 offset:16384
  ds_read_b64_tr_b16 v[194:195], v240 offset:17408
  s_waitcnt lgkmcnt(10)
  v_mfma_f32_16x16x32_bf16 v[156:159], v[204:207], v[80:83], v[156:159]
  ds_read_b64_tr_b16 v[196:197], v241 offset:16384
  ds_read_b64_tr_b16 v[198:199], v241 offset:17408
  s_waitcnt lgkmcnt(10)
  s_waitcnt vmcnt(10)
  v_mfma_f32_16x16x32_bf16 v[132:135], v[208:211], v[84:87], v[132:135]
  ds_read_b64_tr_b16 v[200:201], v242 offset:16384
  ds_read_b64_tr_b16 v[202:203], v242 offset:17408
  s_waitcnt lgkmcnt(10)
  v_mfma_f32_16x16x32_bf16 v[140:143], v[212:215], v[84:87], v[140:143]
  ds_read_b64_tr_b16 v[204:205], v243 offset:16384
  ds_read_b64_tr_b16 v[206:207], v243 offset:17408
  s_waitcnt lgkmcnt(10)
  v_mfma_f32_16x16x32_bf16 v[148:151], v[216:219], v[84:87], v[148:151]
  ds_read_b64_tr_b16 v[208:209], v240 offset:24576
  ds_read_b64_tr_b16 v[210:211], v240 offset:25600
  s_waitcnt lgkmcnt(10)
  v_mfma_f32_16x16x32_bf16 v[156:159], v[220:223], v[84:87], v[156:159]
  ds_read_b64_tr_b16 v[212:213], v241 offset:24576
  ds_read_b64_tr_b16 v[214:215], v241 offset:25600
  s_waitcnt lgkmcnt(10)
  s_waitcnt vmcnt(9)
  v_mfma_f32_16x16x32_bf16 v[132:135], v[192:195], v[88:91], v[132:135]
  ds_read_b64_tr_b16 v[216:217], v242 offset:24576
  ds_read_b64_tr_b16 v[218:219], v242 offset:25600
  s_waitcnt lgkmcnt(10)
  v_mfma_f32_16x16x32_bf16 v[140:143], v[196:199], v[88:91], v[140:143]
  ds_read_b64_tr_b16 v[220:221], v243 offset:24576
  ds_read_b64_tr_b16 v[222:223], v243 offset:25600
  s_waitcnt lgkmcnt(10)
  v_mfma_f32_16x16x32_bf16 v[148:151], v[200:203], v[88:91], v[148:151]
  v_subrev_u32 v236, 65536, v236
  v_subrev_u32 v237, 65536, v237
  v_subrev_u32 v238, 65536, v238
  v_subrev_u32 v239, 65536, v239
  v_subrev_u32 v240, 65536, v240
  v_subrev_u32 v241, 65536, v241
  v_subrev_u32 v242, 65536, v242
  v_subrev_u32 v243, 65536, v243
  ds_read_b64_tr_b16 v[192:193], v236 offset:49152
  ds_read_b64_tr_b16 v[194:195], v236 offset:50176
  s_waitcnt lgkmcnt(10)
  v_mfma_f32_16x16x32_bf16 v[156:159], v[204:207], v[88:91], v[156:159]
  ds_read_b64_tr_b16 v[196:197], v237 offset:49152
  ds_read_b64_tr_b16 v[198:199], v237 offset:50176
  s_waitcnt lgkmcnt(10)
  s_waitcnt vmcnt(8)
  v_mfma_f32_16x16x32_bf16 v[132:135], v[208:211], v[92:95], v[132:135]
  ds_read_b64_tr_b16 v[200:201], v238 offset:49152
  ds_read_b64_tr_b16 v[202:203], v238 offset:50176
  s_waitcnt lgkmcnt(10)
  v_mfma_f32_16x16x32_bf16 v[140:143], v[212:215], v[92:95], v[140:143]
  ds_read_b64_tr_b16 v[204:205], v239 offset:49152
  ds_read_b64_tr_b16 v[206:207], v239 offset:50176
  s_waitcnt lgkmcnt(10)
  v_mfma_f32_16x16x32_bf16 v[148:151], v[216:219], v[92:95], v[148:151]
  ds_read_b64_tr_b16 v[208:209], v236 offset:57344
  ds_read_b64_tr_b16 v[210:211], v236 offset:58368
  s_waitcnt lgkmcnt(10)
  v_mfma_f32_16x16x32_bf16 v[156:159], v[220:223], v[92:95], v[156:159]
  ds_read_b64_tr_b16 v[212:213], v237 offset:57344
  ds_read_b64_tr_b16 v[214:215], v237 offset:58368
  s_waitcnt lgkmcnt(10)
  s_waitcnt vmcnt(7)
  v_mfma_f32_16x16x32_bf16 v[132:135], v[192:195], v[96:99], v[132:135]
  ds_read_b64_tr_b16 v[216:217], v238 offset:57344
  ds_read_b64_tr_b16 v[218:219], v238 offset:58368
  s_waitcnt lgkmcnt(10)
  v_mfma_f32_16x16x32_bf16 v[140:143], v[196:199], v[96:99], v[140:143]
  ds_read_b64_tr_b16 v[220:221], v239 offset:57344
  ds_read_b64_tr_b16 v[222:223], v239 offset:58368
  s_waitcnt lgkmcnt(10)
  v_mfma_f32_16x16x32_bf16 v[148:151], v[200:203], v[96:99], v[148:151]
  ds_read_b64_tr_b16 v[192:193], v240 offset:49152
  ds_read_b64_tr_b16 v[194:195], v240 offset:50176
  s_waitcnt lgkmcnt(10)
  v_mfma_f32_16x16x32_bf16 v[156:159], v[204:207], v[96:99], v[156:159]
  ds_read_b64_tr_b16 v[196:197], v241 offset:49152
  ds_read_b64_tr_b16 v[198:199], v241 offset:50176
  s_waitcnt lgkmcnt(10)
  s_waitcnt vmcnt(6)
  v_mfma_f32_16x16x32_bf16 v[132:135], v[208:211], v[100:103], v[132:135]
  ds_read_b64_tr_b16 v[200:201], v242 offset:49152
  ds_read_b64_tr_b16 v[202:203], v242 offset:50176
  s_waitcnt lgkmcnt(10)
  v_mfma_f32_16x16x32_bf16 v[140:143], v[212:215], v[100:103], v[140:143]
  ds_read_b64_tr_b16 v[204:205], v243 offset:49152
  ds_read_b64_tr_b16 v[206:207], v243 offset:50176
  s_waitcnt lgkmcnt(10)
  v_mfma_f32_16x16x32_bf16 v[148:151], v[216:219], v[100:103], v[148:151]
  ds_read_b64_tr_b16 v[208:209], v240 offset:57344
  ds_read_b64_tr_b16 v[210:211], v240 offset:58368
  s_waitcnt lgkmcnt(10)
  v_mfma_f32_16x16x32_bf16 v[156:159], v[220:223], v[100:103], v[156:159]
  ds_read_b64_tr_b16 v[212:213], v241 offset:57344
  ds_read_b64_tr_b16 v[214:215], v241 offset:58368
  s_waitcnt lgkmcnt(10)
  s_waitcnt vmcnt(5)
  v_mfma_f32_16x16x32_bf16 v[132:135], v[192:195], v[104:107], v[132:135]
  ds_read_b64_tr_b16 v[216:217], v242 offset:57344
  ds_read_b64_tr_b16 v[218:219], v242 offset:58368
  s_waitcnt lgkmcnt(10)
  v_mfma_f32_16x16x32_bf16 v[140:143], v[196:199], v[104:107], v[140:143]
  ds_read_b64_tr_b16 v[220:221], v243 offset:57344
  ds_read_b64_tr_b16 v[222:223], v243 offset:58368
  s_waitcnt lgkmcnt(10)
  v_mfma_f32_16x16x32_bf16 v[148:151], v[200:203], v[104:107], v[148:151]
  v_add_u32 v236, 65536, v236
  v_add_u32 v237, 65536, v237
  v_add_u32 v238, 65536, v238
  v_add_u32 v239, 65536, v239
  v_add_u32 v240, 65536, v240
  v_add_u32 v241, 65536, v241
  v_add_u32 v242, 65536, v242
  v_add_u32 v243, 65536, v243
  ds_read_b64_tr_b16 v[192:193], v236 offset:0
  ds_read_b64_tr_b16 v[194:195], v236 offset:1024
  s_waitcnt lgkmcnt(10)
  v_mfma_f32_16x16x32_bf16 v[156:159], v[204:207], v[104:107], v[156:159]
  ds_read_b64_tr_b16 v[196:197], v237 offset:0
  ds_read_b64_tr_b16 v[198:199], v237 offset:1024
  s_waitcnt lgkmcnt(10)
  s_waitcnt vmcnt(4)
  v_mfma_f32_16x16x32_bf16 v[132:135], v[208:211], v[108:111], v[132:135]
  ds_read_b64_tr_b16 v[200:201], v238 offset:0
  ds_read_b64_tr_b16 v[202:203], v238 offset:1024
  s_waitcnt lgkmcnt(10)
  v_mfma_f32_16x16x32_bf16 v[140:143], v[212:215], v[108:111], v[140:143]
  ds_read_b64_tr_b16 v[204:205], v239 offset:0
  ds_read_b64_tr_b16 v[206:207], v239 offset:1024
  s_waitcnt lgkmcnt(10)
  v_mfma_f32_16x16x32_bf16 v[148:151], v[216:219], v[108:111], v[148:151]
  ds_read_b64_tr_b16 v[208:209], v236 offset:8192
  ds_read_b64_tr_b16 v[210:211], v236 offset:9216
  s_waitcnt lgkmcnt(10)
  v_mfma_f32_16x16x32_bf16 v[156:159], v[220:223], v[108:111], v[156:159]
  ds_read_b64_tr_b16 v[212:213], v237 offset:8192
  ds_read_b64_tr_b16 v[214:215], v237 offset:9216
  s_waitcnt lgkmcnt(10)
  s_waitcnt vmcnt(3)
  v_mfma_f32_16x16x32_bf16 v[132:135], v[192:195], v[112:115], v[132:135]
  ds_read_b64_tr_b16 v[216:217], v238 offset:8192
  ds_read_b64_tr_b16 v[218:219], v238 offset:9216
  s_waitcnt lgkmcnt(10)
  v_mfma_f32_16x16x32_bf16 v[140:143], v[196:199], v[112:115], v[140:143]
  ds_read_b64_tr_b16 v[220:221], v239 offset:8192
  ds_read_b64_tr_b16 v[222:223], v239 offset:9216
  s_waitcnt lgkmcnt(10)
  v_mfma_f32_16x16x32_bf16 v[148:151], v[200:203], v[112:115], v[148:151]
  ds_read_b64_tr_b16 v[192:193], v240 offset:0
  ds_read_b64_tr_b16 v[194:195], v240 offset:1024
  s_waitcnt lgkmcnt(10)
  v_mfma_f32_16x16x32_bf16 v[156:159], v[204:207], v[112:115], v[156:159]
  ds_read_b64_tr_b16 v[196:197], v241 offset:0
  ds_read_b64_tr_b16 v[198:199], v241 offset:1024
  s_waitcnt lgkmcnt(10)
  s_waitcnt vmcnt(2)
  v_mfma_f32_16x16x32_bf16 v[132:135], v[208:211], v[116:119], v[132:135]
  ds_read_b64_tr_b16 v[200:201], v242 offset:0
  ds_read_b64_tr_b16 v[202:203], v242 offset:1024
  s_waitcnt lgkmcnt(10)
  v_mfma_f32_16x16x32_bf16 v[140:143], v[212:215], v[116:119], v[140:143]
  ds_read_b64_tr_b16 v[204:205], v243 offset:0
  ds_read_b64_tr_b16 v[206:207], v243 offset:1024
  s_waitcnt lgkmcnt(10)
  v_mfma_f32_16x16x32_bf16 v[148:151], v[216:219], v[116:119], v[148:151]
  ds_read_b64_tr_b16 v[208:209], v240 offset:8192
  ds_read_b64_tr_b16 v[210:211], v240 offset:9216
  s_waitcnt lgkmcnt(10)
  v_mfma_f32_16x16x32_bf16 v[156:159], v[220:223], v[116:119], v[156:159]
  ds_read_b64_tr_b16 v[212:213], v241 offset:8192
  ds_read_b64_tr_b16 v[214:215], v241 offset:9216
  s_waitcnt lgkmcnt(10)
  s_waitcnt vmcnt(1)
  v_mfma_f32_16x16x32_bf16 v[132:135], v[192:195], v[120:123], v[132:135]
  ds_read_b64_tr_b16 v[216:217], v242 offset:8192
  ds_read_b64_tr_b16 v[218:219], v242 offset:9216
  s_waitcnt lgkmcnt(10)
  v_mfma_f32_16x16x32_bf16 v[140:143], v[196:199], v[120:123], v[140:143]
  ds_read_b64_tr_b16 v[220:221], v243 offset:8192
  ds_read_b64_tr_b16 v[222:223], v243 offset:9216
  s_waitcnt lgkmcnt(10)
  v_mfma_f32_16x16x32_bf16 v[148:151], v[200:203], v[120:123], v[148:151]
  s_waitcnt lgkmcnt(8)
  v_mfma_f32_16x16x32_bf16 v[156:159], v[204:207], v[120:123], v[156:159]
  s_waitcnt lgkmcnt(6)
  s_waitcnt vmcnt(0)
  v_mfma_f32_16x16x32_bf16 v[132:135], v[208:211], v[124:127], v[132:135]
  s_waitcnt lgkmcnt(4)
  v_mfma_f32_16x16x32_bf16 v[140:143], v[212:215], v[124:127], v[140:143]
  s_waitcnt lgkmcnt(2)
  v_mfma_f32_16x16x32_bf16 v[148:151], v[216:219], v[124:127], v[148:151]
  s_waitcnt lgkmcnt(0)
  v_mfma_f32_16x16x32_bf16 v[156:159], v[220:223], v[124:127], v[156:159]
  s_add_u32 s38, s55, 0
  s_nop 0
  buffer_store_dwordx4 v[132:135], v248, s[84:87], s38 offen offset:0 sc1
  s_nop 0
  buffer_store_dwordx4 v[140:143], v248, s[84:87], s38 offen offset:1024 sc1
  s_add_u32 s38, s55, 57344
  buffer_store_dwordx4 v[148:151], v248, s[84:87], s38 offen offset:0 sc1
  s_nop 0
  buffer_store_dwordx4 v[156:159], v248, s[84:87], s38 offen offset:1024 sc1
  s_waitcnt vmcnt(0) lgkmcnt(0)
  s_nop 7
  s_cmp_lg_u32 s54, 0
  s_mov_b32 s54, 3670016
  s_mov_b32 s55, 3670016
  s_cbranch_scc0 L_gen_item
  v_mov_b32 v244, s10
  s_mov_b64 exec, 1
  buffer_atomic_or v244, off, s[20:23], 0 offset:0 sc0 sc1
  s_mov_b64 exec, -1
  v_mov_b32 v245, s10
  s_mov_b64 exec, 1
  buffer_atomic_or v245, off, s[20:23], 0 offset:128 sc0 sc1
  s_mov_b64 exec, -1
  s_mov_b32 s38, 0
  buffer_load_dwordx4 v[132:135], v248, s[84:87], s38 offen offset:0 sc1
  buffer_load_dwordx4 v[140:143], v248, s[84:87], s38 offen offset:1024 sc1
  s_mov_b32 s38, 57344
  buffer_load_dwordx4 v[148:151], v248, s[84:87], s38 offen offset:0 sc1
  buffer_load_dwordx4 v[156:159], v248, s[84:87], s38 offen offset:1024 sc1
  s_mov_b32 s38, 3670016
  buffer_load_dwordx4 v[164:167], v248, s[84:87], s38 offen offset:0 sc1
  buffer_load_dwordx4 v[172:175], v248, s[84:87], s38 offen offset:1024 sc1
  s_mov_b32 s38, 3727360
  buffer_load_dwordx4 v[180:183], v248, s[84:87], s38 offen offset:0 sc1
  buffer_load_dwordx4 v[188:191], v248, s[84:87], s38 offen offset:1024 sc1
  v_and_b32 v251, 0xf0, v248
  v_lshlrev_b32 v251, 7, v251
  v_bfe_u32 v250, v248, 8, 2
  v_lshl_or_b32 v251, v250, 4, v251
  s_waitcnt vmcnt(0)
  v_readfirstlane_b32 s98, v244
  s_nop 0
  s_or_b32 s98, s98, s10
  s_and_b32 s98, s98, 15
  s_cmp_eq_u32 s98, 15
  s_cbranch_scc0 L_x125
L_x126:
  s_add_u32 s38, s6, 0
  buffer_load_dwordx4 v[64:67], v248, s[28:31], s38 offen offset:0 sc1
  buffer_load_dwordx4 v[72:75], v248, s[28:31], s38 offen offset:1024 sc1
  s_add_u32 s38, s6, 57344
  buffer_load_dwordx4 v[80:83], v248, s[28:31], s38 offen offset:0 sc1
  buffer_load_dwordx4 v[88:91], v248, s[28:31], s38 offen offset:1024 sc1
  s_add_u32 s38, s7, 0
  buffer_load_dwordx4 v[96:99], v248, s[28:31], s38 offen offset:0 sc1
  buffer_load_dwordx4 v[104:107], v248, s[28:31], s38 offen offset:1024 sc1
  s_add_u32 s38, s7, 57344
  buffer_load_dwordx4 v[112:115], v248, s[28:31], s38 offen offset:0 sc1
  buffer_load_dwordx4 v[120:123], v248, s[28:31], s38 offen offset:1024 sc1
  s_add_u32 s38, s8, 0
  buffer_load_dwordx4 v[4:7], v248, s[28:31], s38 offen offset:0 sc1
  buffer_load_dwordx4 v[12:15], v248, s[28:31], s38 offen offset:1024 sc1
  s_add_u32 s38, s8, 57344
  buffer_load_dwordx4 v[20:23], v248, s[28:31], s38 offen offset:0 sc1
  buffer_load_dwordx4 v[28:31], v248, s[28:31], s38 offen offset:1024 sc1
L_x127:
  s_waitcnt vmcnt(0)
L_x128:
  v_pk_add_f32 v[132:133], v[132:133], v[64:65]
  v_pk_add_f32 v[134:135], v[134:135], v[66:67]
  v_pk_add_f32 v[140:141], v[140:141], v[72:73]
  v_pk_add_f32 v[142:143], v[142:143], v[74:75]
  v_pk_add_f32 v[148:149], v[148:149], v[80:81]
  v_pk_add_f32 v[150:151], v[150:151], v[82:83]
  v_pk_add_f32 v[156:157], v[156:157], v[88:89]
  v_pk_add_f32 v[158:159], v[158:159], v[90:91]
  v_pk_add_f32 v[132:133], v[132:133], v[96:97]
  v_pk_add_f32 v[134:135], v[134:135], v[98:99]
  v_pk_add_f32 v[140:141], v[140:141], v[104:105]
  v_pk_add_f32 v[142:143], v[142:143], v[106:107]
  v_pk_add_f32 v[148:149], v[148:149], v[112:113]
  v_pk_add_f32 v[150:151], v[150:151], v[114:115]
  v_pk_add_f32 v[156:157], v[156:157], v[120:121]
  v_pk_add_f32 v[158:159], v[158:159], v[122:123]
  v_pk_add_f32 v[132:133], v[132:133], v[4:5]
  v_pk_add_f32 v[134:135], v[134:135], v[6:7]
  v_pk_add_f32 v[140:141], v[140:141], v[12:13]
  v_pk_add_f32 v[142:143], v[142:143], v[14:15]
  v_pk_add_f32 v[148:149], v[148:149], v[20:21]
  v_pk_add_f32 v[150:151], v[150:151], v[22:23]
  v_pk_add_f32 v[156:157], v[156:157], v[28:29]
  v_pk_add_f32 v[158:159], v[158:159], v[30:31]
  v_cvt_pk_bf16_f32 v132, v132, v133
  v_cvt_pk_bf16_f32 v133, v134, v135
  v_cvt_pk_bf16_f32 v134, v140, v141
  v_cvt_pk_bf16_f32 v135, v142, v143
  v_cndmask_b32_e64 v192, v132, v134, s[42:43]
  v_cndmask_b32_e64 v193, v133, v135, s[42:43]
  v_cndmask_b32_e64 v194, v134, v132, s[42:43]
  v_cndmask_b32_e64 v195, v135, v133, s[42:43]
  buffer_store_dwordx4 v[192:195], v251, s[24:27], 0 offen offset:0
  v_cvt_pk_bf16_f32 v148, v148, v149
  v_cvt_pk_bf16_f32 v149, v150, v151
  v_cvt_pk_bf16_f32 v150, v156, v157
  v_cvt_pk_bf16_f32 v151, v158, v159
  v_cndmask_b32_e64 v196, v148, v150, s[42:43]
  v_cndmask_b32_e64 v197, v149, v151, s[42:43]
  v_cndmask_b32_e64 v198, v150, v148, s[42:43]
  v_cndmask_b32_e64 v199, v151, v149, s[42:43]
  buffer_store_dwordx4 v[196:199], v251, s[24:27], 0 offen offset:64
L_x125:
  s_waitcnt vmcnt(0)
  v_readfirstlane_b32 s98, v245
  s_nop 0
  s_or_b32 s98, s98, s10
  s_and_b32 s98, s98, 15
  s_cmp_eq_u32 s98, 15
  s_cbranch_scc0 L_x132
L_x133:
  s_add_u32 s38, s6, 3670016
  buffer_load_dwordx4 v[64:67], v248, s[28:31], s38 offen offset:0 sc1
  buffer_load_dwordx4 v[72:75], v248, s[28:31], s38 offen offset:1024 sc1
  s_add_u32 s38, s6, 3727360
  buffer_load_dwordx4 v[80:83], v248, s[28:31], s38 offen offset:0 sc1
  buffer_load_dwordx4 v[88:91], v248, s[28:31], s38 offen offset:1024 sc1
  s_add_u32 s38, s7, 3670016
  buffer_load_dwordx4 v[96:99], v248, s[28:31], s38 offen offset:0 sc1
  buffer_load_dwordx4 v[104:107], v248, s[28:31], s38 offen offset:1024 sc1
  s_add_u32 s38, s7, 3727360
  buffer_load_dwordx4 v[112:115], v248, s[28:31], s38 offen offset:0 sc1
  buffer_load_dwordx4 v[120:123], v248, s[28:31], s38 offen offset:1024 sc1
  s_add_u32 s38, s8, 3670016
  buffer_load_dwordx4 v[4:7], v248, s[28:31], s38 offen offset:0 sc1
  buffer_load_dwordx4 v[12:15], v248, s[28:31], s38 offen offset:1024 sc1
  s_add_u32 s38, s8, 3727360
  buffer_load_dwordx4 v[20:23], v248, s[28:31], s38 offen offset:0 sc1
  buffer_load_dwordx4 v[28:31], v248, s[28:31], s38 offen offset:1024 sc1
L_x134:
  s_waitcnt vmcnt(0)
L_x135:
  v_pk_add_f32 v[164:165], v[164:165], v[64:65]
  v_pk_add_f32 v[166:167], v[166:167], v[66:67]
  v_pk_add_f32 v[172:173], v[172:173], v[72:73]
  v_pk_add_f32 v[174:175], v[174:175], v[74:75]
  v_pk_add_f32 v[180:181], v[180:181], v[80:81]
  v_pk_add_f32 v[182:183], v[182:183], v[82:83]
  v_pk_add_f32 v[188:189], v[188:189], v[88:89]
  v_pk_add_f32 v[190:191], v[190:191], v[90:91]
  v_pk_add_f32 v[164:165], v[164:165], v[96:97]
  v_pk_add_f32 v[166:167], v[166:167], v[98:99]
  v_pk_add_f32 v[172:173], v[172:173], v[104:105]
  v_pk_add_f32 v[174:175], v[174:175], v[106:107]
  v_pk_add_f32 v[180:181], v[180:181], v[112:113]
  v_pk_add_f32 v[182:183], v[182:183], v[114:115]
  v_pk_add_f32 v[188:189], v[188:189], v[120:121]
  v_pk_add_f32 v[190:191], v[190:191], v[122:123]
  v_pk_add_f32 v[164:165], v[164:165], v[4:5]
  v_pk_add_f32 v[166:167], v[166:167], v[6:7]
  v_pk_add_f32 v[172:173], v[172:173], v[12:13]
  v_pk_add_f32 v[174:175], v[174:175], v[14:15]
  v_pk_add_f32 v[180:181], v[180:181], v[20:21]
  v_pk_add_f32 v[182:183], v[182:183], v[22:23]
  v_pk_add_f32 v[188:189], v[188:189], v[28:29]
  v_pk_add_f32 v[190:191], v[190:191], v[30:31]
  s_mov_b32 s38, 917504
  v_cvt_pk_bf16_f32 v164, v164, v165
  v_cvt_pk_bf16_f32 v165, v166, v167
  v_cvt_pk_bf16_f32 v166, v172, v173
  v_cvt_pk_bf16_f32 v167, v174, v175
  v_cndmask_b32_e64 v200, v164, v166, s[42:43]
  v_cndmask_b32_e64 v201, v165, v167, s[42:43]
  v_cndmask_b32_e64 v202, v166, v164, s[42:43]
  v_cndmask_b32_e64 v203, v167, v165, s[42:43]
  buffer_store_dwordx4 v[200:203], v251, s[24:27], s38 offen offset:0
  v_cvt_pk_bf16_f32 v180, v180, v181
  v_cvt_pk_bf16_f32 v181, v182, v183
  v_cvt_pk_bf16_f32 v182, v188, v189
  v_cvt_pk_bf16_f32 v183, v190, v191
  v_cndmask_b32_e64 v204, v180, v182, s[42:43]
  v_cndmask_b32_e64 v205, v181, v183, s[42:43]
  v_cndmask_b32_e64 v206, v182, v180, s[42:43]
  v_cndmask_b32_e64 v207, v183, v181, s[42:43]
  buffer_store_dwordx4 v[204:207], v251, s[24:27], s38 offen offset:64
L_x132:
  s_waitcnt vmcnt(0)
  s_barrier
  s_branch L_gen_loop
L_gen_ld:
  s_lshl_b32 s63, s88, 5
  s_mov_b32 m0, 98304
  s_add_u32 s38, s63, 0
  buffer_load_dwordx4 v236, s[76:79], s38 offen offset:0 lds
  buffer_load_dwordx4 v237, s[76:79], s38 offen offset:1024 lds
  buffer_load_dwordx4 v238, s[76:79], s38 offen offset:2048 lds
  buffer_load_dwordx4 v239, s[76:79], s38 offen offset:3072 lds
  s_mov_b32 m0, 102400
  s_add_u32 s38, s63, 16384
  buffer_load_dwordx4 v236, s[76:79], s38 offen offset:0 lds
  buffer_load_dwordx4 v237, s[76:79], s38 offen offset:1024 lds
  buffer_load_dwordx4 v238, s[76:79], s38 offen offset:2048 lds
  buffer_load_dwordx4 v239, s[76:79], s38 offen offset:3072 lds
  s_mov_b32 m0, 106496
  s_add_u32 s38, s63, 32768
  buffer_load_dwordx4 v236, s[76:79], s38 offen offset:0 lds
  buffer_load_dwordx4 v237, s[76:79], s38 offen offset:1024 lds
  buffer_load_dwordx4 v238, s[76:79], s38 offen offset:2048 lds
  buffer_load_dwordx4 v239, s[76:79], s38 offen offset:3072 lds
  s_mov_b32 m0, 110592
  s_add_u32 s38, s63, 49152
  buffer_load_dwordx4 v236, s[76:79], s38 offen offset:0 lds
  buffer_load_dwordx4 v237, s[76:79], s38 offen offset:1024 lds
  buffer_load_dwordx4 v238, s[76:79], s38 offen offset:2048 lds
  buffer_load_dwordx4 v239, s[76:79], s38 offen offset:3072 lds
  s_lshl_b32 s63, s89, 5
  s_mov_b32 m0, 0
  s_add_u32 s38, s63, 0
  buffer_load_dwordx4 v236, s[76:79], s38 offen offset:0 lds
  buffer_load_dwordx4 v237, s[76:79], s38 offen offset:1024 lds
  buffer_load_dwordx4 v238, s[76:79], s38 offen offset:2048 lds
  buffer_load_dwordx4 v239, s[76:79], s38 offen offset:3072 lds
  s_mov_b32 m0, 4096
  s_add_u32 s38, s63, 16384
  buffer_load_dwordx4 v236, s[76:79], s38 offen offset:0 lds
  buffer_load_dwordx4 v237, s[76:79], s38 offen offset:1024 lds
  buffer_load_dwordx4 v238, s[76:79], s38 offen offset:2048 lds
  buffer_load_dwordx4 v239, s[76:79], s38 offen offset:3072 lds
  s_mov_b32 m0, 8192
  s_add_u32 s38, s63, 32768
  buffer_load_dwordx4 v236, s[76:79], s38 offen offset:0 lds
  buffer_load_dwordx4 v237, s[76:79], s38 offen offset:1024 lds
  buffer_load_dwordx4 v238, s[76:79], s38 offen offset:2048 lds
  buffer_load_dwordx4 v239, s[76:79], s38 offen offset:3072 lds
  s_mov_b32 m0, 12288
  s_add_u32 s38, s63, 49152
  buffer_load_dwordx4 v236, s[76:79], s38 offen offset:0 lds
  buffer_load_dwordx4 v237, s[76:79], s38 offen offset:1024 lds
  buffer_load_dwordx4 v238, s[76:79], s38 offen offset:2048 lds
  buffer_load_dwordx4 v239, s[76:79], s38 offen offset:3072 lds
  s_lshl_b32 s63, s90, 5
  s_mov_b32 m0, 16384
  s_add_u32 s38, s63, 0
  buffer_load_dwordx4 v236, s[76:79], s38 offen offset:0 lds
  buffer_load_dwordx4 v237, s[76:79], s38 offen offset:1024 lds
  buffer_load_dwordx4 v238, s[76:79], s38 offen offset:2048 lds
  buffer_load_dwordx4 v239, s[76:79], s38 offen offset:3072 lds
  s_mov_b32 m0, 20480
  s_add_u32 s38, s63, 16384
  buffer_load_dwordx4 v236, s[76:79], s38 offen offset:0 lds
  buffer_load_dwordx4 v237, s[76:79], s38 offen offset:1024 lds
  buffer_load_dwordx4 v238, s[76:79], s38 offen offset:2048 lds
  buffer_load_dwordx4 v239, s[76:79], s38 offen offset:3072 lds
  s_mov_b32 m0, 24576
  s_add_u32 s38, s63, 32768
  buffer_load_dwordx4 v236, s[76:79], s38 offen offset:0 lds
  buffer_load_dwordx4 v237, s[76:79], s38 offen offset:1024 lds
  buffer_load_dwordx4 v238, s[76:79], s38 offen offset:2048 lds
  buffer_load_dwordx4 v239, s[76:79], s38 offen offset:3072 lds
  s_mov_b32 m0, 28672
  s_add_u32 s38, s63, 49152
  buffer_load_dwordx4 v236, s[76:79], s38 offen offset:0 lds
  buffer_load_dwordx4 v237, s[76:79], s38 offen offset:1024 lds
  buffer_load_dwordx4 v238, s[76:79], s38 offen offset:2048 lds
  buffer_load_dwordx4 v239, s[76:79], s38 offen offset:3072 lds
  s_lshl_b32 s63, s91, 5
  s_mov_b32 m0, 32768
  s_add_u32 s38, s63, 0
  buffer_load_dwordx4 v236, s[76:79], s38 offen offset:0 lds
  buffer_load_dwordx4 v237, s[76:79], s38 offen offset:1024 lds
  buffer_load_dwordx4 v238, s[76:79], s38 offen offset:2048 lds
  buffer_load_dwordx4 v239, s[76:79], s38 offen offset:3072 lds
  s_mov_b32 m0, 36864
  s_add_u32 s38, s63, 16384
  buffer_load_dwordx4 v236, s[76:79], s38 offen offset:0 lds
  buffer_load_dwordx4 v237, s[76:79], s38 offen offset:1024 lds
  buffer_load_dwordx4 v238, s[76:79], s38 offen offset:2048 lds
  buffer_load_dwordx4 v239, s[76:79], s38 offen offset:3072 lds
  s_mov_b32 m0, 40960
  s_add_u32 s38, s63, 32768
  buffer_load_dwordx4 v236, s[76:79], s38 offen offset:0 lds
  buffer_load_dwordx4 v237, s[76:79], s38 offen offset:1024 lds
  buffer_load_dwordx4 v238, s[76:79], s38 offen offset:2048 lds
  buffer_load_dwordx4 v239, s[76:79], s38 offen offset:3072 lds
  s_mov_b32 m0, 45056
  s_add_u32 s38, s63, 49152
  buffer_load_dwordx4 v236, s[76:79], s38 offen offset:0 lds
  buffer_load_dwordx4 v237, s[76:79], s38 offen offset:1024 lds
  buffer_load_dwordx4 v238, s[76:79], s38 offen offset:2048 lds
  buffer_load_dwordx4 v239, s[76:79], s38 offen offset:3072 lds
  s_lshl_b32 s63, s92, 5
  s_mov_b32 m0, 49152
  s_add_u32 s38, s63, 0
  buffer_load_dwordx4 v236, s[76:79], s38 offen offset:0 lds
  buffer_load_dwordx4 v237, s[76:79], s38 offen offset:1024 lds
  buffer_load_dwordx4 v238, s[76:79], s38 offen offset:2048 lds
  buffer_load_dwordx4 v239, s[76:79], s38 offen offset:3072 lds
  s_mov_b32 m0, 53248
  s_add_u32 s38, s63, 16384
  buffer_load_dwordx4 v236, s[76:79], s38 offen offset:0 lds
  buffer_load_dwordx4 v237, s[76:79], s38 offen offset:1024 lds
  buffer_load_dwordx4 v238, s[76:79], s38 offen offset:2048 lds
  buffer_load_dwordx4 v239, s[76:79], s38 offen offset:3072 lds
  s_mov_b32 m0, 57344
  s_add_u32 s38, s63, 32768
  buffer_load_dwordx4 v236, s[76:79], s38 offen offset:0 lds
  buffer_load_dwordx4 v237, s[76:79], s38 offen offset:1024 lds
  buffer_load_dwordx4 v238, s[76:79], s38 offen offset:2048 lds
  buffer_load_dwordx4 v239, s[76:79], s38 offen offset:3072 lds
  s_mov_b32 m0, 61440
  s_add_u32 s38, s63, 49152
  buffer_load_dwordx4 v236, s[76:79], s38 offen offset:0 lds
  buffer_load_dwordx4 v237, s[76:79], s38 offen offset:1024 lds
  buffer_load_dwordx4 v238, s[76:79], s38 offen offset:2048 lds
  buffer_load_dwordx4 v239, s[76:79], s38 offen offset:3072 lds
  s_lshl_b32 s63, s93, 5
  s_mov_b32 m0, 147456
  s_add_u32 s38, s63, 0
  buffer_load_dwordx4 v236, s[76:79], s38 offen offset:0 lds
  buffer_load_dwordx4 v237, s[76:79], s38 offen offset:1024 lds
  buffer_load_dwordx4 v238, s[76:79], s38 offen offset:2048 lds
  buffer_load_dwordx4 v239, s[76:79], s38 offen offset:3072 lds
  s_mov_b32 m0, 151552
  s_add_u32 s38, s63, 16384
  buffer_load_dwordx4 v236, s[76:79], s38 offen offset:0 lds
  buffer_load_dwordx4 v237, s[76:79], s38 offen offset:1024 lds
  buffer_load_dwordx4 v238, s[76:79], s38 offen offset:2048 lds
  buffer_load_dwordx4 v239, s[76:79], s38 offen offset:3072 lds
  s_mov_b32 m0, 155648
  s_add_u32 s38, s63, 32768
  buffer_load_dwordx4 v236, s[76:79], s38 offen offset:0 lds
  buffer_load_dwordx4 v237, s[76:79], s38 offen offset:1024 lds
  buffer_load_dwordx4 v238, s[76:79], s38 offen offset:2048 lds
  buffer_load_dwordx4 v239, s[76:79], s38 offen offset:3072 lds
  s_mov_b32 m0, 159744
  s_add_u32 s38, s63, 49152
  buffer_load_dwordx4 v236, s[76:79], s38 offen offset:0 lds
  buffer_load_dwordx4 v237, s[76:79], s38 offen offset:1024 lds
  buffer_load_dwordx4 v238, s[76:79], s38 offen offset:2048 lds
  buffer_load_dwordx4 v239, s[76:79], s38 offen offset:3072 lds
  s_lshl_b32 s63, s94, 5
  s_mov_b32 m0, 114688
  s_add_u32 s38, s63, 0
  buffer_load_dwordx4 v236, s[76:79], s38 offen offset:0 lds
  buffer_load_dwordx4 v237, s[76:79], s38 offen offset:1024 lds
  buffer_load_dwordx4 v238, s[76:79], s38 offen offset:2048 lds
  buffer_load_dwordx4 v239, s[76:79], s38 offen offset:3072 lds
  s_mov_b32 m0, 118784
  s_add_u32 s38, s63, 16384
  buffer_load_dwordx4 v236, s[76:79], s38 offen offset:0 lds
  buffer_load_dwordx4 v237, s[76:79], s38 offen offset:1024 lds
  buffer_load_dwordx4 v238, s[76:79], s38 offen offset:2048 lds
  buffer_load_dwordx4 v239, s[76:79], s38 offen offset:3072 lds
  s_mov_b32 m0, 122880
  s_add_u32 s38, s63, 32768
  buffer_load_dwordx4 v236, s[76:79], s38 offen offset:0 lds
  buffer_load_dwordx4 v237, s[76:79], s38 offen offset:1024 lds
  buffer_load_dwordx4 v238, s[76:79], s38 offen offset:2048 lds
  buffer_load_dwordx4 v239, s[76:79], s38 offen offset:3072 lds
  s_mov_b32 m0, 126976
  s_add_u32 s38, s63, 49152
  buffer_load_dwordx4 v236, s[76:79], s38 offen offset:0 lds
  buffer_load_dwordx4 v237, s[76:79], s38 offen offset:1024 lds
  buffer_load_dwordx4 v238, s[76:79], s38 offen offset:2048 lds
  buffer_load_dwordx4 v239, s[76:79], s38 offen offset:3072 lds
  s_lshl_b32 s63, s95, 5
  s_mov_b32 m0, 131072
  s_add_u32 s38, s63, 0
  buffer_load_dwordx4 v236, s[76:79], s38 offen offset:0 lds
  buffer_load_dwordx4 v237, s[76:79], s38 offen offset:1024 lds
  buffer_load_dwordx4 v238, s[76:79], s38 offen offset:2048 lds
  buffer_load_dwordx4 v239, s[76:79], s38 offen offset:3072 lds
  s_mov_b32 m0, 135168
  s_add_u32 s38, s63, 16384
  buffer_load_dwordx4 v236, s[76:79], s38 offen offset:0 lds
  buffer_load_dwordx4 v237, s[76:79], s38 offen offset:1024 lds
  buffer_load_dwordx4 v238, s[76:79], s38 offen offset:2048 lds
  buffer_load_dwordx4 v239, s[76:79], s38 offen offset:3072 lds
  s_mov_b32 m0, 139264
  s_add_u32 s38, s63, 32768
  buffer_load_dwordx4 v236, s[76:79], s38 offen offset:0 lds
  buffer_load_dwordx4 v237, s[76:79], s38 offen offset:1024 lds
  buffer_load_dwordx4 v238, s[76:79], s38 offen offset:2048 lds
  buffer_load_dwordx4 v239, s[76:79], s38 offen offset:3072 lds
  s_mov_b32 m0, 143360
  s_add_u32 s38, s63, 49152
  buffer_load_dwordx4 v236, s[76:79], s38 offen offset:0 lds
  buffer_load_dwordx4 v237, s[76:79], s38 offen offset:1024 lds
  buffer_load_dwordx4 v238, s[76:79], s38 offen offset:2048 lds
  buffer_load_dwordx4 v239, s[76:79], s38 offen offset:3072 lds
  s_waitcnt vmcnt(0)
  s_barrier
  s_barrier
  s_branch L_gen_loop
L_k1_loader:
  v_xor_b32 v8, 0, v7
  v_xor_b32 v8, v8, v4
  v_lshlrev_b32 v8, 4, v8
  v_lshl_add_u32 v8, v3, 13, v8
  v_add_u32 v224, 0, v8
  v_xor_b32 v8, 0, v7
  v_xor_b32 v8, v8, v4
  v_lshlrev_b32 v8, 4, v8
  v_lshl_add_u32 v8, v3, 13, v8
  v_add_u32 v225, 31744, v8
  v_xor_b32 v8, 8, v7
  v_xor_b32 v8, v8, v4
  v_lshlrev_b32 v8, 4, v8
  v_lshl_add_u32 v8, v3, 13, v8
  v_add_u32 v226, 63488, v8
  v_xor_b32 v8, 8, v7
  v_xor_b32 v8, v8, v4
  v_lshlrev_b32 v8, 4, v8
  v_lshl_add_u32 v8, v3, 13, v8
  v_add_u32 v227, 95232, v8
  s_lshl_b32 s50, s47, 8
  s_waitcnt lgkmcnt(0)
  s_add_u32 s28, s10, s50
  s_addc_u32 s29, s11, 0
  s_sub_u32 s30, 0x400000, s50
  s_mov_b32 s31, 0x20000
  s_lshl_b32 s63, s62, 1
  s_add_u32 s63, s63, 0
  s_and_b32 s63, s63, 7
  s_lshl_b32 s63, s63, 19
  s_mov_b32 m0, 114688
  s_add_u32 s38, s63, 0
  buffer_load_dwordx4 v224, s[28:31], s38 offen offset:0 lds
  buffer_load_dwordx4 v225, s[28:31], s38 offen offset:1024 lds
  buffer_load_dwordx4 v226, s[28:31], s38 offen offset:2048 lds
  buffer_load_dwordx4 v227, s[28:31], s38 offen offset:3072 lds
  s_mov_b32 m0, 118784
  s_add_u32 s38, s63, 131072
  buffer_load_dwordx4 v224, s[28:31], s38 offen offset:0 lds
  buffer_load_dwordx4 v225, s[28:31], s38 offen offset:1024 lds
  buffer_load_dwordx4 v226, s[28:31], s38 offen offset:2048 lds
  buffer_load_dwordx4 v227, s[28:31], s38 offen offset:3072 lds
  s_mov_b32 m0, 122880
  s_add_u32 s38, s63, 262144
  buffer_load_dwordx4 v224, s[28:31], s38 offen offset:0 lds
  buffer_load_dwordx4 v225, s[28:31], s38 offen offset:1024 lds
  buffer_load_dwordx4 v226, s[28:31], s38 offen offset:2048 lds
  buffer_load_dwordx4 v227, s[28:31], s38 offen offset:3072 lds
  s_mov_b32 m0, 126976
  s_add_u32 s38, s63, 393216
  buffer_load_dwordx4 v224, s[28:31], s38 offen offset:0 lds
  buffer_load_dwordx4 v225, s[28:31], s38 offen offset:1024 lds
  buffer_load_dwordx4 v226, s[28:31], s38 offen offset:2048 lds
  buffer_load_dwordx4 v227, s[28:31], s38 offen offset:3072 lds
  s_lshl_b32 s50, s48, 5
  s_add_u32 s50, s50, s47
  s_lshl_b32 s50, s50, 17
  s_add_u32 s20, s6, s50
  s_addc_u32 s21, s7, 0
  s_mov_b32 s22, 16908288
  s_mov_b32 s23, 0x20000
  s_add_u32 s24, s8, s50
  s_addc_u32 s25, s9, 0
  s_mov_b32 s26, 16908288
  s_mov_b32 s27, 0x20000
  v_xor_b32 v8, 0, v3
  v_lshlrev_b32 v8, 1, v8
  v_or_b32 v8, 0, v8
  v_xor_b32 v8, v8, v4
  v_lshlrev_b32 v8, 4, v8
  v_lshl_add_u32 v228, v3, 8, v8
  v_xor_b32 v8, 4, v3
  v_lshlrev_b32 v8, 1, v8
  v_or_b32 v8, 0, v8
  v_xor_b32 v8, v8, v4
  v_lshlrev_b32 v8, 4, v8
  v_lshl_add_u32 v229, v3, 8, v8
  v_xor_b32 v8, 4, v3
  v_lshlrev_b32 v8, 1, v8
  v_or_b32 v8, 1, v8
  v_xor_b32 v8, v8, v4
  v_lshlrev_b32 v8, 4, v8
  v_lshl_add_u32 v230, v3, 8, v8
  v_xor_b32 v8, 0, v3
  v_lshlrev_b32 v8, 1, v8
  v_or_b32 v8, 1, v8
  v_xor_b32 v8, v8, v4
  v_lshlrev_b32 v8, 4, v8
  v_lshl_add_u32 v231, v3, 8, v8
  v_xor_b32 v8, 0, v7
  v_xor_b32 v8, v8, v4
  v_lshrrev_b32 v9, 3, v8
  v_and_b32 v10, 7, v8
  v_lshlrev_b32 v8, 4, v8
  v_lshl_add_u32 v232, v3, 8, v8
  v_lshlrev_b32 v10, 4, v10
  v_lshl_add_u32 v10, v9, 14, v10
  v_lshl_add_u32 v234, v3, 8, v10
  v_xor_b32 v8, 8, v7
  v_xor_b32 v8, v8, v4
  v_lshrrev_b32 v9, 3, v8
  v_and_b32 v10, 7, v8
  v_lshlrev_b32 v8, 4, v8
  v_lshl_add_u32 v233, v3, 8, v8
  v_lshlrev_b32 v10, 4, v10
  v_lshl_add_u32 v10, v9, 14, v10
  v_lshl_add_u32 v235, v3, 8, v10
  v_xor_b32 v8, 0, v7
  v_xor_b32 v8, v8, v4
  v_lshrrev_b32 v9, 3, v8
  v_and_b32 v8, 7, v8
  v_lshlrev_b32 v8, 4, v8
  v_lshl_add_u32 v8, v9, 16, v8
  v_lshl_add_u32 v8, v3, 10, v8
  v_add_u32 v236, 0, v8
  v_xor_b32 v8, 0, v7
  v_xor_b32 v8, v8, v4
  v_lshrrev_b32 v9, 3, v8
  v_and_b32 v8, 7, v8
  v_lshlrev_b32 v8, 4, v8
  v_lshl_add_u32 v8, v9, 16, v8
  v_lshl_add_u32 v8, v3, 10, v8
  v_add_u32 v237, 3072, v8
  v_xor_b32 v8, 8, v7
  v_xor_b32 v8, v8, v4
  v_lshrrev_b32 v9, 3, v8
  v_and_b32 v8, 7, v8
  v_lshlrev_b32 v8, 4, v8
  v_lshl_add_u32 v8, v9, 16, v8
  v_lshl_add_u32 v8, v3, 10, v8
  v_add_u32 v238, 6144, v8
  v_xor_b32 v8, 8, v7
  v_xor_b32 v8, v8, v4
  v_lshrrev_b32 v9, 3, v8
  v_and_b32 v8, 7, v8
  v_lshlrev_b32 v8, 4, v8
  v_lshl_add_u32 v8, v9, 16, v8
  v_lshl_add_u32 v8, v3, 10, v8
  v_add_u32 v239, 9216, v8
  s_and_b32 s66, s3, 3
  s_lshl_b32 s98, s3, 13
  s_add_u32 s98, s98, 0x3000000
  s_add_u32 s68, s12, s98
  s_addc_u32 s69, s13, 0
  s_mov_b32 s70, 8192
  s_mov_b32 s71, 0x20000
  s_mov_b32 s74, 256
  s_mov_b32 s75, 0x20000
  s_lshl_b32 s53, s48, 9
  s_lshl_b32 s98, s36, 6
  s_add_u32 s53, s53, s98
  s_lshr_b32 s98, s44, 2
  s_lshl_b32 s98, s98, 3
  s_add_u32 s52, s53, s98
  s_mov_b32 s55, 0
  s_mov_b32 s56, 0
  s_mov_b32 s37, 0
  s_mov_b32 s39, 0
  s_mov_b32 s57, 0
  s_mov_b32 s46, -1
  s_mov_b32 s59, 0xff
  s_mov_b32 s67, 0
  s_getreg_b32 s49, hwreg(HW_REG_XCC_ID, 0, 16)
  s_add_u32 s49, s49, 1
  s_lshr_b32 s98, s44, 2
  s_and_b32 s99, s44, 3
  s_lshl_b32 s100, s66, 20
  s_lshl_b32 s101, s98, 7
  s_add_u32 s100, s100, s101
  s_add_u32 s76, s14, s100
  s_addc_u32 s77, s15, 0
  s_sub_u32 s78, 0x100000, s101
  s_mov_b32 s79, 0x20000
  s_lshl_b32 s100, s45, 3
  s_add_u32 s99, s99, s100
  s_mul_i32 s100, s99, 7
  s_add_u32 s100, s100, s36
  s_lshl_b32 s100, s100, 17
  s_lshl_b32 s101, s66, 15
  s_add_u32 s100, s100, s101
  s_add_u32 s80, s12, s100
  s_addc_u32 s81, s13, 0
  s_mov_b32 s82, 3702784
  s_mov_b32 s83, 0x20000
  s_lshl_b32 s99, s99, 4
  s_lshl_b32 s100, s98, 1
  s_add_u32 s99, s99, s100
  s_lshl_b32 s99, s99, 2
  s_add_u32 s99, s99, s66
  s_mul_i32 s99, s99, 14336
  s_lshl_b32 s100, s36, 11
  s_add_u32 s99, s99, s100
  s_add_u32 s99, s99, 0x2000000
  s_add_u32 s84, s12, s99
  s_addc_u32 s85, s13, 0
  s_mov_b32 s86, 3729408
  s_mov_b32 s87, 0x20000
  s_add_u32 s100, s98, 0
  s_and_b32 s100, s100, 7
  s_lshl_b32 s88, s100, 12
  s_add_u32 s100, s98, 1
  s_and_b32 s100, s100, 7
  s_lshl_b32 s89, s100, 12
  s_add_u32 s100, s98, 2
  s_and_b32 s100, s100, 7
  s_lshl_b32 s90, s100, 12
  s_add_u32 s100, s98, 3
  s_and_b32 s100, s100, 7
  s_lshl_b32 s91, s100, 12
  s_add_u32 s100, s98, 4
  s_and_b32 s100, s100, 7
  s_lshl_b32 s92, s100, 12
  s_add_u32 s100, s98, 5
  s_and_b32 s100, s100, 7
  s_lshl_b32 s93, s100, 12
  s_add_u32 s100, s98, 6
  s_and_b32 s100, s100, 7
  s_lshl_b32 s94, s100, 12
  s_add_u32 s100, s98, 7
  s_and_b32 s100, s100, 7
  s_lshl_b32 s95, s100, 12
  s_lshl_b32 s98, s66, 20
  s_lshl_b32 s99, s44, 15
  s_add_u32 s98, s98, s99
  s_add_u32 s16, s14, s98
  s_addc_u32 s17, s15, 0
  s_mov_b32 s18, 32768
  s_mov_b32 s19, 0x20000
  s_lshl_b32 s63, s62, 1
  s_add_u32 s63, s63, 1
  s_and_b32 s63, s63, 7
  s_lshl_b32 s63, s63, 19
  s_mov_b32 m0, 131072
  s_add_u32 s38, s63, 0
  buffer_load_dwordx4 v224, s[28:31], s38 offen offset:0 lds
  buffer_load_dwordx4 v225, s[28:31], s38 offen offset:1024 lds
  buffer_load_dwordx4 v226, s[28:31], s38 offen offset:2048 lds
  buffer_load_dwordx4 v227, s[28:31], s38 offen offset:3072 lds
  s_mov_b32 m0, 135168
  s_add_u32 s38, s63, 131072
  buffer_load_dwordx4 v224, s[28:31], s38 offen offset:0 lds
  buffer_load_dwordx4 v225, s[28:31], s38 offen offset:1024 lds
  buffer_load_dwordx4 v226, s[28:31], s38 offen offset:2048 lds
  buffer_load_dwordx4 v227, s[28:31], s38 offen offset:3072 lds
  s_mov_b32 m0, 139264
  s_add_u32 s38, s63, 262144
  buffer_load_dwordx4 v224, s[28:31], s38 offen offset:0 lds
  buffer_load_dwordx4 v225, s[28:31], s38 offen offset:1024 lds
  buffer_load_dwordx4 v226, s[28:31], s38 offen offset:2048 lds
  buffer_load_dwordx4 v227, s[28:31], s38 offen offset:3072 lds
  s_mov_b32 m0, 143360
  s_add_u32 s38, s63, 393216
  buffer_load_dwordx4 v224, s[28:31], s38 offen offset:0 lds
  buffer_load_dwordx4 v225, s[28:31], s38 offen offset:1024 lds
  buffer_load_dwordx4 v226, s[28:31], s38 offen offset:2048 lds
  buffer_load_dwordx4 v227, s[28:31], s38 offen offset:3072 lds
  s_waitcnt vmcnt(16)
  s_barrier
  s_lshl_b32 s63, s62, 1
  s_add_u32 s63, s63, 2
  s_and_b32 s63, s63, 7
  s_lshl_b32 s63, s63, 19
  s_mov_b32 m0, 147456
  s_add_u32 s38, s63, 0
  buffer_load_dwordx4 v224, s[28:31], s38 offen offset:0 lds
  buffer_load_dwordx4 v225, s[28:31], s38 offen offset:1024 lds
  buffer_load_dwordx4 v226, s[28:31], s38 offen offset:2048 lds
  buffer_load_dwordx4 v227, s[28:31], s38 offen offset:3072 lds
  s_mov_b32 m0, 151552
  s_add_u32 s38, s63, 131072
  buffer_load_dwordx4 v224, s[28:31], s38 offen offset:0 lds
  buffer_load_dwordx4 v225, s[28:31], s38 offen offset:1024 lds
  buffer_load_dwordx4 v226, s[28:31], s38 offen offset:2048 lds
  buffer_load_dwordx4 v227, s[28:31], s38 offen offset:3072 lds
  s_mov_b32 m0, 155648
  s_add_u32 s38, s63, 262144
  buffer_load_dwordx4 v224, s[28:31], s38 offen offset:0 lds
  buffer_load_dwordx4 v225, s[28:31], s38 offen offset:1024 lds
  buffer_load_dwordx4 v226, s[28:31], s38 offen offset:2048 lds
  buffer_load_dwordx4 v227, s[28:31], s38 offen offset:3072 lds
  s_mov_b32 m0, 159744
  s_add_u32 s38, s63, 393216
  buffer_load_dwordx4 v224, s[28:31], s38 offen offset:0 lds
  buffer_load_dwordx4 v225, s[28:31], s38 offen offset:1024 lds
  buffer_load_dwordx4 v226, s[28:31], s38 offen offset:2048 lds
  buffer_load_dwordx4 v227, s[28:31], s38 offen offset:3072 lds
  s_mov_b32 m0, 65536
  s_mov_b32 s38, 0
  buffer_load_dwordx4 v228, s[20:23], s38 offen offset:0 nt lds
  buffer_load_dwordx4 v229, s[20:23], s38 offen offset:1024 nt lds
  buffer_load_dwordx4 v230, s[20:23], s38 offen offset:2048 nt lds
  buffer_load_dwordx4 v231, s[20:23], s38 offen offset:3072 nt lds
  s_mov_b32 m0, 69632
  s_mov_b32 s38, 4096
  buffer_load_dwordx4 v228, s[20:23], s38 offen offset:0 nt lds
  buffer_load_dwordx4 v229, s[20:23], s38 offen offset:1024 nt lds
  buffer_load_dwordx4 v230, s[20:23], s38 offen offset:2048 nt lds
  buffer_load_dwordx4 v231, s[20:23], s38 offen offset:3072 nt lds
  s_mov_b32 m0, 73728
  s_mov_b32 s38, 8192
  buffer_load_dwordx4 v228, s[20:23], s38 offen offset:0 nt lds
  buffer_load_dwordx4 v229, s[20:23], s38 offen offset:1024 nt lds
  buffer_load_dwordx4 v230, s[20:23], s38 offen offset:2048 nt lds
  buffer_load_dwordx4 v231, s[20:23], s38 offen offset:3072 nt lds
  s_mov_b32 m0, 77824
  s_mov_b32 s38, 12288
  buffer_load_dwordx4 v228, s[20:23], s38 offen offset:0 nt lds
  buffer_load_dwordx4 v229, s[20:23], s38 offen offset:1024 nt lds
  buffer_load_dwordx4 v230, s[20:23], s38 offen offset:2048 nt lds
  buffer_load_dwordx4 v231, s[20:23], s38 offen offset:3072 nt lds
  s_mov_b32 m0, 81920
  s_mov_b32 s38, 16384
  buffer_load_dwordx4 v228, s[20:23], s38 offen offset:0 nt lds
  buffer_load_dwordx4 v229, s[20:23], s38 offen offset:1024 nt lds
  buffer_load_dwordx4 v230, s[20:23], s38 offen offset:2048 nt lds
  buffer_load_dwordx4 v231, s[20:23], s38 offen offset:3072 nt lds
  s_mov_b32 m0, 86016
  s_mov_b32 s38, 20480
  buffer_load_dwordx4 v228, s[20:23], s38 offen offset:0 nt lds
  buffer_load_dwordx4 v229, s[20:23], s38 offen offset:1024 nt lds
  buffer_load_dwordx4 v230, s[20:23], s38 offen offset:2048 nt lds
  buffer_load_dwordx4 v231, s[20:23], s38 offen offset:3072 nt lds
  s_mov_b32 m0, 90112
  s_mov_b32 s38, 24576
  buffer_load_dwordx4 v228, s[20:23], s38 offen offset:0 nt lds
  buffer_load_dwordx4 v229, s[20:23], s38 offen offset:1024 nt lds
  buffer_load_dwordx4 v230, s[20:23], s38 offen offset:2048 nt lds
  buffer_load_dwordx4 v231, s[20:23], s38 offen offset:3072 nt lds
  s_mov_b32 m0, 94208
  s_mov_b32 s38, 28672
  buffer_load_dwordx4 v228, s[20:23], s38 offen offset:0 nt lds
  buffer_load_dwordx4 v229, s[20:23], s38 offen offset:1024 nt lds
  buffer_load_dwordx4 v230, s[20:23], s38 offen offset:2048 nt lds
  buffer_load_dwordx4 v231, s[20:23], s38 offen offset:3072 nt lds
  s_waitcnt vmcnt(48)
  s_barrier
  s_lshl_b32 s63, s62, 1
  s_add_u32 s63, s63, 3
  s_and_b32 s63, s63, 7
  s_lshl_b32 s63, s63, 19
  s_mov_b32 m0, 114688
  s_add_u32 s38, s63, 0
  buffer_load_dwordx4 v224, s[28:31], s38 offen offset:0 lds
  buffer_load_dwordx4 v225, s[28:31], s38 offen offset:1024 lds
  buffer_load_dwordx4 v226, s[28:31], s38 offen offset:2048 lds
  buffer_load_dwordx4 v227, s[28:31], s38 offen offset:3072 lds
  s_mov_b32 m0, 118784
  s_add_u32 s38, s63, 131072
  buffer_load_dwordx4 v224, s[28:31], s38 offen offset:0 lds
  buffer_load_dwordx4 v225, s[28:31], s38 offen offset:1024 lds
  buffer_load_dwordx4 v226, s[28:31], s38 offen offset:2048 lds
  buffer_load_dwordx4 v227, s[28:31], s38 offen offset:3072 lds
  s_mov_b32 m0, 122880
  s_add_u32 s38, s63, 262144
  buffer_load_dwordx4 v224, s[28:31], s38 offen offset:0 lds
  buffer_load_dwordx4 v225, s[28:31], s38 offen offset:1024 lds
  buffer_load_dwordx4 v226, s[28:31], s38 offen offset:2048 lds
  buffer_load_dwordx4 v227, s[28:31], s38 offen offset:3072 lds
  s_mov_b32 m0, 126976
  s_add_u32 s38, s63, 393216
  buffer_load_dwordx4 v224, s[28:31], s38 offen offset:0 lds
  buffer_load_dwordx4 v225, s[28:31], s38 offen offset:1024 lds
  buffer_load_dwordx4 v226, s[28:31], s38 offen offset:2048 lds
  buffer_load_dwordx4 v227, s[28:31], s38 offen offset:3072 lds
  s_mov_b32 m0, 98304
  s_mov_b32 s38, 32768
  buffer_load_dwordx4 v228, s[20:23], s38 offen offset:0 nt lds
  buffer_load_dwordx4 v229, s[20:23], s38 offen offset:1024 nt lds
  buffer_load_dwordx4 v230, s[20:23], s38 offen offset:2048 nt lds
  buffer_load_dwordx4 v231, s[20:23], s38 offen offset:3072 nt lds
  s_mov_b32 m0, 102400
  s_mov_b32 s38, 36864
  buffer_load_dwordx4 v228, s[20:23], s38 offen offset:0 nt lds
  buffer_load_dwordx4 v229, s[20:23], s38 offen offset:1024 nt lds
  buffer_load_dwordx4 v230, s[20:23], s38 offen offset:2048 nt lds
  buffer_load_dwordx4 v231, s[20:23], s38 offen offset:3072 nt lds
  s_mov_b32 m0, 106496
  s_mov_b32 s38, 40960
  buffer_load_dwordx4 v228, s[20:23], s38 offen offset:0 nt lds
  buffer_load_dwordx4 v229, s[20:23], s38 offen offset:1024 nt lds
  buffer_load_dwordx4 v230, s[20:23], s38 offen offset:2048 nt lds
  buffer_load_dwordx4 v231, s[20:23], s38 offen offset:3072 nt lds
  s_mov_b32 m0, 110592
  s_mov_b32 s38, 45056
  buffer_load_dwordx4 v228, s[20:23], s38 offen offset:0 nt lds
  buffer_load_dwordx4 v229, s[20:23], s38 offen offset:1024 nt lds
  buffer_load_dwordx4 v230, s[20:23], s38 offen offset:2048 nt lds
  buffer_load_dwordx4 v231, s[20:23], s38 offen offset:3072 nt lds
  s_waitcnt vmcnt(63)
  s_barrier
  s_lshl_b32 s63, s62, 1
  s_add_u32 s63, s63, 4
  s_and_b32 s63, s63, 7
  s_lshl_b32 s63, s63, 19
  s_mov_b32 m0, 131072
  s_add_u32 s38, s63, 0
  buffer_load_dwordx4 v224, s[28:31], s38 offen offset:0 lds
  buffer_load_dwordx4 v225, s[28:31], s38 offen offset:1024 lds
  buffer_load_dwordx4 v226, s[28:31], s38 offen offset:2048 lds
  buffer_load_dwordx4 v227, s[28:31], s38 offen offset:3072 lds
  s_mov_b32 m0, 135168
  s_add_u32 s38, s63, 131072
  buffer_load_dwordx4 v224, s[28:31], s38 offen offset:0 lds
  buffer_load_dwordx4 v225, s[28:31], s38 offen offset:1024 lds
  buffer_load_dwordx4 v226, s[28:31], s38 offen offset:2048 lds
  buffer_load_dwordx4 v227, s[28:31], s38 offen offset:3072 lds
  s_mov_b32 m0, 139264
  s_add_u32 s38, s63, 262144
  buffer_load_dwordx4 v224, s[28:31], s38 offen offset:0 lds
  buffer_load_dwordx4 v225, s[28:31], s38 offen offset:1024 lds
  buffer_load_dwordx4 v226, s[28:31], s38 offen offset:2048 lds
  buffer_load_dwordx4 v227, s[28:31], s38 offen offset:3072 lds
  s_mov_b32 m0, 143360
  s_add_u32 s38, s63, 393216
  buffer_load_dwordx4 v224, s[28:31], s38 offen offset:0 lds
  buffer_load_dwordx4 v225, s[28:31], s38 offen offset:1024 lds
  buffer_load_dwordx4 v226, s[28:31], s38 offen offset:2048 lds
  buffer_load_dwordx4 v227, s[28:31], s38 offen offset:3072 lds
  s_mov_b32 s38, 0
  buffer_load_dwordx4 v[16:19], v248, s[16:19], s38 offen offset:0
  buffer_load_dwordx4 v[20:23], v248, s[16:19], s38 offen offset:1024
  buffer_load_dwordx4 v[24:27], v248, s[16:19], s38 offen offset:2048
  buffer_load_dwordx4 v[28:31], v248, s[16:19], s38 offen offset:3072
  s_mov_b32 s38, 4096
  buffer_load_dwordx4 v[32:35], v248, s[16:19], s38 offen offset:0
  buffer_load_dwordx4 v[36:39], v248, s[16:19], s38 offen offset:1024
  buffer_load_dwordx4 v[40:43], v248, s[16:19], s38 offen offset:2048
  buffer_load_dwordx4 v[44:47], v248, s[16:19], s38 offen offset:3072
  s_mov_b32 s38, 8192
  buffer_load_dwordx4 v[48:51], v248, s[16:19], s38 offen offset:0
  buffer_load_dwordx4 v[52:55], v248, s[16:19], s38 offen offset:1024
  buffer_load_dwordx4 v[56:59], v248, s[16:19], s38 offen offset:2048
  buffer_load_dwordx4 v[60:63], v248, s[16:19], s38 offen offset:3072
  s_mov_b32 s38, 12288
  buffer_load_dwordx4 v[64:67], v248, s[16:19], s38 offen offset:0
  buffer_load_dwordx4 v[68:71], v248, s[16:19], s38 offen offset:1024
  buffer_load_dwordx4 v[72:75], v248, s[16:19], s38 offen offset:2048
  buffer_load_dwordx4 v[76:79], v248, s[16:19], s38 offen offset:3072
  s_waitcnt vmcnt(48)
  s_barrier
  s_lshl_b32 s63, s62, 1
  s_add_u32 s63, s63, 5
  s_and_b32 s63, s63, 7
  s_lshl_b32 s63, s63, 19
  s_mov_b32 m0, 147456
  s_add_u32 s38, s63, 0
  buffer_load_dwordx4 v224, s[28:31], s38 offen offset:0 lds
  buffer_load_dwordx4 v225, s[28:31], s38 offen offset:1024 lds
  buffer_load_dwordx4 v226, s[28:31], s38 offen offset:2048 lds
  buffer_load_dwordx4 v227, s[28:31], s38 offen offset:3072 lds
  s_mov_b32 m0, 151552
  s_add_u32 s38, s63, 131072
  buffer_load_dwordx4 v224, s[28:31], s38 offen offset:0 lds
  buffer_load_dwordx4 v225, s[28:31], s38 offen offset:1024 lds
  buffer_load_dwordx4 v226, s[28:31], s38 offen offset:2048 lds
  buffer_load_dwordx4 v227, s[28:31], s38 offen offset:3072 lds
  s_mov_b32 m0, 155648
  s_add_u32 s38, s63, 262144
  buffer_load_dwordx4 v224, s[28:31], s38 offen offset:0 lds
  buffer_load_dwordx4 v225, s[28:31], s38 offen offset:1024 lds
  buffer_load_dwordx4 v226, s[28:31], s38 offen offset:2048 lds
  buffer_load_dwordx4 v227, s[28:31], s38 offen offset:3072 lds
  s_mov_b32 m0, 159744
  s_add_u32 s38, s63, 393216
  buffer_load_dwordx4 v224, s[28:31], s38 offen offset:0 lds
  buffer_load_dwordx4 v225, s[28:31], s38 offen offset:1024 lds
  buffer_load_dwordx4 v226, s[28:31], s38 offen offset:2048 lds
  buffer_load_dwordx4 v227, s[28:31], s38 offen offset:3072 lds
  s_mov_b32 s38, 16384
  buffer_load_dwordx4 v[80:83], v248, s[16:19], s38 offen offset:0
  buffer_load_dwordx4 v[84:87], v248, s[16:19], s38 offen offset:1024
  buffer_load_dwordx4 v[88:91], v248, s[16:19], s38 offen offset:2048
  buffer_load_dwordx4 v[92:95], v248, s[16:19], s38 offen offset:3072
  s_mov_b32 s38, 20480
  buffer_load_dwordx4 v[96:99], v248, s[16:19], s38 offen offset:0
  buffer_load_dwordx4 v[100:103], v248, s[16:19], s38 offen offset:1024
  buffer_load_dwordx4 v[104:107], v248, s[16:19], s38 offen offset:2048
  buffer_load_dwordx4 v[108:111], v248, s[16:19], s38 offen offset:3072
  s_mov_b32 s38, 24576
  buffer_load_dwordx4 v[112:115], v248, s[16:19], s38 offen offset:0
  buffer_load_dwordx4 v[116:119], v248, s[16:19], s38 offen offset:1024
  buffer_load_dwordx4 v[120:123], v248, s[16:19], s38 offen offset:2048
  buffer_load_dwordx4 v[124:127], v248, s[16:19], s38 offen offset:3072
  s_mov_b32 s38, 28672
  buffer_load_dwordx4 v[128:131], v248, s[16:19], s38 offen offset:0
  buffer_load_dwordx4 v[132:135], v248, s[16:19], s38 offen offset:1024
  buffer_load_dwordx4 v[136:139], v248, s[16:19], s38 offen offset:2048
  buffer_load_dwordx4 v[140:143], v248, s[16:19], s38 offen offset:3072
  s_waitcnt vmcnt(48)
  s_barrier
  s_lshl_b32 s63, s62, 1
  s_add_u32 s63, s63, 6
  s_and_b32 s63, s63, 7
  s_lshl_b32 s63, s63, 19
  s_mov_b32 m0, 114688
  s_add_u32 s38, s63, 0
  buffer_load_dwordx4 v224, s[28:31], s38 offen offset:0 lds
  buffer_load_dwordx4 v225, s[28:31], s38 offen offset:1024 lds
  buffer_load_dwordx4 v226, s[28:31], s38 offen offset:2048 lds
  buffer_load_dwordx4 v227, s[28:31], s38 offen offset:3072 lds
  s_mov_b32 m0, 118784
  s_add_u32 s38, s63, 131072
  buffer_load_dwordx4 v224, s[28:31], s38 offen offset:0 lds
  buffer_load_dwordx4 v225, s[28:31], s38 offen offset:1024 lds
  buffer_load_dwordx4 v226, s[28:31], s38 offen offset:2048 lds
  buffer_load_dwordx4 v227, s[28:31], s38 offen offset:3072 lds
  s_mov_b32 m0, 122880
  s_add_u32 s38, s63, 262144
  buffer_load_dwordx4 v224, s[28:31], s38 offen offset:0 lds
  buffer_load_dwordx4 v225, s[28:31], s38 offen offset:1024 lds
  buffer_load_dwordx4 v226, s[28:31], s38 offen offset:2048 lds
  buffer_load_dwordx4 v227, s[28:31], s38 offen offset:3072 lds
  s_mov_b32 m0, 126976
  s_add_u32 s38, s63, 393216
  buffer_load_dwordx4 v224, s[28:31], s38 offen offset:0 lds
  buffer_load_dwordx4 v225, s[28:31], s38 offen offset:1024 lds
  buffer_load_dwordx4 v226, s[28:31], s38 offen offset:2048 lds
  buffer_load_dwordx4 v227, s[28:31], s38 offen offset:3072 lds
  s_mov_b32 m0, 0
  s_mov_b32 s38, 49152
  buffer_load_dwordx4 v228, s[20:23], s38 offen offset:0 nt lds
  buffer_load_dwordx4 v229, s[20:23], s38 offen offset:1024 nt lds
  buffer_load_dwordx4 v230, s[20:23], s38 offen offset:2048 nt lds
  buffer_load_dwordx4 v231, s[20:23], s38 offen offset:3072 nt lds
  s_mov_b32 m0, 4096
  s_mov_b32 s38, 53248
  buffer_load_dwordx4 v228, s[20:23], s38 offen offset:0 nt lds
  buffer_load_dwordx4 v229, s[20:23], s38 offen offset:1024 nt lds
  buffer_load_dwordx4 v230, s[20:23], s38 offen offset:2048 nt lds
  buffer_load_dwordx4 v231, s[20:23], s38 offen offset:3072 nt lds
  s_mov_b32 m0, 8192
  s_mov_b32 s38, 57344
  buffer_load_dwordx4 v228, s[20:23], s38 offen offset:0 nt lds
  buffer_load_dwordx4 v229, s[20:23], s38 offen offset:1024 nt lds
  buffer_load_dwordx4 v230, s[20:23], s38 offen offset:2048 nt lds
  buffer_load_dwordx4 v231, s[20:23], s38 offen offset:3072 nt lds
  s_mov_b32 m0, 12288
  s_mov_b32 s38, 61440
  buffer_load_dwordx4 v228, s[20:23], s38 offen offset:0 nt lds
  buffer_load_dwordx4 v229, s[20:23], s38 offen offset:1024 nt lds
  buffer_load_dwordx4 v230, s[20:23], s38 offen offset:2048 nt lds
  buffer_load_dwordx4 v231, s[20:23], s38 offen offset:3072 nt lds
  s_mov_b32 m0, 16384
  s_mov_b32 s38, 65536
  buffer_load_dwordx4 v228, s[20:23], s38 offen offset:0 nt lds
  buffer_load_dwordx4 v229, s[20:23], s38 offen offset:1024 nt lds
  buffer_load_dwordx4 v230, s[20:23], s38 offen offset:2048 nt lds
  buffer_load_dwordx4 v231, s[20:23], s38 offen offset:3072 nt lds
  s_mov_b32 m0, 20480
  s_mov_b32 s38, 69632
  buffer_load_dwordx4 v228, s[20:23], s38 offen offset:0 nt lds
  buffer_load_dwordx4 v229, s[20:23], s38 offen offset:1024 nt lds
  buffer_load_dwordx4 v230, s[20:23], s38 offen offset:2048 nt lds
  buffer_load_dwordx4 v231, s[20:23], s38 offen offset:3072 nt lds
  s_mov_b32 m0, 24576
  s_mov_b32 s38, 73728
  buffer_load_dwordx4 v228, s[20:23], s38 offen offset:0 nt lds
  buffer_load_dwordx4 v229, s[20:23], s38 offen offset:1024 nt lds
  buffer_load_dwordx4 v230, s[20:23], s38 offen offset:2048 nt lds
  buffer_load_dwordx4 v231, s[20:23], s38 offen offset:3072 nt lds
  s_mov_b32 m0, 28672
  s_mov_b32 s38, 77824
  buffer_load_dwordx4 v228, s[20:23], s38 offen offset:0 nt lds
  buffer_load_dwordx4 v229, s[20:23], s38 offen offset:1024 nt lds
  buffer_load_dwordx4 v230, s[20:23], s38 offen offset:2048 nt lds
  buffer_load_dwordx4 v231, s[20:23], s38 offen offset:3072 nt lds
  s_waitcnt vmcnt(63)
  s_barrier
  s_lshl_b32 s63, s62, 1
  s_add_u32 s63, s63, 7
  s_and_b32 s63, s63, 7
  s_lshl_b32 s63, s63, 19
  s_mov_b32 m0, 131072
  s_add_u32 s38, s63, 0
  buffer_load_dwordx4 v224, s[28:31], s38 offen offset:0 lds
  buffer_load_dwordx4 v225, s[28:31], s38 offen offset:1024 lds
  buffer_load_dwordx4 v226, s[28:31], s38 offen offset:2048 lds
  buffer_load_dwordx4 v227, s[28:31], s38 offen offset:3072 lds
  s_mov_b32 m0, 135168
  s_add_u32 s38, s63, 131072
  buffer_load_dwordx4 v224, s[28:31], s38 offen offset:0 lds
  buffer_load_dwordx4 v225, s[28:31], s38 offen offset:1024 lds
  buffer_load_dwordx4 v226, s[28:31], s38 offen offset:2048 lds
  buffer_load_dwordx4 v227, s[28:31], s38 offen offset:3072 lds
  s_mov_b32 m0, 139264
  s_add_u32 s38, s63, 262144
  buffer_load_dwordx4 v224, s[28:31], s38 offen offset:0 lds
  buffer_load_dwordx4 v225, s[28:31], s38 offen offset:1024 lds
  buffer_load_dwordx4 v226, s[28:31], s38 offen offset:2048 lds
  buffer_load_dwordx4 v227, s[28:31], s38 offen offset:3072 lds
  s_mov_b32 m0, 143360
  s_add_u32 s38, s63, 393216
  buffer_load_dwordx4 v224, s[28:31], s38 offen offset:0 lds
  buffer_load_dwordx4 v225, s[28:31], s38 offen offset:1024 lds
  buffer_load_dwordx4 v226, s[28:31], s38 offen offset:2048 lds
  buffer_load_dwordx4 v227, s[28:31], s38 offen offset:3072 lds
  s_mov_b32 m0, 32768
  s_mov_b32 s38, 81920
  buffer_load_dwordx4 v228, s[20:23], s38 offen offset:0 nt lds
  buffer_load_dwordx4 v229, s[20:23], s38 offen offset:1024 nt lds
  buffer_load_dwordx4 v230, s[20:23], s38 offen offset:2048 nt lds
  buffer_load_dwordx4 v231, s[20:23], s38 offen offset:3072 nt lds
  s_mov_b32 m0, 36864
  s_mov_b32 s38, 86016
  buffer_load_dwordx4 v228, s[20:23], s38 offen offset:0 nt lds
  buffer_load_dwordx4 v229, s[20:23], s38 offen offset:1024 nt lds
  buffer_load_dwordx4 v230, s[20:23], s38 offen offset:2048 nt lds
  buffer_load_dwordx4 v231, s[20:23], s38 offen offset:3072 nt lds
  s_mov_b32 m0, 40960
  s_mov_b32 s38, 90112
  buffer_load_dwordx4 v228, s[20:23], s38 offen offset:0 nt lds
  buffer_load_dwordx4 v229, s[20:23], s38 offen offset:1024 nt lds
  buffer_load_dwordx4 v230, s[20:23], s38 offen offset:2048 nt lds
  buffer_load_dwordx4 v231, s[20:23], s38 offen offset:3072 nt lds
  s_mov_b32 m0, 45056
  s_mov_b32 s38, 94208
  buffer_load_dwordx4 v228, s[20:23], s38 offen offset:0 nt lds
  buffer_load_dwordx4 v229, s[20:23], s38 offen offset:1024 nt lds
  buffer_load_dwordx4 v230, s[20:23], s38 offen offset:2048 nt lds
  buffer_load_dwordx4 v231, s[20:23], s38 offen offset:3072 nt lds
  s_waitcnt vmcnt(63)
  s_barrier
  s_mov_b32 m0, 49152
  s_mov_b32 s38, 98304
  buffer_load_dwordx4 v228, s[20:23], s38 offen offset:0 nt lds
  buffer_load_dwordx4 v229, s[20:23], s38 offen offset:1024 nt lds
  buffer_load_dwordx4 v230, s[20:23], s38 offen offset:2048 nt lds
  buffer_load_dwordx4 v231, s[20:23], s38 offen offset:3072 nt lds
  s_mov_b32 m0, 53248
  s_mov_b32 s38, 102400
  buffer_load_dwordx4 v228, s[20:23], s38 offen offset:0 nt lds
  buffer_load_dwordx4 v229, s[20:23], s38 offen offset:1024 nt lds
  buffer_load_dwordx4 v230, s[20:23], s38 offen offset:2048 nt lds
  buffer_load_dwordx4 v231, s[20:23], s38 offen offset:3072 nt lds
  s_mov_b32 m0, 57344
  s_mov_b32 s38, 106496
  buffer_load_dwordx4 v228, s[20:23], s38 offen offset:0 nt lds
  buffer_load_dwordx4 v229, s[20:23], s38 offen offset:1024 nt lds
  buffer_load_dwordx4 v230, s[20:23], s38 offen offset:2048 nt lds
  buffer_load_dwordx4 v231, s[20:23], s38 offen offset:3072 nt lds
  s_mov_b32 m0, 61440
  s_mov_b32 s38, 110592
  buffer_load_dwordx4 v228, s[20:23], s38 offen offset:0 nt lds
  buffer_load_dwordx4 v229, s[20:23], s38 offen offset:1024 nt lds
  buffer_load_dwordx4 v230, s[20:23], s38 offen offset:2048 nt lds
  buffer_load_dwordx4 v231, s[20:23], s38 offen offset:3072 nt lds
  s_waitcnt vmcnt(32)
  s_barrier
  s_mov_b32 m0, 147456
  s_mov_b32 s38, 114688
  buffer_load_dwordx4 v228, s[20:23], s38 offen offset:0 nt lds
  buffer_load_dwordx4 v229, s[20:23], s38 offen offset:1024 nt lds
  buffer_load_dwordx4 v230, s[20:23], s38 offen offset:2048 nt lds
  buffer_load_dwordx4 v231, s[20:23], s38 offen offset:3072 nt lds
  s_mov_b32 m0, 151552
  s_mov_b32 s38, 118784
  buffer_load_dwordx4 v228, s[20:23], s38 offen offset:0 nt lds
  buffer_load_dwordx4 v229, s[20:23], s38 offen offset:1024 nt lds
  buffer_load_dwordx4 v230, s[20:23], s38 offen offset:2048 nt lds
  buffer_load_dwordx4 v231, s[20:23], s38 offen offset:3072 nt lds
  s_mov_b32 m0, 155648
  s_mov_b32 s38, 122880
  buffer_load_dwordx4 v228, s[20:23], s38 offen offset:0 nt lds
  buffer_load_dwordx4 v229, s[20:23], s38 offen offset:1024 nt lds
  buffer_load_dwordx4 v230, s[20:23], s38 offen offset:2048 nt lds
  buffer_load_dwordx4 v231, s[20:23], s38 offen offset:3072 nt lds
  s_mov_b32 m0, 159744
  s_mov_b32 s38, 126976
  buffer_load_dwordx4 v228, s[20:23], s38 offen offset:0 nt lds
  buffer_load_dwordx4 v229, s[20:23], s38 offen offset:1024 nt lds
  buffer_load_dwordx4 v230, s[20:23], s38 offen offset:2048 nt lds
  buffer_load_dwordx4 v231, s[20:23], s38 offen offset:3072 nt lds
  s_barrier
  s_mov_b32 m0, 114688
  s_mov_b32 s38, 0
  buffer_load_dwordx4 v232, s[24:27], s38 offen offset:0 nt lds
  buffer_load_dwordx4 v233, s[24:27], s38 offen offset:1024 nt lds
  buffer_load_dwordx4 v232, s[24:27], s38 offen offset:2048 nt lds
  buffer_load_dwordx4 v233, s[24:27], s38 offen offset:3072 nt lds
  s_mov_b32 m0, 118784
  s_mov_b32 s38, 4096
  buffer_load_dwordx4 v232, s[24:27], s38 offen offset:0 nt lds
  buffer_load_dwordx4 v233, s[24:27], s38 offen offset:1024 nt lds
  buffer_load_dwordx4 v232, s[24:27], s38 offen offset:2048 nt lds
  buffer_load_dwordx4 v233, s[24:27], s38 offen offset:3072 nt lds
  s_mov_b32 m0, 122880
  s_mov_b32 s38, 8192
  buffer_load_dwordx4 v232, s[24:27], s38 offen offset:0 nt lds
  buffer_load_dwordx4 v233, s[24:27], s38 offen offset:1024 nt lds
  buffer_load_dwordx4 v232, s[24:27], s38 offen offset:2048 nt lds
  buffer_load_dwordx4 v233, s[24:27], s38 offen offset:3072 nt lds
  s_mov_b32 m0, 126976
  s_mov_b32 s38, 12288
  buffer_load_dwordx4 v232, s[24:27], s38 offen offset:0 nt lds
  buffer_load_dwordx4 v233, s[24:27], s38 offen offset:1024 nt lds
  buffer_load_dwordx4 v232, s[24:27], s38 offen offset:2048 nt lds
  buffer_load_dwordx4 v233, s[24:27], s38 offen offset:3072 nt lds
  s_barrier
  s_mov_b32 m0, 131072
  s_mov_b32 s38, 16384
  buffer_load_dwordx4 v232, s[24:27], s38 offen offset:0 nt lds
  buffer_load_dwordx4 v233, s[24:27], s38 offen offset:1024 nt lds
  buffer_load_dwordx4 v232, s[24:27], s38 offen offset:2048 nt lds
  buffer_load_dwordx4 v233, s[24:27], s38 offen offset:3072 nt lds
  s_mov_b32 m0, 135168
  s_mov_b32 s38, 20480
  buffer_load_dwordx4 v232, s[24:27], s38 offen offset:0 nt lds
  buffer_load_dwordx4 v233, s[24:27], s38 offen offset:1024 nt lds
  buffer_load_dwordx4 v232, s[24:27], s38 offen offset:2048 nt lds
  buffer_load_dwordx4 v233, s[24:27], s38 offen offset:3072 nt lds
  s_mov_b32 m0, 139264
  s_mov_b32 s38, 24576
  buffer_load_dwordx4 v232, s[24:27], s38 offen offset:0 nt lds
  buffer_load_dwordx4 v233, s[24:27], s38 offen offset:1024 nt lds
  buffer_load_dwordx4 v232, s[24:27], s38 offen offset:2048 nt lds
  buffer_load_dwordx4 v233, s[24:27], s38 offen offset:3072 nt lds
  s_mov_b32 m0, 143360
  s_mov_b32 s38, 28672
  buffer_load_dwordx4 v232, s[24:27], s38 offen offset:0 nt lds
  buffer_load_dwordx4 v233, s[24:27], s38 offen offset:1024 nt lds
  buffer_load_dwordx4 v232, s[24:27], s38 offen offset:2048 nt lds
  buffer_load_dwordx4 v233, s[24:27], s38 offen offset:3072 nt lds
  s_barrier
  s_barrier
  buffer_load_dwordx2 v[254:255], off, s[72:75], 0 sc1
  s_barrier
  s_mov_b32 m0, 65536
  s_mov_b32 s38, 32768
  buffer_load_dwordx4 v232, s[24:27], s38 offen offset:0 nt lds
  buffer_load_dwordx4 v233, s[24:27], s38 offen offset:1024 nt lds
  buffer_load_dwordx4 v232, s[24:27], s38 offen offset:2048 nt lds
  buffer_load_dwordx4 v233, s[24:27], s38 offen offset:3072 nt lds
  s_mov_b32 m0, 69632
  s_mov_b32 s38, 36864
  buffer_load_dwordx4 v232, s[24:27], s38 offen offset:0 nt lds
  buffer_load_dwordx4 v233, s[24:27], s38 offen offset:1024 nt lds
  buffer_load_dwordx4 v232, s[24:27], s38 offen offset:2048 nt lds
  buffer_load_dwordx4 v233, s[24:27], s38 offen offset:3072 nt lds
  s_mov_b32 m0, 73728
  s_mov_b32 s38, 40960
  buffer_load_dwordx4 v232, s[24:27], s38 offen offset:0 nt lds
  buffer_load_dwordx4 v233, s[24:27], s38 offen offset:1024 nt lds
  buffer_load_dwordx4 v232, s[24:27], s38 offen offset:2048 nt lds
  buffer_load_dwordx4 v233, s[24:27], s38 offen offset:3072 nt lds
  s_mov_b32 m0, 77824
  s_mov_b32 s38, 45056
  buffer_load_dwordx4 v232, s[24:27], s38 offen offset:0 nt lds
  buffer_load_dwordx4 v233, s[24:27], s38 offen offset:1024 nt lds
  buffer_load_dwordx4 v232, s[24:27], s38 offen offset:2048 nt lds
  buffer_load_dwordx4 v233, s[24:27], s38 offen offset:3072 nt lds
  s_waitcnt vmcnt(63)
  s_barrier
  s_mov_b32 m0, 81920
  s_mov_b32 s38, 49152
  buffer_load_dwordx4 v232, s[24:27], s38 offen offset:0 nt lds
  buffer_load_dwordx4 v233, s[24:27], s38 offen offset:1024 nt lds
  buffer_load_dwordx4 v232, s[24:27], s38 offen offset:2048 nt lds
  buffer_load_dwordx4 v233, s[24:27], s38 offen offset:3072 nt lds
  s_mov_b32 m0, 86016
  s_mov_b32 s38, 53248
  buffer_load_dwordx4 v232, s[24:27], s38 offen offset:0 nt lds
  buffer_load_dwordx4 v233, s[24:27], s38 offen offset:1024 nt lds
  buffer_load_dwordx4 v232, s[24:27], s38 offen offset:2048 nt lds
  buffer_load_dwordx4 v233, s[24:27], s38 offen offset:3072 nt lds
  s_mov_b32 m0, 90112
  s_mov_b32 s38, 57344
  buffer_load_dwordx4 v232, s[24:27], s38 offen offset:0 nt lds
  buffer_load_dwordx4 v233, s[24:27], s38 offen offset:1024 nt lds
  buffer_load_dwordx4 v232, s[24:27], s38 offen offset:2048 nt lds
  buffer_load_dwordx4 v233, s[24:27], s38 offen offset:3072 nt lds
  s_mov_b32 m0, 94208
  s_mov_b32 s38, 61440
  buffer_load_dwordx4 v232, s[24:27], s38 offen offset:0 nt lds
  buffer_load_dwordx4 v233, s[24:27], s38 offen offset:1024 nt lds
  buffer_load_dwordx4 v232, s[24:27], s38 offen offset:2048 nt lds
  buffer_load_dwordx4 v233, s[24:27], s38 offen offset:3072 nt lds
  s_waitcnt vmcnt(63)
  s_barrier
  s_mov_b32 m0, 98304
  s_mov_b32 s38, 65536
  buffer_load_dwordx4 v232, s[24:27], s38 offen offset:0 nt lds
  buffer_load_dwordx4 v233, s[24:27], s38 offen offset:1024 nt lds
  buffer_load_dwordx4 v232, s[24:27], s38 offen offset:2048 nt lds
  buffer_load_dwordx4 v233, s[24:27], s38 offen offset:3072 nt lds
  s_mov_b32 m0, 102400
  s_mov_b32 s38, 69632
  buffer_load_dwordx4 v232, s[24:27], s38 offen offset:0 nt lds
  buffer_load_dwordx4 v233, s[24:27], s38 offen offset:1024 nt lds
  buffer_load_dwordx4 v232, s[24:27], s38 offen offset:2048 nt lds
  buffer_load_dwordx4 v233, s[24:27], s38 offen offset:3072 nt lds
  s_mov_b32 m0, 106496
  s_mov_b32 s38, 73728
  buffer_load_dwordx4 v232, s[24:27], s38 offen offset:0 nt lds
  buffer_load_dwordx4 v233, s[24:27], s38 offen offset:1024 nt lds
  buffer_load_dwordx4 v232, s[24:27], s38 offen offset:2048 nt lds
  buffer_load_dwordx4 v233, s[24:27], s38 offen offset:3072 nt lds
  s_mov_b32 m0, 110592
  s_mov_b32 s38, 77824
  buffer_load_dwordx4 v232, s[24:27], s38 offen offset:0 nt lds
  buffer_load_dwordx4 v233, s[24:27], s38 offen offset:1024 nt lds
  buffer_load_dwordx4 v232, s[24:27], s38 offen offset:2048 nt lds
  buffer_load_dwordx4 v233, s[24:27], s38 offen offset:3072 nt lds
  s_waitcnt vmcnt(63)
  s_barrier
  s_mov_b32 m0, 0
  s_mov_b32 s38, 81920
  buffer_load_dwordx4 v232, s[24:27], s38 offen offset:0 nt lds
  buffer_load_dwordx4 v233, s[24:27], s38 offen offset:1024 nt lds
  buffer_load_dwordx4 v232, s[24:27], s38 offen offset:2048 nt lds
  buffer_load_dwordx4 v233, s[24:27], s38 offen offset:3072 nt lds
  s_mov_b32 m0, 4096
  s_mov_b32 s38, 86016
  buffer_load_dwordx4 v232, s[24:27], s38 offen offset:0 nt lds
  buffer_load_dwordx4 v233, s[24:27], s38 offen offset:1024 nt lds
  buffer_load_dwordx4 v232, s[24:27], s38 offen offset:2048 nt lds
  buffer_load_dwordx4 v233, s[24:27], s38 offen offset:3072 nt lds
  s_mov_b32 m0, 8192
  s_mov_b32 s38, 90112
  buffer_load_dwordx4 v232, s[24:27], s38 offen offset:0 nt lds
  buffer_load_dwordx4 v233, s[24:27], s38 offen offset:1024 nt lds
  buffer_load_dwordx4 v232, s[24:27], s38 offen offset:2048 nt lds
  buffer_load_dwordx4 v233, s[24:27], s38 offen offset:3072 nt lds
  s_mov_b32 m0, 12288
  s_mov_b32 s38, 94208
  buffer_load_dwordx4 v232, s[24:27], s38 offen offset:0 nt lds
  buffer_load_dwordx4 v233, s[24:27], s38 offen offset:1024 nt lds
  buffer_load_dwordx4 v232, s[24:27], s38 offen offset:2048 nt lds
  buffer_load_dwordx4 v233, s[24:27], s38 offen offset:3072 nt lds
  s_waitcnt vmcnt(63)
  s_barrier
  s_mov_b32 m0, 16384
  s_mov_b32 s38, 98304
  buffer_load_dwordx4 v232, s[24:27], s38 offen offset:0 nt lds
  buffer_load_dwordx4 v233, s[24:27], s38 offen offset:1024 nt lds
  buffer_load_dwordx4 v232, s[24:27], s38 offen offset:2048 nt lds
  buffer_load_dwordx4 v233, s[24:27], s38 offen offset:3072 nt lds
  s_mov_b32 m0, 20480
  s_mov_b32 s38, 102400
  buffer_load_dwordx4 v232, s[24:27], s38 offen offset:0 nt lds
  buffer_load_dwordx4 v233, s[24:27], s38 offen offset:1024 nt lds
  buffer_load_dwordx4 v232, s[24:27], s38 offen offset:2048 nt lds
  buffer_load_dwordx4 v233, s[24:27], s38 offen offset:3072 nt lds
  s_mov_b32 m0, 24576
  s_mov_b32 s38, 106496
  buffer_load_dwordx4 v232, s[24:27], s38 offen offset:0 nt lds
  buffer_load_dwordx4 v233, s[24:27], s38 offen offset:1024 nt lds
  buffer_load_dwordx4 v232, s[24:27], s38 offen offset:2048 nt lds
  buffer_load_dwordx4 v233, s[24:27], s38 offen offset:3072 nt lds
  s_mov_b32 m0, 28672
  s_mov_b32 s38, 110592
  buffer_load_dwordx4 v232, s[24:27], s38 offen offset:0 nt lds
  buffer_load_dwordx4 v233, s[24:27], s38 offen offset:1024 nt lds
  buffer_load_dwordx4 v232, s[24:27], s38 offen offset:2048 nt lds
  buffer_load_dwordx4 v233, s[24:27], s38 offen offset:3072 nt lds
  s_waitcnt vmcnt(63)
  s_barrier
  s_mov_b32 m0, 32768
  s_mov_b32 s38, 114688
  buffer_load_dwordx4 v232, s[24:27], s38 offen offset:0 nt lds
  buffer_load_dwordx4 v233, s[24:27], s38 offen offset:1024 nt lds
  buffer_load_dwordx4 v232, s[24:27], s38 offen offset:2048 nt lds
  buffer_load_dwordx4 v233, s[24:27], s38 offen offset:3072 nt lds
  s_mov_b32 m0, 36864
  s_mov_b32 s38, 118784
  buffer_load_dwordx4 v232, s[24:27], s38 offen offset:0 nt lds
  buffer_load_dwordx4 v233, s[24:27], s38 offen offset:1024 nt lds
  buffer_load_dwordx4 v232, s[24:27], s38 offen offset:2048 nt lds
  buffer_load_dwordx4 v233, s[24:27], s38 offen offset:3072 nt lds
  s_mov_b32 m0, 40960
  s_mov_b32 s38, 122880
  buffer_load_dwordx4 v232, s[24:27], s38 offen offset:0 nt lds
  buffer_load_dwordx4 v233, s[24:27], s38 offen offset:1024 nt lds
  buffer_load_dwordx4 v232, s[24:27], s38 offen offset:2048 nt lds
  buffer_load_dwordx4 v233, s[24:27], s38 offen offset:3072 nt lds
  s_mov_b32 m0, 45056
  s_mov_b32 s38, 126976
  buffer_load_dwordx4 v232, s[24:27], s38 offen offset:0 nt lds
  buffer_load_dwordx4 v233, s[24:27], s38 offen offset:1024 nt lds
  buffer_load_dwordx4 v232, s[24:27], s38 offen offset:2048 nt lds
  buffer_load_dwordx4 v233, s[24:27], s38 offen offset:3072 nt lds
  s_waitcnt vmcnt(63)
  s_barrier
  s_mov_b32 m0, 49152
  s_mov_b32 s38, 16777216
  buffer_load_dwordx4 v228, s[20:23], s38 offen offset:0 nt lds
  buffer_load_dwordx4 v229, s[20:23], s38 offen offset:1024 nt lds
  buffer_load_dwordx4 v230, s[20:23], s38 offen offset:2048 nt lds
  buffer_load_dwordx4 v231, s[20:23], s38 offen offset:3072 nt lds
  s_mov_b32 m0, 53248
  s_mov_b32 s38, 16781312
  buffer_load_dwordx4 v228, s[20:23], s38 offen offset:0 nt lds
  buffer_load_dwordx4 v229, s[20:23], s38 offen offset:1024 nt lds
  buffer_load_dwordx4 v230, s[20:23], s38 offen offset:2048 nt lds
  buffer_load_dwordx4 v231, s[20:23], s38 offen offset:3072 nt lds
  s_mov_b32 m0, 57344
  s_mov_b32 s38, 16785408
  buffer_load_dwordx4 v228, s[20:23], s38 offen offset:0 nt lds
  buffer_load_dwordx4 v229, s[20:23], s38 offen offset:1024 nt lds
  buffer_load_dwordx4 v230, s[20:23], s38 offen offset:2048 nt lds
  buffer_load_dwordx4 v231, s[20:23], s38 offen offset:3072 nt lds
  s_mov_b32 m0, 61440
  s_mov_b32 s38, 16789504
  buffer_load_dwordx4 v228, s[20:23], s38 offen offset:0 nt lds
  buffer_load_dwordx4 v229, s[20:23], s38 offen offset:1024 nt lds
  buffer_load_dwordx4 v230, s[20:23], s38 offen offset:2048 nt lds
  buffer_load_dwordx4 v231, s[20:23], s38 offen offset:3072 nt lds
  s_mov_b32 m0, 147456
  s_mov_b32 s38, 16793600
  buffer_load_dwordx4 v228, s[20:23], s38 offen offset:0 nt lds
  buffer_load_dwordx4 v229, s[20:23], s38 offen offset:1024 nt lds
  buffer_load_dwordx4 v230, s[20:23], s38 offen offset:2048 nt lds
  buffer_load_dwordx4 v231, s[20:23], s38 offen offset:3072 nt lds
  s_mov_b32 m0, 151552
  s_mov_b32 s38, 16797696
  buffer_load_dwordx4 v228, s[20:23], s38 offen offset:0 nt lds
  buffer_load_dwordx4 v229, s[20:23], s38 offen offset:1024 nt lds
  buffer_load_dwordx4 v230, s[20:23], s38 offen offset:2048 nt lds
  buffer_load_dwordx4 v231, s[20:23], s38 offen offset:3072 nt lds
  s_mov_b32 m0, 155648
  s_mov_b32 s38, 16801792
  buffer_load_dwordx4 v228, s[20:23], s38 offen offset:0 nt lds
  buffer_load_dwordx4 v229, s[20:23], s38 offen offset:1024 nt lds
  buffer_load_dwordx4 v230, s[20:23], s38 offen offset:2048 nt lds
  buffer_load_dwordx4 v231, s[20:23], s38 offen offset:3072 nt lds
  s_mov_b32 m0, 159744
  s_mov_b32 s38, 16805888
  buffer_load_dwordx4 v228, s[20:23], s38 offen offset:0 nt lds
  buffer_load_dwordx4 v229, s[20:23], s38 offen offset:1024 nt lds
  buffer_load_dwordx4 v230, s[20:23], s38 offen offset:2048 nt lds
  buffer_load_dwordx4 v231, s[20:23], s38 offen offset:3072 nt lds
  s_mov_b32 m0, 114688
  s_mov_b32 s38, 16809984
  buffer_load_dwordx4 v228, s[20:23], s38 offen offset:0 nt lds
  buffer_load_dwordx4 v229, s[20:23], s38 offen offset:1024 nt lds
  buffer_load_dwordx4 v230, s[20:23], s38 offen offset:2048 nt lds
  buffer_load_dwordx4 v231, s[20:23], s38 offen offset:3072 nt lds
  s_mov_b32 m0, 118784
  s_mov_b32 s38, 16814080
  buffer_load_dwordx4 v228, s[20:23], s38 offen offset:0 nt lds
  buffer_load_dwordx4 v229, s[20:23], s38 offen offset:1024 nt lds
  buffer_load_dwordx4 v230, s[20:23], s38 offen offset:2048 nt lds
  buffer_load_dwordx4 v231, s[20:23], s38 offen offset:3072 nt lds
  s_mov_b32 m0, 122880
  s_mov_b32 s38, 16818176
  buffer_load_dwordx4 v228, s[20:23], s38 offen offset:0 nt lds
  buffer_load_dwordx4 v229, s[20:23], s38 offen offset:1024 nt lds
  buffer_load_dwordx4 v230, s[20:23], s38 offen offset:2048 nt lds
  buffer_load_dwordx4 v231, s[20:23], s38 offen offset:3072 nt lds
  s_mov_b32 m0, 126976
  s_mov_b32 s38, 16822272
  buffer_load_dwordx4 v228, s[20:23], s38 offen offset:0 nt lds
  buffer_load_dwordx4 v229, s[20:23], s38 offen offset:1024 nt lds
  buffer_load_dwordx4 v230, s[20:23], s38 offen offset:2048 nt lds
  buffer_load_dwordx4 v231, s[20:23], s38 offen offset:3072 nt lds
  s_mov_b32 m0, 131072
  s_mov_b32 s38, 16826368
  buffer_load_dwordx4 v228, s[20:23], s38 offen offset:0 nt lds
  buffer_load_dwordx4 v229, s[20:23], s38 offen offset:1024 nt lds
  buffer_load_dwordx4 v230, s[20:23], s38 offen offset:2048 nt lds
  buffer_load_dwordx4 v231, s[20:23], s38 offen offset:3072 nt lds
  s_mov_b32 m0, 135168
  s_mov_b32 s38, 16830464
  buffer_load_dwordx4 v228, s[20:23], s38 offen offset:0 nt lds
  buffer_load_dwordx4 v229, s[20:23], s38 offen offset:1024 nt lds
  buffer_load_dwordx4 v230, s[20:23], s38 offen offset:2048 nt lds
  buffer_load_dwordx4 v231, s[20:23], s38 offen offset:3072 nt lds
  s_mov_b32 m0, 139264
  s_mov_b32 s38, 16834560
  buffer_load_dwordx4 v228, s[20:23], s38 offen offset:0 nt lds
  buffer_load_dwordx4 v229, s[20:23], s38 offen offset:1024 nt lds
  buffer_load_dwordx4 v230, s[20:23], s38 offen offset:2048 nt lds
  buffer_load_dwordx4 v231, s[20:23], s38 offen offset:3072 nt lds
  s_mov_b32 m0, 143360
  s_mov_b32 s38, 16838656
  buffer_load_dwordx4 v228, s[20:23], s38 offen offset:0 nt lds
  buffer_load_dwordx4 v229, s[20:23], s38 offen offset:1024 nt lds
  buffer_load_dwordx4 v230, s[20:23], s38 offen offset:2048 nt lds
  buffer_load_dwordx4 v231, s[20:23], s38 offen offset:3072 nt lds
  s_waitcnt vmcnt(63)
  s_barrier
  s_mov_b32 m0, 65536
  s_mov_b32 s38, 16842752
  buffer_load_dwordx4 v228, s[20:23], s38 offen offset:0 nt lds
  buffer_load_dwordx4 v229, s[20:23], s38 offen offset:1024 nt lds
  buffer_load_dwordx4 v230, s[20:23], s38 offen offset:2048 nt lds
  buffer_load_dwordx4 v231, s[20:23], s38 offen offset:3072 nt lds
  s_mov_b32 m0, 69632
  s_mov_b32 s38, 16846848
  buffer_load_dwordx4 v228, s[20:23], s38 offen offset:0 nt lds
  buffer_load_dwordx4 v229, s[20:23], s38 offen offset:1024 nt lds
  buffer_load_dwordx4 v230, s[20:23], s38 offen offset:2048 nt lds
  buffer_load_dwordx4 v231, s[20:23], s38 offen offset:3072 nt lds
  s_mov_b32 m0, 73728
  s_mov_b32 s38, 16850944
  buffer_load_dwordx4 v228, s[20:23], s38 offen offset:0 nt lds
  buffer_load_dwordx4 v229, s[20:23], s38 offen offset:1024 nt lds
  buffer_load_dwordx4 v230, s[20:23], s38 offen offset:2048 nt lds
  buffer_load_dwordx4 v231, s[20:23], s38 offen offset:3072 nt lds
  s_mov_b32 m0, 77824
  s_mov_b32 s38, 16855040
  buffer_load_dwordx4 v228, s[20:23], s38 offen offset:0 nt lds
  buffer_load_dwordx4 v229, s[20:23], s38 offen offset:1024 nt lds
  buffer_load_dwordx4 v230, s[20:23], s38 offen offset:2048 nt lds
  buffer_load_dwordx4 v231, s[20:23], s38 offen offset:3072 nt lds
  s_waitcnt vmcnt(63)
  s_barrier
  s_mov_b32 m0, 81920
  s_mov_b32 s38, 16859136
  buffer_load_dwordx4 v228, s[20:23], s38 offen offset:0 nt lds
  buffer_load_dwordx4 v229, s[20:23], s38 offen offset:1024 nt lds
  buffer_load_dwordx4 v230, s[20:23], s38 offen offset:2048 nt lds
  buffer_load_dwordx4 v231, s[20:23], s38 offen offset:3072 nt lds
  s_mov_b32 m0, 86016
  s_mov_b32 s38, 16863232
  buffer_load_dwordx4 v228, s[20:23], s38 offen offset:0 nt lds
  buffer_load_dwordx4 v229, s[20:23], s38 offen offset:1024 nt lds
  buffer_load_dwordx4 v230, s[20:23], s38 offen offset:2048 nt lds
  buffer_load_dwordx4 v231, s[20:23], s38 offen offset:3072 nt lds
  s_mov_b32 m0, 90112
  s_mov_b32 s38, 16867328
  buffer_load_dwordx4 v228, s[20:23], s38 offen offset:0 nt lds
  buffer_load_dwordx4 v229, s[20:23], s38 offen offset:1024 nt lds
  buffer_load_dwordx4 v230, s[20:23], s38 offen offset:2048 nt lds
  buffer_load_dwordx4 v231, s[20:23], s38 offen offset:3072 nt lds
  s_mov_b32 m0, 94208
  s_mov_b32 s38, 16871424
  buffer_load_dwordx4 v228, s[20:23], s38 offen offset:0 nt lds
  buffer_load_dwordx4 v229, s[20:23], s38 offen offset:1024 nt lds
  buffer_load_dwordx4 v230, s[20:23], s38 offen offset:2048 nt lds
  buffer_load_dwordx4 v231, s[20:23], s38 offen offset:3072 nt lds
  s_waitcnt vmcnt(63)
  s_barrier
  s_mov_b32 m0, 98304
  s_mov_b32 s38, 16875520
  buffer_load_dwordx4 v228, s[20:23], s38 offen offset:0 nt lds
  buffer_load_dwordx4 v229, s[20:23], s38 offen offset:1024 nt lds
  buffer_load_dwordx4 v230, s[20:23], s38 offen offset:2048 nt lds
  buffer_load_dwordx4 v231, s[20:23], s38 offen offset:3072 nt lds
  s_mov_b32 m0, 102400
  s_mov_b32 s38, 16879616
  buffer_load_dwordx4 v228, s[20:23], s38 offen offset:0 nt lds
  buffer_load_dwordx4 v229, s[20:23], s38 offen offset:1024 nt lds
  buffer_load_dwordx4 v230, s[20:23], s38 offen offset:2048 nt lds
  buffer_load_dwordx4 v231, s[20:23], s38 offen offset:3072 nt lds
  s_mov_b32 m0, 106496
  s_mov_b32 s38, 16883712
  buffer_load_dwordx4 v228, s[20:23], s38 offen offset:0 nt lds
  buffer_load_dwordx4 v229, s[20:23], s38 offen offset:1024 nt lds
  buffer_load_dwordx4 v230, s[20:23], s38 offen offset:2048 nt lds
  buffer_load_dwordx4 v231, s[20:23], s38 offen offset:3072 nt lds
  s_mov_b32 m0, 110592
  s_mov_b32 s38, 16887808
  buffer_load_dwordx4 v228, s[20:23], s38 offen offset:0 nt lds
  buffer_load_dwordx4 v229, s[20:23], s38 offen offset:1024 nt lds
  buffer_load_dwordx4 v230, s[20:23], s38 offen offset:2048 nt lds
  buffer_load_dwordx4 v231, s[20:23], s38 offen offset:3072 nt lds
  s_waitcnt vmcnt(63)
  s_barrier
  s_mov_b32 m0, 0
  s_mov_b32 s38, 16891904
  buffer_load_dwordx4 v228, s[20:23], s38 offen offset:0 nt lds
  buffer_load_dwordx4 v229, s[20:23], s38 offen offset:1024 nt lds
  buffer_load_dwordx4 v230, s[20:23], s38 offen offset:2048 nt lds
  buffer_load_dwordx4 v231, s[20:23], s38 offen offset:3072 nt lds
  s_mov_b32 m0, 4096
  s_mov_b32 s38, 16896000
  buffer_load_dwordx4 v228, s[20:23], s38 offen offset:0 nt lds
  buffer_load_dwordx4 v229, s[20:23], s38 offen offset:1024 nt lds
  buffer_load_dwordx4 v230, s[20:23], s38 offen offset:2048 nt lds
  buffer_load_dwordx4 v231, s[20:23], s38 offen offset:3072 nt lds
  s_mov_b32 m0, 8192
  s_mov_b32 s38, 16900096
  buffer_load_dwordx4 v228, s[20:23], s38 offen offset:0 nt lds
  buffer_load_dwordx4 v229, s[20:23], s38 offen offset:1024 nt lds
  buffer_load_dwordx4 v230, s[20:23], s38 offen offset:2048 nt lds
  buffer_load_dwordx4 v231, s[20:23], s38 offen offset:3072 nt lds
  s_mov_b32 m0, 12288
  s_mov_b32 s38, 16904192
  buffer_load_dwordx4 v228, s[20:23], s38 offen offset:0 nt lds
  buffer_load_dwordx4 v229, s[20:23], s38 offen offset:1024 nt lds
  buffer_load_dwordx4 v230, s[20:23], s38 offen offset:2048 nt lds
  buffer_load_dwordx4 v231, s[20:23], s38 offen offset:3072 nt lds
  s_waitcnt vmcnt(63)
  s_barrier
  s_mov_b32 m0, 16384
  s_mov_b32 s38, 16777216
  buffer_load_dwordx4 v234, s[24:27], s38 offen offset:0 nt lds
  buffer_load_dwordx4 v235, s[24:27], s38 offen offset:1024 nt lds
  buffer_load_dwordx4 v234, s[24:27], s38 offen offset:2048 nt lds
  buffer_load_dwordx4 v235, s[24:27], s38 offen offset:3072 nt lds
  s_mov_b32 m0, 20480
  s_mov_b32 s38, 16781312
  buffer_load_dwordx4 v234, s[24:27], s38 offen offset:0 nt lds
  buffer_load_dwordx4 v235, s[24:27], s38 offen offset:1024 nt lds
  buffer_load_dwordx4 v234, s[24:27], s38 offen offset:2048 nt lds
  buffer_load_dwordx4 v235, s[24:27], s38 offen offset:3072 nt lds
  s_mov_b32 m0, 24576
  s_mov_b32 s38, 16785408
  buffer_load_dwordx4 v234, s[24:27], s38 offen offset:0 nt lds
  buffer_load_dwordx4 v235, s[24:27], s38 offen offset:1024 nt lds
  buffer_load_dwordx4 v234, s[24:27], s38 offen offset:2048 nt lds
  buffer_load_dwordx4 v235, s[24:27], s38 offen offset:3072 nt lds
  s_mov_b32 m0, 28672
  s_mov_b32 s38, 16789504
  buffer_load_dwordx4 v234, s[24:27], s38 offen offset:0 nt lds
  buffer_load_dwordx4 v235, s[24:27], s38 offen offset:1024 nt lds
  buffer_load_dwordx4 v234, s[24:27], s38 offen offset:2048 nt lds
  buffer_load_dwordx4 v235, s[24:27], s38 offen offset:3072 nt lds
  s_waitcnt vmcnt(63)
  s_barrier
  s_mov_b32 m0, 32768
  s_mov_b32 s38, 16809984
  buffer_load_dwordx4 v234, s[24:27], s38 offen offset:0 nt lds
  buffer_load_dwordx4 v235, s[24:27], s38 offen offset:1024 nt lds
  buffer_load_dwordx4 v234, s[24:27], s38 offen offset:2048 nt lds
  buffer_load_dwordx4 v235, s[24:27], s38 offen offset:3072 nt lds
  s_mov_b32 m0, 36864
  s_mov_b32 s38, 16814080
  buffer_load_dwordx4 v234, s[24:27], s38 offen offset:0 nt lds
  buffer_load_dwordx4 v235, s[24:27], s38 offen offset:1024 nt lds
  buffer_load_dwordx4 v234, s[24:27], s38 offen offset:2048 nt lds
  buffer_load_dwordx4 v235, s[24:27], s38 offen offset:3072 nt lds
  s_mov_b32 m0, 40960
  s_mov_b32 s38, 16818176
  buffer_load_dwordx4 v234, s[24:27], s38 offen offset:0 nt lds
  buffer_load_dwordx4 v235, s[24:27], s38 offen offset:1024 nt lds
  buffer_load_dwordx4 v234, s[24:27], s38 offen offset:2048 nt lds
  buffer_load_dwordx4 v235, s[24:27], s38 offen offset:3072 nt lds
  s_mov_b32 m0, 45056
  s_mov_b32 s38, 16822272
  buffer_load_dwordx4 v234, s[24:27], s38 offen offset:0 nt lds
  buffer_load_dwordx4 v235, s[24:27], s38 offen offset:1024 nt lds
  buffer_load_dwordx4 v234, s[24:27], s38 offen offset:2048 nt lds
  buffer_load_dwordx4 v235, s[24:27], s38 offen offset:3072 nt lds
  s_waitcnt vmcnt(63)
  s_barrier
  s_mov_b32 m0, 49152
  s_mov_b32 s38, 16842752
  buffer_load_dwordx4 v234, s[24:27], s38 offen offset:0 nt lds
  buffer_load_dwordx4 v235, s[24:27], s38 offen offset:1024 nt lds
  buffer_load_dwordx4 v234, s[24:27], s38 offen offset:2048 nt lds
  buffer_load_dwordx4 v235, s[24:27], s38 offen offset:3072 nt lds
  s_mov_b32 m0, 53248
  s_mov_b32 s38, 16846848
  buffer_load_dwordx4 v234, s[24:27], s38 offen offset:0 nt lds
  buffer_load_dwordx4 v235, s[24:27], s38 offen offset:1024 nt lds
  buffer_load_dwordx4 v234, s[24:27], s38 offen offset:2048 nt lds
  buffer_load_dwordx4 v235, s[24:27], s38 offen offset:3072 nt lds
  s_mov_b32 m0, 57344
  s_mov_b32 s38, 16850944
  buffer_load_dwordx4 v234, s[24:27], s38 offen offset:0 nt lds
  buffer_load_dwordx4 v235, s[24:27], s38 offen offset:1024 nt lds
  buffer_load_dwordx4 v234, s[24:27], s38 offen offset:2048 nt lds
  buffer_load_dwordx4 v235, s[24:27], s38 offen offset:3072 nt lds
  s_mov_b32 m0, 61440
  s_mov_b32 s38, 16855040
  buffer_load_dwordx4 v234, s[24:27], s38 offen offset:0 nt lds
  buffer_load_dwordx4 v235, s[24:27], s38 offen offset:1024 nt lds
  buffer_load_dwordx4 v234, s[24:27], s38 offen offset:2048 nt lds
  buffer_load_dwordx4 v235, s[24:27], s38 offen offset:3072 nt lds
  s_waitcnt vmcnt(63)
  s_barrier
  s_mov_b32 m0, 147456
  s_mov_b32 s38, 16875520
  buffer_load_dwordx4 v234, s[24:27], s38 offen offset:0 nt lds
  buffer_load_dwordx4 v235, s[24:27], s38 offen offset:1024 nt lds
  buffer_load_dwordx4 v234, s[24:27], s38 offen offset:2048 nt lds
  buffer_load_dwordx4 v235, s[24:27], s38 offen offset:3072 nt lds
  s_mov_b32 m0, 151552
  s_mov_b32 s38, 16879616
  buffer_load_dwordx4 v234, s[24:27], s38 offen offset:0 nt lds
  buffer_load_dwordx4 v235, s[24:27], s38 offen offset:1024 nt lds
  buffer_load_dwordx4 v234, s[24:27], s38 offen offset:2048 nt lds
  buffer_load_dwordx4 v235, s[24:27], s38 offen offset:3072 nt lds
  s_mov_b32 m0, 155648
  s_mov_b32 s38, 16883712
  buffer_load_dwordx4 v234, s[24:27], s38 offen offset:0 nt lds
  buffer_load_dwordx4 v235, s[24:27], s38 offen offset:1024 nt lds
  buffer_load_dwordx4 v234, s[24:27], s38 offen offset:2048 nt lds
  buffer_load_dwordx4 v235, s[24:27], s38 offen offset:3072 nt lds
  s_mov_b32 m0, 159744
  s_mov_b32 s38, 16887808
  buffer_load_dwordx4 v234, s[24:27], s38 offen offset:0 nt lds
  buffer_load_dwordx4 v235, s[24:27], s38 offen offset:1024 nt lds
  buffer_load_dwordx4 v234, s[24:27], s38 offen offset:2048 nt lds
  buffer_load_dwordx4 v235, s[24:27], s38 offen offset:3072 nt lds
  s_waitcnt vmcnt(63)
  s_barrier
  s_mov_b32 m0, 114688
  s_mov_b32 s38, 16777344
  buffer_load_dwordx4 v234, s[24:27], s38 offen offset:0 nt lds
  buffer_load_dwordx4 v235, s[24:27], s38 offen offset:1024 nt lds
  buffer_load_dwordx4 v234, s[24:27], s38 offen offset:2048 nt lds
  buffer_load_dwordx4 v235, s[24:27], s38 offen offset:3072 nt lds
  s_mov_b32 m0, 118784
  s_mov_b32 s38, 16781440
  buffer_load_dwordx4 v234, s[24:27], s38 offen offset:0 nt lds
  buffer_load_dwordx4 v235, s[24:27], s38 offen offset:1024 nt lds
  buffer_load_dwordx4 v234, s[24:27], s38 offen offset:2048 nt lds
  buffer_load_dwordx4 v235, s[24:27], s38 offen offset:3072 nt lds
  s_mov_b32 m0, 122880
  s_mov_b32 s38, 16785536
  buffer_load_dwordx4 v234, s[24:27], s38 offen offset:0 nt lds
  buffer_load_dwordx4 v235, s[24:27], s38 offen offset:1024 nt lds
  buffer_load_dwordx4 v234, s[24:27], s38 offen offset:2048 nt lds
  buffer_load_dwordx4 v235, s[24:27], s38 offen offset:3072 nt lds
  s_mov_b32 m0, 126976
  s_mov_b32 s38, 16789632
  buffer_load_dwordx4 v234, s[24:27], s38 offen offset:0 nt lds
  buffer_load_dwordx4 v235, s[24:27], s38 offen offset:1024 nt lds
  buffer_load_dwordx4 v234, s[24:27], s38 offen offset:2048 nt lds
  buffer_load_dwordx4 v235, s[24:27], s38 offen offset:3072 nt lds
  v_mov_b32 v200, 1
  s_mov_b64 exec, 1
  buffer_atomic_add v200, off, s[72:75], 0 offset:8 sc0 sc1
  s_mov_b64 exec, -1
  s_waitcnt vmcnt(63)
  s_barrier
  s_mov_b32 m0, 131072
  s_mov_b32 s38, 16810112
  buffer_load_dwordx4 v234, s[24:27], s38 offen offset:0 nt lds
  buffer_load_dwordx4 v235, s[24:27], s38 offen offset:1024 nt lds
  buffer_load_dwordx4 v234, s[24:27], s38 offen offset:2048 nt lds
  buffer_load_dwordx4 v235, s[24:27], s38 offen offset:3072 nt lds
  s_mov_b32 m0, 135168
  s_mov_b32 s38, 16814208
  buffer_load_dwordx4 v234, s[24:27], s38 offen offset:0 nt lds
  buffer_load_dwordx4 v235, s[24:27], s38 offen offset:1024 nt lds
  buffer_load_dwordx4 v234, s[24:27], s38 offen offset:2048 nt lds
  buffer_load_dwordx4 v235, s[24:27], s38 offen offset:3072 nt lds
  s_mov_b32 m0, 139264
  s_mov_b32 s38, 16818304
  buffer_load_dwordx4 v234, s[24:27], s38 offen offset:0 nt lds
  buffer_load_dwordx4 v235, s[24:27], s38 offen offset:1024 nt lds
  buffer_load_dwordx4 v234, s[24:27], s38 offen offset:2048 nt lds
  buffer_load_dwordx4 v235, s[24:27], s38 offen offset:3072 nt lds
  s_mov_b32 m0, 143360
  s_mov_b32 s38, 16822400
  buffer_load_dwordx4 v234, s[24:27], s38 offen offset:0 nt lds
  buffer_load_dwordx4 v235, s[24:27], s38 offen offset:1024 nt lds
  buffer_load_dwordx4 v234, s[24:27], s38 offen offset:2048 nt lds
  buffer_load_dwordx4 v235, s[24:27], s38 offen offset:3072 nt lds
  s_waitcnt vmcnt(63)
  s_barrier
  s_mov_b32 m0, 65536
  s_mov_b32 s38, 16842880
  buffer_load_dwordx4 v234, s[24:27], s38 offen offset:0 nt lds
  buffer_load_dwordx4 v235, s[24:27], s38 offen offset:1024 nt lds
  buffer_load_dwordx4 v234, s[24:27], s38 offen offset:2048 nt lds
  buffer_load_dwordx4 v235, s[24:27], s38 offen offset:3072 nt lds
  s_mov_b32 m0, 69632
  s_mov_b32 s38, 16846976
  buffer_load_dwordx4 v234, s[24:27], s38 offen offset:0 nt lds
  buffer_load_dwordx4 v235, s[24:27], s38 offen offset:1024 nt lds
  buffer_load_dwordx4 v234, s[24:27], s38 offen offset:2048 nt lds
  buffer_load_dwordx4 v235, s[24:27], s38 offen offset:3072 nt lds
  s_mov_b32 m0, 73728
  s_mov_b32 s38, 16851072
  buffer_load_dwordx4 v234, s[24:27], s38 offen offset:0 nt lds
  buffer_load_dwordx4 v235, s[24:27], s38 offen offset:1024 nt lds
  buffer_load_dwordx4 v234, s[24:27], s38 offen offset:2048 nt lds
  buffer_load_dwordx4 v235, s[24:27], s38 offen offset:3072 nt lds
  s_mov_b32 m0, 77824
  s_mov_b32 s38, 16855168
  buffer_load_dwordx4 v234, s[24:27], s38 offen offset:0 nt lds
  buffer_load_dwordx4 v235, s[24:27], s38 offen offset:1024 nt lds
  buffer_load_dwordx4 v234, s[24:27], s38 offen offset:2048 nt lds
  buffer_load_dwordx4 v235, s[24:27], s38 offen offset:3072 nt lds
  s_waitcnt vmcnt(63)
  s_barrier
  s_mov_b32 m0, 81920
  s_mov_b32 s38, 16875648
  buffer_load_dwordx4 v234, s[24:27], s38 offen offset:0 nt lds
  buffer_load_dwordx4 v235, s[24:27], s38 offen offset:1024 nt lds
  buffer_load_dwordx4 v234, s[24:27], s38 offen offset:2048 nt lds
  buffer_load_dwordx4 v235, s[24:27], s38 offen offset:3072 nt lds
  s_mov_b32 m0, 86016
  s_mov_b32 s38, 16879744
  buffer_load_dwordx4 v234, s[24:27], s38 offen offset:0 nt lds
  buffer_load_dwordx4 v235, s[24:27], s38 offen offset:1024 nt lds
  buffer_load_dwordx4 v234, s[24:27], s38 offen offset:2048 nt lds
  buffer_load_dwordx4 v235, s[24:27], s38 offen offset:3072 nt lds
  s_mov_b32 m0, 90112
  s_mov_b32 s38, 16883840
  buffer_load_dwordx4 v234, s[24:27], s38 offen offset:0 nt lds
  buffer_load_dwordx4 v235, s[24:27], s38 offen offset:1024 nt lds
  buffer_load_dwordx4 v234, s[24:27], s38 offen offset:2048 nt lds
  buffer_load_dwordx4 v235, s[24:27], s38 offen offset:3072 nt lds
  s_mov_b32 m0, 94208
  s_mov_b32 s38, 16887936
  buffer_load_dwordx4 v234, s[24:27], s38 offen offset:0 nt lds
  buffer_load_dwordx4 v235, s[24:27], s38 offen offset:1024 nt lds
  buffer_load_dwordx4 v234, s[24:27], s38 offen offset:2048 nt lds
  buffer_load_dwordx4 v235, s[24:27], s38 offen offset:3072 nt lds
  s_waitcnt vmcnt(63)
  s_barrier
  s_lshl_b32 s63, s88, 5
  s_mov_b32 m0, 98304
  s_add_u32 s38, s63, 0
  buffer_load_dwordx4 v236, s[76:79], s38 offen offset:0 lds
  buffer_load_dwordx4 v237, s[76:79], s38 offen offset:1024 lds
  buffer_load_dwordx4 v238, s[76:79], s38 offen offset:2048 lds
  buffer_load_dwordx4 v239, s[76:79], s38 offen offset:3072 lds
  s_mov_b32 m0, 102400
  s_add_u32 s38, s63, 16384
  buffer_load_dwordx4 v236, s[76:79], s38 offen offset:0 lds
  buffer_load_dwordx4 v237, s[76:79], s38 offen offset:1024 lds
  buffer_load_dwordx4 v238, s[76:79], s38 offen offset:2048 lds
  buffer_load_dwordx4 v239, s[76:79], s38 offen offset:3072 lds
  s_mov_b32 m0, 106496
  s_add_u32 s38, s63, 32768
  buffer_load_dwordx4 v236, s[76:79], s38 offen offset:0 lds
  buffer_load_dwordx4 v237, s[76:79], s38 offen offset:1024 lds
  buffer_load_dwordx4 v238, s[76:79], s38 offen offset:2048 lds
  buffer_load_dwordx4 v239, s[76:79], s38 offen offset:3072 lds
  s_mov_b32 m0, 110592
  s_add_u32 s38, s63, 49152
  buffer_load_dwordx4 v236, s[76:79], s38 offen offset:0 lds
  buffer_load_dwordx4 v237, s[76:79], s38 offen offset:1024 lds
  buffer_load_dwordx4 v238, s[76:79], s38 offen offset:2048 lds
  buffer_load_dwordx4 v239, s[76:79], s38 offen offset:3072 lds
  s_waitcnt vmcnt(63)
  s_barrier
  s_lshl_b32 s63, s89, 5
  s_mov_b32 m0, 0
  s_add_u32 s38, s63, 0
  buffer_load_dwordx4 v236, s[76:79], s38 offen offset:0 lds
  buffer_load_dwordx4 v237, s[76:79], s38 offen offset:1024 lds
  buffer_load_dwordx4 v238, s[76:79], s38 offen offset:2048 lds
  buffer_load_dwordx4 v239, s[76:79], s38 offen offset:3072 lds
  s_mov_b32 m0, 4096
  s_add_u32 s38, s63, 16384
  buffer_load_dwordx4 v236, s[76:79], s38 offen offset:0 lds
  buffer_load_dwordx4 v237, s[76:79], s38 offen offset:1024 lds
  buffer_load_dwordx4 v238, s[76:79], s38 offen offset:2048 lds
  buffer_load_dwordx4 v239, s[76:79], s38 offen offset:3072 lds
  s_mov_b32 m0, 8192
  s_add_u32 s38, s63, 32768
  buffer_load_dwordx4 v236, s[76:79], s38 offen offset:0 lds
  buffer_load_dwordx4 v237, s[76:79], s38 offen offset:1024 lds
  buffer_load_dwordx4 v238, s[76:79], s38 offen offset:2048 lds
  buffer_load_dwordx4 v239, s[76:79], s38 offen offset:3072 lds
  s_mov_b32 m0, 12288
  s_add_u32 s38, s63, 49152
  buffer_load_dwordx4 v236, s[76:79], s38 offen offset:0 lds
  buffer_load_dwordx4 v237, s[76:79], s38 offen offset:1024 lds
  buffer_load_dwordx4 v238, s[76:79], s38 offen offset:2048 lds
  buffer_load_dwordx4 v239, s[76:79], s38 offen offset:3072 lds
  s_waitcnt vmcnt(63)
  s_barrier
  s_lshl_b32 s63, s90, 5
  s_mov_b32 m0, 16384
  s_add_u32 s38, s63, 0
  buffer_load_dwordx4 v236, s[76:79], s38 offen offset:0 lds
  buffer_load_dwordx4 v237, s[76:79], s38 offen offset:1024 lds
  buffer_load_dwordx4 v238, s[76:79], s38 offen offset:2048 lds
  buffer_load_dwordx4 v239, s[76:79], s38 offen offset:3072 lds
  s_mov_b32 m0, 20480
  s_add_u32 s38, s63, 16384
  buffer_load_dwordx4 v236, s[76:79], s38 offen offset:0 lds
  buffer_load_dwordx4 v237, s[76:79], s38 offen offset:1024 lds
  buffer_load_dwordx4 v238, s[76:79], s38 offen offset:2048 lds
  buffer_load_dwordx4 v239, s[76:79], s38 offen offset:3072 lds
  s_mov_b32 m0, 24576
  s_add_u32 s38, s63, 32768
  buffer_load_dwordx4 v236, s[76:79], s38 offen offset:0 lds
  buffer_load_dwordx4 v237, s[76:79], s38 offen offset:1024 lds
  buffer_load_dwordx4 v238, s[76:79], s38 offen offset:2048 lds
  buffer_load_dwordx4 v239, s[76:79], s38 offen offset:3072 lds
  s_mov_b32 m0, 28672
  s_add_u32 s38, s63, 49152
  buffer_load_dwordx4 v236, s[76:79], s38 offen offset:0 lds
  buffer_load_dwordx4 v237, s[76:79], s38 offen offset:1024 lds
  buffer_load_dwordx4 v238, s[76:79], s38 offen offset:2048 lds
  buffer_load_dwordx4 v239, s[76:79], s38 offen offset:3072 lds
  s_waitcnt vmcnt(63)
  s_barrier
  s_lshl_b32 s63, s91, 5
  s_mov_b32 m0, 32768
  s_add_u32 s38, s63, 0
  buffer_load_dwordx4 v236, s[76:79], s38 offen offset:0 lds
  buffer_load_dwordx4 v237, s[76:79], s38 offen offset:1024 lds
  buffer_load_dwordx4 v238, s[76:79], s38 offen offset:2048 lds
  buffer_load_dwordx4 v239, s[76:79], s38 offen offset:3072 lds
  s_mov_b32 m0, 36864
  s_add_u32 s38, s63, 16384
  buffer_load_dwordx4 v236, s[76:79], s38 offen offset:0 lds
  buffer_load_dwordx4 v237, s[76:79], s38 offen offset:1024 lds
  buffer_load_dwordx4 v238, s[76:79], s38 offen offset:2048 lds
  buffer_load_dwordx4 v239, s[76:79], s38 offen offset:3072 lds
  s_mov_b32 m0, 40960
  s_add_u32 s38, s63, 32768
  buffer_load_dwordx4 v236, s[76:79], s38 offen offset:0 lds
  buffer_load_dwordx4 v237, s[76:79], s38 offen offset:1024 lds
  buffer_load_dwordx4 v238, s[76:79], s38 offen offset:2048 lds
  buffer_load_dwordx4 v239, s[76:79], s38 offen offset:3072 lds
  s_mov_b32 m0, 45056
  s_add_u32 s38, s63, 49152
  buffer_load_dwordx4 v236, s[76:79], s38 offen offset:0 lds
  buffer_load_dwordx4 v237, s[76:79], s38 offen offset:1024 lds
  buffer_load_dwordx4 v238, s[76:79], s38 offen offset:2048 lds
  buffer_load_dwordx4 v239, s[76:79], s38 offen offset:3072 lds
  s_waitcnt vmcnt(63)
  s_barrier
  s_lshl_b32 s63, s92, 5
  s_mov_b32 m0, 49152
  s_add_u32 s38, s63, 0
  buffer_load_dwordx4 v236, s[76:79], s38 offen offset:0 lds
  buffer_load_dwordx4 v237, s[76:79], s38 offen offset:1024 lds
  buffer_load_dwordx4 v238, s[76:79], s38 offen offset:2048 lds
  buffer_load_dwordx4 v239, s[76:79], s38 offen offset:3072 lds
  s_mov_b32 m0, 53248
  s_add_u32 s38, s63, 16384
  buffer_load_dwordx4 v236, s[76:79], s38 offen offset:0 lds
  buffer_load_dwordx4 v237, s[76:79], s38 offen offset:1024 lds
  buffer_load_dwordx4 v238, s[76:79], s38 offen offset:2048 lds
  buffer_load_dwordx4 v239, s[76:79], s38 offen offset:3072 lds
  s_mov_b32 m0, 57344
  s_add_u32 s38, s63, 32768
  buffer_load_dwordx4 v236, s[76:79], s38 offen offset:0 lds
  buffer_load_dwordx4 v237, s[76:79], s38 offen offset:1024 lds
  buffer_load_dwordx4 v238, s[76:79], s38 offen offset:2048 lds
  buffer_load_dwordx4 v239, s[76:79], s38 offen offset:3072 lds
  s_mov_b32 m0, 61440
  s_add_u32 s38, s63, 49152
  buffer_load_dwordx4 v236, s[76:79], s38 offen offset:0 lds
  buffer_load_dwordx4 v237, s[76:79], s38 offen offset:1024 lds
  buffer_load_dwordx4 v238, s[76:79], s38 offen offset:2048 lds
  buffer_load_dwordx4 v239, s[76:79], s38 offen offset:3072 lds
  s_waitcnt vmcnt(63)
  s_barrier
  s_lshl_b32 s63, s93, 5
  s_mov_b32 m0, 147456
  s_add_u32 s38, s63, 0
  buffer_load_dwordx4 v236, s[76:79], s38 offen offset:0 lds
  buffer_load_dwordx4 v237, s[76:79], s38 offen offset:1024 lds
  buffer_load_dwordx4 v238, s[76:79], s38 offen offset:2048 lds
  buffer_load_dwordx4 v239, s[76:79], s38 offen offset:3072 lds
  s_mov_b32 m0, 151552
  s_add_u32 s38, s63, 16384
  buffer_load_dwordx4 v236, s[76:79], s38 offen offset:0 lds
  buffer_load_dwordx4 v237, s[76:79], s38 offen offset:1024 lds
  buffer_load_dwordx4 v238, s[76:79], s38 offen offset:2048 lds
  buffer_load_dwordx4 v239, s[76:79], s38 offen offset:3072 lds
  s_mov_b32 m0, 155648
  s_add_u32 s38, s63, 32768
  buffer_load_dwordx4 v236, s[76:79], s38 offen offset:0 lds
  buffer_load_dwordx4 v237, s[76:79], s38 offen offset:1024 lds
  buffer_load_dwordx4 v238, s[76:79], s38 offen offset:2048 lds
  buffer_load_dwordx4 v239, s[76:79], s38 offen offset:3072 lds
  s_mov_b32 m0, 159744
  s_add_u32 s38, s63, 49152
  buffer_load_dwordx4 v236, s[76:79], s38 offen offset:0 lds
  buffer_load_dwordx4 v237, s[76:79], s38 offen offset:1024 lds
  buffer_load_dwordx4 v238, s[76:79], s38 offen offset:2048 lds
  buffer_load_dwordx4 v239, s[76:79], s38 offen offset:3072 lds
  s_waitcnt vmcnt(63)
  s_barrier
  s_lshl_b32 s63, s94, 5
  s_mov_b32 m0, 114688
  s_add_u32 s38, s63, 0
  buffer_load_dwordx4 v236, s[76:79], s38 offen offset:0 lds
  buffer_load_dwordx4 v237, s[76:79], s38 offen offset:1024 lds
  buffer_load_dwordx4 v238, s[76:79], s38 offen offset:2048 lds
  buffer_load_dwordx4 v239, s[76:79], s38 offen offset:3072 lds
  s_mov_b32 m0, 118784
  s_add_u32 s38, s63, 16384
  buffer_load_dwordx4 v236, s[76:79], s38 offen offset:0 lds
  buffer_load_dwordx4 v237, s[76:79], s38 offen offset:1024 lds
  buffer_load_dwordx4 v238, s[76:79], s38 offen offset:2048 lds
  buffer_load_dwordx4 v239, s[76:79], s38 offen offset:3072 lds
  s_mov_b32 m0, 122880
  s_add_u32 s38, s63, 32768
  buffer_load_dwordx4 v236, s[76:79], s38 offen offset:0 lds
  buffer_load_dwordx4 v237, s[76:79], s38 offen offset:1024 lds
  buffer_load_dwordx4 v238, s[76:79], s38 offen offset:2048 lds
  buffer_load_dwordx4 v239, s[76:79], s38 offen offset:3072 lds
  s_mov_b32 m0, 126976
  s_add_u32 s38, s63, 49152
  buffer_load_dwordx4 v236, s[76:79], s38 offen offset:0 lds
  buffer_load_dwordx4 v237, s[76:79], s38 offen offset:1024 lds
  buffer_load_dwordx4 v238, s[76:79], s38 offen offset:2048 lds
  buffer_load_dwordx4 v239, s[76:79], s38 offen offset:3072 lds
  s_waitcnt vmcnt(63)
  s_barrier
  s_lshl_b32 s63, s95, 5
  s_mov_b32 m0, 131072
  s_add_u32 s38, s63, 0
  buffer_load_dwordx4 v236, s[76:79], s38 offen offset:0 lds
  buffer_load_dwordx4 v237, s[76:79], s38 offen offset:1024 lds
  buffer_load_dwordx4 v238, s[76:79], s38 offen offset:2048 lds
  buffer_load_dwordx4 v239, s[76:79], s38 offen offset:3072 lds
  s_mov_b32 m0, 135168
  s_add_u32 s38, s63, 16384
  buffer_load_dwordx4 v236, s[76:79], s38 offen offset:0 lds
  buffer_load_dwordx4 v237, s[76:79], s38 offen offset:1024 lds
  buffer_load_dwordx4 v238, s[76:79], s38 offen offset:2048 lds
  buffer_load_dwordx4 v239, s[76:79], s38 offen offset:3072 lds
  s_mov_b32 m0, 139264
  s_add_u32 s38, s63, 32768
  buffer_load_dwordx4 v236, s[76:79], s38 offen offset:0 lds
  buffer_load_dwordx4 v237, s[76:79], s38 offen offset:1024 lds
  buffer_load_dwordx4 v238, s[76:79], s38 offen offset:2048 lds
  buffer_load_dwordx4 v239, s[76:79], s38 offen offset:3072 lds
  s_mov_b32 m0, 143360
  s_add_u32 s38, s63, 49152
  buffer_load_dwordx4 v236, s[76:79], s38 offen offset:0 lds
  buffer_load_dwordx4 v237, s[76:79], s38 offen offset:1024 lds
  buffer_load_dwordx4 v238, s[76:79], s38 offen offset:2048 lds
  buffer_load_dwordx4 v239, s[76:79], s38 offen offset:3072 lds
  s_waitcnt vmcnt(63)
  s_waitcnt vmcnt(0)
  s_barrier
  v_mov_b32 v232, 65536
  v_add_u32 v233, 65600, v248
  s_lshl_b32 s101, s48, 9
  s_add_u32 s101, s101, 4096
  s_lshl_b32 s63, s48, 9
  s_mov_b32 s54, 128
  s_waitcnt vmcnt(0) lgkmcnt(0)
  v_readfirstlane_b32 s98, v200
  s_nop 0
  s_cmp_lg_u32 s98, 255
  s_cbranch_scc1 L_noclean
  v_mov_b32 v200, 0
  v_mov_b32 v201, 0
  v_mov_b32 v202, 0
  v_mov_b32 v203, 0
  s_mov_b64 exec, 1
  buffer_store_dwordx4 v[200:203], off, s[72:75], 0 sc1
  s_mov_b64 exec, -1
  s_waitcnt vmcnt(0)
L_noclean:
  s_movk_i32 s100, 0xff
  buffer_load_dwordx2 v[8:9], v249, s[68:71], s101 offen offset:2048 sc1
  buffer_load_dwordx2 v[0:1], v249, s[68:71], s63 offen offset:2048 sc1
  s_sleep 1
  buffer_load_dwordx2 v[10:11], v249, s[68:71], s101 offen offset:2048 sc1
  buffer_load_dwordx2 v[2:3], v249, s[68:71], s63 offen offset:2048 sc1
L_lk_loop:
  s_waitcnt vmcnt(2)
  v_cmp_eq_u64 vcc, v[0:1], v[254:255]
  v_cmp_eq_u64_e64 s[20:21], v[8:9], v[254:255]
  buffer_load_dwordx2 v[8:9], v249, s[68:71], s101 offen offset:2048 sc1
  buffer_load_dwordx2 v[0:1], v249, s[68:71], s63 offen offset:2048 sc1
  s_or_b64 s[20:21], s[20:21], vcc
  v_lshrrev_b64 v[4:5], v249, vcc
  v_lshrrev_b64 v[6:7], v249, s[20:21]
  v_and_b32 v4, 0xff, v4
  v_and_b32 v6, 0xff, v6
  v_cmp_eq_u32_e64 s[98:99], v4, s100
  v_cmp_eq_u32_e64 s[20:21], v6, s100
  s_nop 1
  s_and_b32 s20, s20, 0x7f
  s_cbranch_scc0 L_lk0
  s_mov_b32 exec_lo, s20
  s_mov_b32 exec_hi, 0
  ds_write_b64 v233, v[254:255]
  s_mov_b64 exec, -1
  s_and_b32 s98, s98, 0x7f
  s_cbranch_scc0 L_lk0
  s_mov_b32 exec_lo, s98
  s_mov_b32 exec_hi, 0
  ds_write_b64 v233, v[254:255] offset:8
  s_mov_b64 exec, -1
  s_cmp_eq_u32 s98, 0x7f
  s_cbranch_scc1 L_lk_done
L_lk0:
  s_waitcnt vmcnt(2)
  v_cmp_eq_u64 vcc, v[2:3], v[254:255]
  v_cmp_eq_u64_e64 s[20:21], v[10:11], v[254:255]
  buffer_load_dwordx2 v[10:11], v249, s[68:71], s101 offen offset:2048 sc1
  buffer_load_dwordx2 v[2:3], v249, s[68:71], s63 offen offset:2048 sc1
  s_or_b64 s[20:21], s[20:21], vcc
  v_lshrrev_b64 v[4:5], v249, vcc
  v_lshrrev_b64 v[6:7], v249, s[20:21]
  v_and_b32 v4, 0xff, v4
  v_and_b32 v6, 0xff, v6
  v_cmp_eq_u32_e64 s[98:99], v4, s100
  v_cmp_eq_u32_e64 s[20:21], v6, s100
  s_nop 1
  s_and_b32 s20, s20, 0x7f
  s_cbranch_scc0 L_lk2
  s_mov_b32 exec_lo, s20
  s_mov_b32 exec_hi, 0
  ds_write_b64 v233, v[254:255]
  s_mov_b64 exec, -1
  s_and_b32 s98, s98, 0x7f
  s_cbranch_scc0 L_lk2
  s_mov_b32 exec_lo, s98
  s_mov_b32 exec_hi, 0
  ds_write_b64 v233, v[254:255] offset:8
  s_mov_b64 exec, -1
  s_cmp_eq_u32 s98, 0x7f
  s_cbranch_scc1 L_lk_done
L_lk2:
  s_sub_u32 s54, s54, 1
  s_cbranch_scc0 L_lk_loop
  ds_write_b64 v232, v[254:255] offset:32
L_lk_done:
  s_movk_i32 s98, 4096
  buffer_load_dwordx2 v[244:245], v249, s[68:71], s98 offen sc1
  s_waitcnt vmcnt(0)
  v_cmp_eq_u64 vcc, v[244:245], v[254:255]
  s_nop 4
  v_mov_b32 v234, vcc_lo
  ds_write_b32 v232, v234
  s_waitcnt lgkmcnt(0)
  s_branch L_fin
L_k1_done:
  s_endpgm
.section .rodata,"a"
.p2align 6
.amdhsa_kernel attn_kernel
  .amdhsa_next_free_vgpr 256
  .amdhsa_next_free_sgpr 102
  .amdhsa_accum_offset 256
  .amdhsa_group_segment_fixed_size 0
  .amdhsa_kernarg_size 104
  .amdhsa_user_sgpr_count 2
  .amdhsa_user_sgpr_kernarg_segment_ptr 1
  .amdhsa_system_sgpr_workgroup_id_x 1
.end_amdhsa_kernel
```
